```python
import torch

def _softmax(x, axis=-1):
    return torch.softmax(x, dim=axis)
def _gelu(x):
    return torch.nn.functional.gelu(x, approximate="tanh")
def _silu(x):
    return torch.nn.functional.silu(x)
def _sigmoid(x):
    return torch.sigmoid(x)
def _layernorm(x, axis=-1, eps=1e-5):
    m = x.mean(dim=axis, keepdim=True)
    v = x.var(dim=axis, keepdim=True, unbiased=False)
    return (x - m) / torch.sqrt(v + eps)
def _scatter_add(tgt, idx, src, axis=0):
    return tgt.clone().index_add_(axis, idx, src)
def _segment_sum(src, seg, n):
    out = torch.zeros((n,) + src.shape[1:], dtype=src.dtype)
    return out.index_add_(0, seg, src)
def _pad(x, pw):
    flat = tuple(v for pair in reversed(pw) for v in pair)
    return torch.nn.functional.pad(x, flat)

kernel_name = 'interleave_layers__mha_block__dense_activation_silu__prompt'

def setup_inputs():

    _w = (lambda a: (lambda t: t.to(torch.bfloat16) if t.is_floating_point() else t)(torch.as_tensor(a)))
    def _A_setup():
        B, S, D, H = 1, 2048, 576, 32
        return {
            "x": _w((lambda *s: torch.randn(*s, dtype=torch.bfloat16) * 0.05)(B, S, D)),
            "wqkv": _w((lambda *s: torch.randn(*s, dtype=torch.bfloat16) * 0.05)(D, 3 * D)),
            "wo": _w((lambda *s: torch.randn(*s, dtype=torch.bfloat16) * 0.05)(D, D)),
        }
    _A_in = _A_setup()

    def _B_setup():
        B, S, D, F = 1, 2048, 576, 4608
        return {
            "x": _w((lambda *s: torch.randn(*s, dtype=torch.bfloat16) * 0.05)(B, S, D)),
            "w1": _w((lambda *s: torch.randn(*s, dtype=torch.bfloat16) * 3.2)(D, F) * (D ** -0.5)),
            "w2": _w((lambda *s: torch.randn(*s, dtype=torch.bfloat16) * 0.4)(F, D) * (F ** -0.5)),
        }
    _B_in = _B_setup()

    return {
        "A_x": _A_in["x"],
        "A_wqkv": _A_in["wqkv"],
        "A_wo": _A_in["wo"],
        "B_x": _B_in["x"],
        "B_w1": _B_in["w1"],
        "B_w2": _B_in["w2"],
    }

def reference(A_x, A_wqkv, A_wo, B_x, B_w1, B_w2):
    def _A_ref(x, wqkv, wo):
        B, S, D = x.shape
        H = 32
        Dh = D // H
        qkv = (lambda x, *d: x.permute(*d))((x @ wqkv).reshape(B, S, 3, H, Dh), 2, 0, 3, 1, 4)
        q, k, v = qkv[0], qkv[1], qkv[2]
        scores = torch.einsum("bhqd,bhkd->bhqk", q, k) * (Dh ** -0.5)
        p = _softmax(scores, axis=-1)
        o = torch.einsum("bhqk,bhkd->bhqd", p, v)
        return (lambda x, *d: x.permute(*d))(o, 0, 2, 1, 3).reshape(B, S, D) @ wo

    def _B_ref(x, w1, w2):
        h = torch.einsum("bsd,df->bsf", x, w1)
        h = _silu(h)
        out = torch.einsum("bsf,fd->bsd", h, w2)
        return out

    x = A_x
    x = x + _A_ref(_layernorm(x, axis=-1), A_wqkv, A_wo)
    x = x + _B_ref(_layernorm(x, axis=-1), B_w1, B_w2)
    x = x + _A_ref(_layernorm(x, axis=-1), A_wqkv, A_wo)
    x = x + _B_ref(_layernorm(x, axis=-1), B_w1, B_w2)
    return x
```

```asm
; @launch kernel=prep_kernel grid=(462,1,1) block=(256,1,1) lds=28672
; @launch kernel=qkv_kernel grid=(224,1,1) block=(512,1,1) lds=147456
; @launch kernel=attn1_kernel grid=(256,1,1) block=(576,1,1) lds=163840
; @launch kernel=chain1_kernel grid=(256,1,1) block=(512,1,1) lds=163840
; @launch kernel=attn2_kernel grid=(256,1,1) block=(576,1,1) lds=163840
; @launch kernel=chain2_kernel grid=(256,1,1) block=(512,1,1) lds=163840
.amdgcn_target "amdgcn-amd-amdhsa--gfx950"
.text
.globl prep_kernel
.p2align 8
.type prep_kernel,@function
prep_kernel:
  s_cmp_ge_u32 s2, 462
  s_cbranch_scc1 END_prep_ker_1
  s_getpc_b64 s[84:85]
PC_prep_ker_2:
  s_mov_b32 s88, s84
  s_and_b32 s89, s85, 0xffff
  s_mov_b32 s90, prep_kernel_codeend-PC_prep_ker_2
  s_mov_b32 s91, 0x20000
  v_lshlrev_b32 v10, 4, v0
  buffer_load_dwordx4 v[76:79], v10, s[88:91], 0 offen
  s_mov_b32 s86, 4096
  buffer_load_dwordx4 v[80:83], v10, s[88:91], s86 offen
  s_load_dwordx4 s[36:39], s[0:1], 0
  s_load_dwordx2 s[40:41], s[0:1], 16
  s_load_dwordx4 s[44:47], s[0:1], 32
  s_load_dwordx2 s[4:5], s[0:1], 64
  v_and_b32 v1, 63, v0
  v_and_b32 v2, 31, v0
  v_bfe_u32 v3, v0, 5, 1
  v_lshrrev_b32 v6, 6, v0
  s_nop 0
  v_readfirstlane_b32 s20, v6
  s_waitcnt lgkmcnt(0)
  s_mov_b32 s8, s4
  s_and_b32 s9, s5, 65535
  s_mov_b32 s10, 0x10000000
  s_mov_b32 s11, 0x20000
  s_cmp_ge_u32 s2, 256
  s_cbranch_scc1 W_prep_ker_6
  s_mov_b32 s12, s36
  s_and_b32 s13, s37, 65535
  s_mov_b32 s14, 0x240000
  s_mov_b32 s15, 0x20000
  s_mov_b32 s3, s2
  s_cmp_eq_u32 s20, 3
  s_cbranch_scc1 B3_prep_ker_7
  v_and_b32 v1, 7, v0
  v_lshrrev_b32 v2, 3, v0
  s_lshr_b32 s20, s3, 2
  s_and_b32 s21, s3, 3
  s_lshl_b32 s21, s21, 3
  s_mul_i32 s22, s20, 36864
  s_lshl_b32 s23, s21, 4
  s_add_u32 s22, s22, s23
  v_lshlrev_b32 v3, 9, v2
  v_lshl_add_u32 v3, v1, 4, v3
  s_lshl_b32 s24, s3, 3
  v_add_u32 v4, s24, v1
  v_mul_u32_u24 v4, 1152, v4
  v_lshl_add_u32 v4, v2, 4, v4
  v_add_u32 v7, 12288, v3
  v_add_u32 v6, 384, v4
  v_add_u32 v9, 24576, v3
  v_add_u32 v8, 768, v4
  buffer_load_dwordx4 v[16:19], v4, s[12:15], 0 offen
  buffer_load_dwordx4 v[20:23], v6, s[12:15], 0 offen
  buffer_load_dwordx4 v[24:27], v8, s[12:15], 0 offen
  s_waitcnt vmcnt(2)
  v_lshlrev_b32 v28, 16, v16
  v_and_b32 v29, 0xffff0000, v16
  v_lshlrev_b32 v30, 16, v17
  v_and_b32 v31, 0xffff0000, v17
  v_lshlrev_b32 v32, 16, v18
  v_and_b32 v33, 0xffff0000, v18
  v_lshlrev_b32 v34, 16, v19
  v_and_b32 v35, 0xffff0000, v19
  s_waitcnt vmcnt(1)
  v_lshlrev_b32 v36, 16, v20
  v_and_b32 v37, 0xffff0000, v20
  v_lshlrev_b32 v38, 16, v21
  v_and_b32 v39, 0xffff0000, v21
  v_lshlrev_b32 v40, 16, v22
  v_and_b32 v41, 0xffff0000, v22
  v_lshlrev_b32 v42, 16, v23
  v_and_b32 v43, 0xffff0000, v23
  s_waitcnt vmcnt(0)
  v_lshlrev_b32 v44, 16, v24
  v_and_b32 v45, 0xffff0000, v24
  v_lshlrev_b32 v46, 16, v25
  v_and_b32 v47, 0xffff0000, v25
  v_lshlrev_b32 v48, 16, v26
  v_and_b32 v49, 0xffff0000, v26
  v_lshlrev_b32 v50, 16, v27
  v_and_b32 v51, 0xffff0000, v27
  s_add_u32 s25, s22, 13676544
  buffer_store_dwordx4 v[16:19], v3, s[8:11], s25 offen sc1
  buffer_store_dwordx4 v[20:23], v7, s[8:11], s25 offen sc1
  buffer_store_dwordx4 v[24:27], v9, s[8:11], s25 offen sc1
  v_add_f32 v76, v28, v29
  v_mul_f32 v77, v28, v28
  v_fmac_f32 v77, v29, v29
  v_add_f32 v76, v76, v30
  v_fmac_f32 v77, v30, v30
  v_add_f32 v76, v76, v31
  v_fmac_f32 v77, v31, v31
  v_add_f32 v76, v76, v32
  v_fmac_f32 v77, v32, v32
  v_add_f32 v76, v76, v33
  v_fmac_f32 v77, v33, v33
  v_add_f32 v76, v76, v34
  v_fmac_f32 v77, v34, v34
  v_add_f32 v76, v76, v35
  v_fmac_f32 v77, v35, v35
  v_add_f32 v76, v76, v36
  v_fmac_f32 v77, v36, v36
  v_add_f32 v76, v76, v37
  v_fmac_f32 v77, v37, v37
  v_add_f32 v76, v76, v38
  v_fmac_f32 v77, v38, v38
  v_add_f32 v76, v76, v39
  v_fmac_f32 v77, v39, v39
  v_add_f32 v76, v76, v40
  v_fmac_f32 v77, v40, v40
  v_add_f32 v76, v76, v41
  v_fmac_f32 v77, v41, v41
  v_add_f32 v76, v76, v42
  v_fmac_f32 v77, v42, v42
  v_add_f32 v76, v76, v43
  v_fmac_f32 v77, v43, v43
  v_add_f32 v76, v76, v44
  v_fmac_f32 v77, v44, v44
  v_add_f32 v76, v76, v45
  v_fmac_f32 v77, v45, v45
  v_add_f32 v76, v76, v46
  v_fmac_f32 v77, v46, v46
  v_add_f32 v76, v76, v47
  v_fmac_f32 v77, v47, v47
  v_add_f32 v76, v76, v48
  v_fmac_f32 v77, v48, v48
  v_add_f32 v76, v76, v49
  v_fmac_f32 v77, v49, v49
  v_add_f32 v76, v76, v50
  v_fmac_f32 v77, v50, v50
  v_add_f32 v76, v76, v51
  v_fmac_f32 v77, v51, v51
  s_nop 0
  v_add_f32_dpp v76, v76, v76 row_ror:8 row_mask:0xf bank_mask:0xf
  v_add_f32_dpp v77, v77, v77 row_ror:8 row_mask:0xf bank_mask:0xf
  v_mov_b32 v78, v76
  s_nop 1
  v_permlane16_swap_b32 v78, v76
  v_add_f32 v76, v76, v78
  v_mov_b32 v78, v77
  s_nop 1
  v_permlane16_swap_b32 v78, v77
  v_add_f32 v77, v77, v78
  v_mov_b32 v78, v76
  s_nop 1
  v_permlane32_swap_b32 v78, v76
  v_add_f32 v76, v76, v78
  v_mov_b32 v78, v77
  s_nop 1
  v_permlane32_swap_b32 v78, v77
  v_add_f32 v77, v77, v78
  v_lshrrev_b32 v78, 6, v0
  v_lshlrev_b32 v78, 3, v78
  v_mul_u32_u24 v79, 80, v1
  v_add_u32 v78, v78, v79
  ds_write_b64 v78, v[76:77]
  s_waitcnt lgkmcnt(0)
  s_barrier
  ds_read_b64 v[80:81], v79 offset:0
  ds_read_b64 v[82:83], v79 offset:8
  ds_read_b64 v[84:85], v79 offset:16
  s_waitcnt lgkmcnt(1)
  v_add_f32 v76, v80, v82
  v_add_f32 v77, v81, v83
  s_waitcnt lgkmcnt(0)
  v_add_f32 v76, v76, v84
  v_add_f32 v77, v77, v85
  v_mul_f32 v76, 0x3ae38e39, v76
  v_mul_f32 v77, 0x3ae38e39, v77
  v_fma_f32 v77, -v76, v76, v77
  v_max_f32 v77, 0, v77
  v_cvt_pk_bf16_f32 v77, v77, v77
  v_and_b32 v77, 0xffff0000, v77
  v_add_f32 v77, 0x3727c5ac, v77
  v_cvt_pk_bf16_f32 v77, v77, v77
  v_and_b32 v77, 0xffff0000, v77
  v_sqrt_f32 v77, v77
  s_nop 0
  v_cvt_pk_bf16_f32 v77, v77, v77
  v_and_b32 v77, 0xffff0000, v77
  v_rcp_f32 v77, v77
  v_cvt_pk_bf16_f32 v76, v76, v76
  v_and_b32 v76, 0xffff0000, v76
  v_sub_f32 v28, v28, v76
  v_sub_f32 v29, v29, v76
  v_sub_f32 v30, v30, v76
  v_sub_f32 v31, v31, v76
  v_sub_f32 v32, v32, v76
  v_sub_f32 v33, v33, v76
  v_sub_f32 v34, v34, v76
  v_sub_f32 v35, v35, v76
  v_sub_f32 v36, v36, v76
  v_sub_f32 v37, v37, v76
  v_sub_f32 v38, v38, v76
  v_sub_f32 v39, v39, v76
  v_sub_f32 v40, v40, v76
  v_sub_f32 v41, v41, v76
  v_sub_f32 v42, v42, v76
  v_sub_f32 v43, v43, v76
  v_sub_f32 v44, v44, v76
  v_sub_f32 v45, v45, v76
  v_sub_f32 v46, v46, v76
  v_sub_f32 v47, v47, v76
  v_sub_f32 v48, v48, v76
  v_sub_f32 v49, v49, v76
  v_sub_f32 v50, v50, v76
  v_sub_f32 v51, v51, v76
  v_cvt_pk_bf16_f32 v16, v28, v29
  v_cvt_pk_bf16_f32 v17, v30, v31
  v_cvt_pk_bf16_f32 v18, v32, v33
  v_cvt_pk_bf16_f32 v19, v34, v35
  v_cvt_pk_bf16_f32 v20, v36, v37
  v_cvt_pk_bf16_f32 v21, v38, v39
  v_cvt_pk_bf16_f32 v22, v40, v41
  v_cvt_pk_bf16_f32 v23, v42, v43
  v_cvt_pk_bf16_f32 v24, v44, v45
  v_cvt_pk_bf16_f32 v25, v46, v47
  v_cvt_pk_bf16_f32 v26, v48, v49
  v_cvt_pk_bf16_f32 v27, v50, v51
  v_lshlrev_b32 v28, 16, v16
  v_and_b32 v29, 0xffff0000, v16
  v_lshlrev_b32 v30, 16, v17
  v_and_b32 v31, 0xffff0000, v17
  v_lshlrev_b32 v32, 16, v18
  v_and_b32 v33, 0xffff0000, v18
  v_lshlrev_b32 v34, 16, v19
  v_and_b32 v35, 0xffff0000, v19
  v_lshlrev_b32 v36, 16, v20
  v_and_b32 v37, 0xffff0000, v20
  v_lshlrev_b32 v38, 16, v21
  v_and_b32 v39, 0xffff0000, v21
  v_lshlrev_b32 v40, 16, v22
  v_and_b32 v41, 0xffff0000, v22
  v_lshlrev_b32 v42, 16, v23
  v_and_b32 v43, 0xffff0000, v23
  v_lshlrev_b32 v44, 16, v24
  v_and_b32 v45, 0xffff0000, v24
  v_lshlrev_b32 v46, 16, v25
  v_and_b32 v47, 0xffff0000, v25
  v_lshlrev_b32 v48, 16, v26
  v_and_b32 v49, 0xffff0000, v26
  v_lshlrev_b32 v50, 16, v27
  v_and_b32 v51, 0xffff0000, v27
  v_mul_f32 v28, v28, v77
  v_mul_f32 v29, v29, v77
  v_mul_f32 v30, v30, v77
  v_mul_f32 v31, v31, v77
  v_mul_f32 v32, v32, v77
  v_mul_f32 v33, v33, v77
  v_mul_f32 v34, v34, v77
  v_mul_f32 v35, v35, v77
  v_mul_f32 v36, v36, v77
  v_mul_f32 v37, v37, v77
  v_mul_f32 v38, v38, v77
  v_mul_f32 v39, v39, v77
  v_mul_f32 v40, v40, v77
  v_mul_f32 v41, v41, v77
  v_mul_f32 v42, v42, v77
  v_mul_f32 v43, v43, v77
  v_mul_f32 v44, v44, v77
  v_mul_f32 v45, v45, v77
  v_mul_f32 v46, v46, v77
  v_mul_f32 v47, v47, v77
  v_mul_f32 v48, v48, v77
  v_mul_f32 v49, v49, v77
  v_mul_f32 v50, v50, v77
  v_mul_f32 v51, v51, v77
  v_cvt_pk_bf16_f32 v16, v28, v29
  v_cvt_pk_bf16_f32 v17, v30, v31
  v_cvt_pk_bf16_f32 v18, v32, v33
  v_cvt_pk_bf16_f32 v19, v34, v35
  v_cvt_pk_bf16_f32 v20, v36, v37
  v_cvt_pk_bf16_f32 v21, v38, v39
  v_cvt_pk_bf16_f32 v22, v40, v41
  v_cvt_pk_bf16_f32 v23, v42, v43
  v_cvt_pk_bf16_f32 v24, v44, v45
  v_cvt_pk_bf16_f32 v25, v46, v47
  v_cvt_pk_bf16_f32 v26, v48, v49
  v_cvt_pk_bf16_f32 v27, v50, v51
  s_add_u32 s25, s22, 16035840
  buffer_store_dwordx4 v[16:19], v3, s[8:11], s25 offen sc1
  buffer_store_dwordx4 v[20:23], v7, s[8:11], s25 offen sc1
  buffer_store_dwordx4 v[24:27], v9, s[8:11], s25 offen sc1
  s_endpgm
B3_prep_ker_7:
  s_barrier
  s_endpgm
W_prep_ker_6:
  s_sub_u32 s2, s2, 256
  s_cmp_ge_u32 s2, 174
  s_cbranch_scc1 O_prep_ker_5
  s_cmp_ge_u32 s2, 102
  s_cbranch_scc1 G_prep_ker_4
  s_mov_b32 s56, 0
  s_mov_b32 s57, 0
  s_mov_b32 s58, 12
  s_mov_b32 s55, 1
  s_cmp_ge_u32 s2, 75
  s_cbranch_scc1 TWO_prep_ker_11
  s_cmp_ge_u32 s2, 27
  s_cbranch_scc1 TQK_prep_ker_10
  s_branch TV_prep_ker_9
TV_prep_ker_9:
  s_mov_b32 s21, s2
  s_mul_i32 s22, s21, 21846
  s_lshr_b32 s22, s22, 16
  s_mul_i32 s23, s22, 3
  s_sub_u32 s23, s21, s23
  s_lshl_b32 s26, s22, 1
  s_add_u32 s26, s26, 36
  s_lshr_b32 s24, s26, 2
  s_mul_i32 s52, s24, 147456
  s_and_b32 s25, s26, 3
  s_lshl_b32 s25, s25, 10
  s_add_u32 s52, s52, s25
  s_mul_i32 s24, s23, 49152
  s_add_u32 s52, s52, s24
  s_add_u32 s52, s52, 0
  s_mov_b32 s53, 1024
  s_mov_b32 s54, 4096
  s_mov_b32 s55, 0
  s_mov_b32 s12, s38
  s_and_b32 s13, s39, 65535
  s_mov_b32 s14, 0x1e6000
  s_mov_b32 s15, 0x20000
  s_mov_b32 s50, 3456
  s_mul_i32 s51, s23, 663552
  s_lshl_b32 s24, s22, 7
  s_add_u32 s51, s51, s24
  s_add_u32 s51, s51, 2304
  s_branch TGO_prep_ker_12
TQK_prep_ker_10:
  s_sub_u32 s21, s2, 27
  s_mul_i32 s22, s21, 21846
  s_lshr_b32 s22, s22, 16
  s_mul_i32 s23, s22, 3
  s_sub_u32 s23, s21, s23
  s_lshl_b32 s26, s22, 1
  s_lshr_b32 s24, s26, 2
  s_mul_i32 s52, s24, 147456
  s_and_b32 s25, s26, 3
  s_lshl_b32 s25, s25, 10
  s_add_u32 s52, s52, s25
  s_mul_i32 s24, s23, 49152
  s_add_u32 s52, s52, s24
  s_add_u32 s52, s52, 0
  s_mov_b32 s53, 1024
  s_mov_b32 s54, 4096
  s_mov_b32 s55, 0
  s_mov_b32 s12, s38
  s_and_b32 s13, s39, 65535
  s_mov_b32 s14, 0x1e6000
  s_mov_b32 s15, 0x20000
  s_mov_b32 s50, 3456
  s_mul_i32 s51, s23, 663552
  s_lshr_b32 s24, s22, 3
  s_mul_i32 s24, s24, 1152
  s_and_b32 s25, s22, 7
  s_mul_i32 s25, s25, 144
  s_add_u32 s51, s51, s24
  s_add_u32 s51, s51, s25
  s_mov_b32 s57, 1
  s_branch TGO_prep_ker_12
TWO_prep_ker_11:
  s_sub_u32 s21, s2, 75
  s_mul_i32 s22, s21, 21846
  s_lshr_b32 s22, s22, 16
  s_mul_i32 s23, s22, 3
  s_sub_u32 s23, s21, s23
  s_mov_b32 s12, s40
  s_and_b32 s13, s41, 65535
  s_mov_b32 s14, 0xa2000
  s_mov_b32 s15, 0x20000
  s_mov_b32 s50, 1152
  s_mul_i32 s51, s23, 248832
  s_lshl_b32 s24, s22, 7
  s_add_u32 s51, s51, s24
  s_mul_i32 s52, s22, 73728
  s_mul_i32 s24, s23, 24576
  s_add_u32 s52, s52, s24
  s_add_u32 s52, s52, 2064384
  s_mov_b32 s53, 1024
  s_mov_b32 s54, 2048
  s_mov_b32 s56, 1
  s_cmp_eq_u32 s23, 2
  s_cselect_b32 s58, 8, 12
TGO_prep_ker_12:
  v_lshrrev_b32 v6, 3, v1
  v_mul_lo_u32 v6, v6, s50
  v_and_b32 v5, 7, v1
  v_lshlrev_b32 v4, 4, v5
  v_lshrrev_b32 v8, 2, v5
  v_mul_u32_u24 v8, 72, v8
  v_and_b32 v7, 1, v5
  v_lshl_add_u32 v8, v7, 4, v8
  v_bfe_u32 v7, v5, 1, 1
  v_mul_u32_u24 v7, 36, v7
  v_add_u32 v8, v8, v7
  s_cmp_eq_u32 s57, 1
  s_cselect_b64 s[30:31], -1, 0
  v_cndmask_b32 v4, v4, v8, s[30:31]
  v_add_u32 v5, v4, v6
  s_add_u32 s59, s56, 6
  s_mul_i32 s24, s20, s59
  s_lshl_b32 s25, s24, 10
  s_lshl_b32 s24, s24, 3
  s_mul_i32 s24, s24, s50
  s_add_u32 s24, s24, s51
  s_lshl_b32 s26, s50, 3
  s_mov_b32 m0, s25
  s_nop 0
  buffer_load_dwordx4 v5, s[12:15], s24 offen lds
  s_add_u32 s24, s24, s26
  s_add_u32 s25, s25, 1024
  s_mov_b32 m0, s25
  s_nop 0
  buffer_load_dwordx4 v5, s[12:15], s24 offen lds
  s_add_u32 s24, s24, s26
  s_add_u32 s25, s25, 1024
  s_mov_b32 m0, s25
  s_nop 0
  buffer_load_dwordx4 v5, s[12:15], s24 offen lds
  s_add_u32 s24, s24, s26
  s_add_u32 s25, s25, 1024
  s_mov_b32 m0, s25
  s_nop 0
  buffer_load_dwordx4 v5, s[12:15], s24 offen lds
  s_add_u32 s24, s24, s26
  s_add_u32 s25, s25, 1024
  s_mov_b32 m0, s25
  s_nop 0
  buffer_load_dwordx4 v5, s[12:15], s24 offen lds
  s_add_u32 s24, s24, s26
  s_add_u32 s25, s25, 1024
  s_mov_b32 m0, s25
  s_nop 0
  buffer_load_dwordx4 v5, s[12:15], s24 offen lds
  s_add_u32 s24, s24, s26
  s_add_u32 s25, s25, 1024
  s_cmp_eq_u32 s56, 0
  s_cbranch_scc1 SK_prep_ker_14
  s_mov_b32 m0, s25
  s_nop 0
  buffer_load_dwordx4 v5, s[12:15], s24 offen lds
  s_add_u32 s24, s24, s26
  s_add_u32 s25, s25, 1024
SK_prep_ker_14:
  v_and_b32 v6, 3, v1
  v_and_b32 v4, 1, v6
  v_lshlrev_b32 v4, 1, v4
  v_lshrrev_b32 v8, 1, v6
  v_or_b32 v4, v4, v8
  s_cmp_eq_u32 s55, 1
  s_cselect_b64 s[30:31], -1, 0
  v_cndmask_b32 v4, v6, v4, s[30:31]
  v_lshlrev_b32 v4, 3, v4
  v_bfe_u32 v6, v1, 4, 1
  v_lshl_add_u32 v4, v6, 5, v4
  v_bfe_u32 v6, v1, 2, 2
  s_sub_u32 s27, 3, s56
  v_lshlrev_b32 v7, s27, v3
  v_add_u32 v6, v6, v7
  v_lshl_add_u32 v8, v6, 7, v4
  s_waitcnt vmcnt(0)
  s_barrier
  v_lshlrev_b32 v5, 4, v1
  s_lshr_b32 s24, s20, 1
  s_and_b32 s25, s20, 1
  s_mul_i32 s25, s25, 6
  s_lshl_b32 s26, s24, 6
  s_mul_i32 s28, s56, 256
  s_add_u32 s28, s28, 2048
  s_mul_i32 s27, s25, s28
  s_add_u32 s26, s26, s27
  v_add_u32 v8, s26, v8
  s_mul_i32 s26, s24, s53
  s_mul_i32 s27, s25, s54
  s_add_u32 s26, s26, s27
  s_add_u32 s26, s26, s52
  s_cmp_eq_u32 s56, 1
  s_cbranch_scc1 EL_prep_ker_15
  ds_read_b64_tr_b16 v[16:17], v8 offset:0
  ds_read_b64_tr_b16 v[18:19], v8 offset:512
  ds_read_b64_tr_b16 v[20:21], v8 offset:2048
  ds_read_b64_tr_b16 v[22:23], v8 offset:2560
  ds_read_b64_tr_b16 v[24:25], v8 offset:4096
  ds_read_b64_tr_b16 v[26:27], v8 offset:4608
  ds_read_b64_tr_b16 v[28:29], v8 offset:6144
  ds_read_b64_tr_b16 v[30:31], v8 offset:6656
  ds_read_b64_tr_b16 v[32:33], v8 offset:8192
  ds_read_b64_tr_b16 v[34:35], v8 offset:8704
  ds_read_b64_tr_b16 v[36:37], v8 offset:10240
  ds_read_b64_tr_b16 v[38:39], v8 offset:10752
  s_branch EN_prep_ker_16
EL_prep_ker_15:
  ds_read_b64_tr_b16 v[16:17], v8 offset:0
  ds_read_b64_tr_b16 v[18:19], v8 offset:1024
  ds_read_b64_tr_b16 v[20:21], v8 offset:2304
  ds_read_b64_tr_b16 v[22:23], v8 offset:3328
  ds_read_b64_tr_b16 v[24:25], v8 offset:4608
  ds_read_b64_tr_b16 v[26:27], v8 offset:5632
  ds_read_b64_tr_b16 v[28:29], v8 offset:6912
  ds_read_b64_tr_b16 v[30:31], v8 offset:7936
  ds_read_b64_tr_b16 v[32:33], v8 offset:9216
  ds_read_b64_tr_b16 v[34:35], v8 offset:10240
  ds_read_b64_tr_b16 v[36:37], v8 offset:11520
  ds_read_b64_tr_b16 v[38:39], v8 offset:12544
EN_prep_ker_16:
  s_waitcnt lgkmcnt(10)
  buffer_store_dwordx4 v[16:19], v5, s[8:11], s26 offen sc1
  s_add_u32 s26, s26, s54
  s_add_u32 s25, s25, 1
  s_cmp_ge_u32 s25, s58
  s_cbranch_scc1 END_prep_ker_1
  s_waitcnt lgkmcnt(8)
  buffer_store_dwordx4 v[20:23], v5, s[8:11], s26 offen sc1
  s_add_u32 s26, s26, s54
  s_add_u32 s25, s25, 1
  s_cmp_ge_u32 s25, s58
  s_cbranch_scc1 END_prep_ker_1
  s_waitcnt lgkmcnt(6)
  buffer_store_dwordx4 v[24:27], v5, s[8:11], s26 offen sc1
  s_add_u32 s26, s26, s54
  s_add_u32 s25, s25, 1
  s_cmp_ge_u32 s25, s58
  s_cbranch_scc1 END_prep_ker_1
  s_waitcnt lgkmcnt(4)
  buffer_store_dwordx4 v[28:31], v5, s[8:11], s26 offen sc1
  s_add_u32 s26, s26, s54
  s_add_u32 s25, s25, 1
  s_cmp_ge_u32 s25, s58
  s_cbranch_scc1 END_prep_ker_1
  s_waitcnt lgkmcnt(2)
  buffer_store_dwordx4 v[32:35], v5, s[8:11], s26 offen sc1
  s_add_u32 s26, s26, s54
  s_add_u32 s25, s25, 1
  s_cmp_ge_u32 s25, s58
  s_cbranch_scc1 END_prep_ker_1
  s_waitcnt lgkmcnt(0)
  buffer_store_dwordx4 v[36:39], v5, s[8:11], s26 offen sc1
  s_add_u32 s26, s26, s54
  s_endpgm
G_prep_ker_4:
  s_cmp_ge_u32 s20, 1
  s_cbranch_scc1 END_prep_ker_1
  s_sub_u32 s21, s2, 102
  s_cmp_ge_u32 s21, 48
  s_cbranch_scc1 WE_prep_ker_17
  s_mul_i32 s22, s21, 5462
  s_lshr_b32 s22, s22, 16
  s_mul_i32 s23, s22, 12
  s_sub_u32 s23, s21, s23
  s_mul_i32 s23, s23, 3
  s_mov_b32 s12, s38
  s_and_b32 s13, s39, 65535
  s_mov_b32 s14, 0x1e6000
  s_mov_b32 s15, 0x20000
  s_lshr_b32 s28, s22, 1
  s_mul_i32 s28, s28, 576
  s_and_b32 s27, s22, 1
  s_mul_i32 s27, s27, 288
  s_add_u32 s27, s27, s28
  s_add_u32 s27, s27, 16
  v_lshrrev_b32 v6, 1, v2
  v_mul_u32_u24 v6, 18, v6
  v_and_b32 v4, 1, v2
  v_add3_u32 v4, v4, v6, s27
  v_mul_u32_u24 v6, 27648, v3
  v_lshl_add_u32 v5, v4, 1, v6
  s_mul_i32 s56, s23, 55296
  buffer_load_ushort v32, v5, s[12:15], s56 offen
  s_add_u32 s56, s56, 3456
  buffer_load_ushort v33, v5, s[12:15], s56 offen
  s_add_u32 s56, s56, 3456
  buffer_load_ushort v34, v5, s[12:15], s56 offen
  s_add_u32 s56, s56, 3456
  buffer_load_ushort v35, v5, s[12:15], s56 offen
  s_add_u32 s56, s56, 3456
  buffer_load_ushort v36, v5, s[12:15], s56 offen
  s_add_u32 s56, s56, 3456
  buffer_load_ushort v37, v5, s[12:15], s56 offen
  s_add_u32 s56, s56, 3456
  buffer_load_ushort v38, v5, s[12:15], s56 offen
  s_add_u32 s56, s56, 3456
  buffer_load_ushort v39, v5, s[12:15], s56 offen
  s_add_u32 s56, s56, 31104
  buffer_load_ushort v40, v5, s[12:15], s56 offen
  s_add_u32 s56, s56, 3456
  buffer_load_ushort v41, v5, s[12:15], s56 offen
  s_add_u32 s56, s56, 3456
  buffer_load_ushort v42, v5, s[12:15], s56 offen
  s_add_u32 s56, s56, 3456
  buffer_load_ushort v43, v5, s[12:15], s56 offen
  s_add_u32 s56, s56, 3456
  buffer_load_ushort v44, v5, s[12:15], s56 offen
  s_add_u32 s56, s56, 3456
  buffer_load_ushort v45, v5, s[12:15], s56 offen
  s_add_u32 s56, s56, 3456
  buffer_load_ushort v46, v5, s[12:15], s56 offen
  s_add_u32 s56, s56, 3456
  buffer_load_ushort v47, v5, s[12:15], s56 offen
  s_add_u32 s56, s56, 31104
  buffer_load_ushort v48, v5, s[12:15], s56 offen
  s_add_u32 s56, s56, 3456
  buffer_load_ushort v49, v5, s[12:15], s56 offen
  s_add_u32 s56, s56, 3456
  buffer_load_ushort v50, v5, s[12:15], s56 offen
  s_add_u32 s56, s56, 3456
  buffer_load_ushort v51, v5, s[12:15], s56 offen
  s_add_u32 s56, s56, 3456
  buffer_load_ushort v52, v5, s[12:15], s56 offen
  s_add_u32 s56, s56, 3456
  buffer_load_ushort v53, v5, s[12:15], s56 offen
  s_add_u32 s56, s56, 3456
  buffer_load_ushort v54, v5, s[12:15], s56 offen
  s_add_u32 s56, s56, 3456
  buffer_load_ushort v55, v5, s[12:15], s56 offen
  s_add_u32 s56, s56, 31104
  s_lshl_b32 s51, s22, 10
  s_mul_i32 s24, s23, 4096
  s_add_u32 s51, s51, s24
  s_add_u32 s51, s51, 1179648
  s_mov_b32 s52, 4096
  s_branch ST_prep_ker_18
WE_prep_ker_17:
  s_sub_u32 s21, s21, 48
  s_mul_i32 s21, s21, 3
  s_mov_b32 s12, s40
  s_and_b32 s13, s41, 65535
  s_mov_b32 s14, 0xa2000
  s_mov_b32 s15, 0x20000
  v_and_b32 v7, 19, v2
  v_and_b32 v6, 4, v2
  v_lshl_or_b32 v7, v6, 1, v7
  v_and_b32 v6, 8, v2
  v_lshrrev_b32 v6, 1, v6
  v_or_b32 v7, v7, v6
  v_mul_u32_u24 v6, 82944, v3
  v_lshl_add_u32 v5, v7, 1, v6
  s_add_u32 s22, s21, 0
  s_lshr_b32 s23, s22, 2
  s_and_b32 s24, s22, 3
  s_mul_i32 s56, s24, 165888
  s_lshl_b32 s25, s23, 6
  s_add_u32 s56, s56, s25
  s_add_u32 s57, s56, 18432
  s_waitcnt vmcnt(23)
  buffer_load_ushort v32, v5, s[12:15], s57 offen
  s_add_u32 s57, s56, 19584
  s_waitcnt vmcnt(23)
  buffer_load_ushort v33, v5, s[12:15], s57 offen
  s_add_u32 s57, s56, 39168
  s_waitcnt vmcnt(23)
  buffer_load_ushort v34, v5, s[12:15], s57 offen
  s_add_u32 s57, s56, 40320
  s_waitcnt vmcnt(23)
  buffer_load_ushort v35, v5, s[12:15], s57 offen
  s_add_u32 s57, s56, 59904
  s_waitcnt vmcnt(23)
  buffer_load_ushort v36, v5, s[12:15], s57 offen
  s_add_u32 s57, s56, 61056
  s_waitcnt vmcnt(23)
  buffer_load_ushort v37, v5, s[12:15], s57 offen
  s_add_u32 s57, s56, 80640
  s_waitcnt vmcnt(23)
  buffer_load_ushort v38, v5, s[12:15], s57 offen
  s_add_u32 s57, s56, 81792
  s_waitcnt vmcnt(23)
  buffer_load_ushort v39, v5, s[12:15], s57 offen
  s_lshr_b32 s25, s23, 1
  s_mul_i32 s60, s25, 73728
  s_add_u32 s24, s24, 32
  s_lshl_b32 s24, s24, 11
  s_add_u32 s60, s60, s24
  s_and_b32 s25, s23, 1
  s_lshl_b32 s25, s25, 10
  s_add_u32 s60, s60, s25
  s_add_u32 s60, s60, 2064384
  s_add_u32 s22, s21, 1
  s_lshr_b32 s23, s22, 2
  s_and_b32 s24, s22, 3
  s_mul_i32 s56, s24, 165888
  s_lshl_b32 s25, s23, 6
  s_add_u32 s56, s56, s25
  s_add_u32 s57, s56, 18432
  s_waitcnt vmcnt(23)
  buffer_load_ushort v40, v5, s[12:15], s57 offen
  s_add_u32 s57, s56, 19584
  s_waitcnt vmcnt(23)
  buffer_load_ushort v41, v5, s[12:15], s57 offen
  s_add_u32 s57, s56, 39168
  s_waitcnt vmcnt(23)
  buffer_load_ushort v42, v5, s[12:15], s57 offen
  s_add_u32 s57, s56, 40320
  s_waitcnt vmcnt(23)
  buffer_load_ushort v43, v5, s[12:15], s57 offen
  s_add_u32 s57, s56, 59904
  s_waitcnt vmcnt(23)
  buffer_load_ushort v44, v5, s[12:15], s57 offen
  s_add_u32 s57, s56, 61056
  s_waitcnt vmcnt(23)
  buffer_load_ushort v45, v5, s[12:15], s57 offen
  s_add_u32 s57, s56, 80640
  s_waitcnt vmcnt(23)
  buffer_load_ushort v46, v5, s[12:15], s57 offen
  s_add_u32 s57, s56, 81792
  s_waitcnt vmcnt(23)
  buffer_load_ushort v47, v5, s[12:15], s57 offen
  s_lshr_b32 s25, s23, 1
  s_mul_i32 s61, s25, 73728
  s_add_u32 s24, s24, 32
  s_lshl_b32 s24, s24, 11
  s_add_u32 s61, s61, s24
  s_and_b32 s25, s23, 1
  s_lshl_b32 s25, s25, 10
  s_add_u32 s61, s61, s25
  s_add_u32 s61, s61, 2064384
  s_add_u32 s22, s21, 2
  s_lshr_b32 s23, s22, 2
  s_and_b32 s24, s22, 3
  s_mul_i32 s56, s24, 165888
  s_lshl_b32 s25, s23, 6
  s_add_u32 s56, s56, s25
  s_add_u32 s57, s56, 18432
  s_waitcnt vmcnt(23)
  buffer_load_ushort v48, v5, s[12:15], s57 offen
  s_add_u32 s57, s56, 19584
  s_waitcnt vmcnt(23)
  buffer_load_ushort v49, v5, s[12:15], s57 offen
  s_add_u32 s57, s56, 39168
  s_waitcnt vmcnt(23)
  buffer_load_ushort v50, v5, s[12:15], s57 offen
  s_add_u32 s57, s56, 40320
  s_waitcnt vmcnt(23)
  buffer_load_ushort v51, v5, s[12:15], s57 offen
  s_add_u32 s57, s56, 59904
  s_waitcnt vmcnt(23)
  buffer_load_ushort v52, v5, s[12:15], s57 offen
  s_add_u32 s57, s56, 61056
  s_waitcnt vmcnt(23)
  buffer_load_ushort v53, v5, s[12:15], s57 offen
  s_add_u32 s57, s56, 80640
  s_waitcnt vmcnt(23)
  buffer_load_ushort v54, v5, s[12:15], s57 offen
  s_add_u32 s57, s56, 81792
  s_waitcnt vmcnt(23)
  buffer_load_ushort v55, v5, s[12:15], s57 offen
  s_lshr_b32 s25, s23, 1
  s_mul_i32 s62, s25, 73728
  s_add_u32 s24, s24, 32
  s_lshl_b32 s24, s24, 11
  s_add_u32 s62, s62, s24
  s_and_b32 s25, s23, 1
  s_lshl_b32 s25, s25, 10
  s_add_u32 s62, s62, s25
  s_add_u32 s62, s62, 2064384
  s_waitcnt vmcnt(0)
  v_lshl_or_b32 v16, v33, 16, v32
  v_lshl_or_b32 v17, v35, 16, v34
  v_lshl_or_b32 v18, v37, 16, v36
  v_lshl_or_b32 v19, v39, 16, v38
  v_lshl_or_b32 v20, v41, 16, v40
  v_lshl_or_b32 v21, v43, 16, v42
  v_lshl_or_b32 v22, v45, 16, v44
  v_lshl_or_b32 v23, v47, 16, v46
  v_lshl_or_b32 v24, v49, 16, v48
  v_lshl_or_b32 v25, v51, 16, v50
  v_lshl_or_b32 v26, v53, 16, v52
  v_lshl_or_b32 v27, v55, 16, v54
  v_lshlrev_b32 v5, 4, v1
  buffer_store_dwordx4 v[16:19], v5, s[8:11], s60 offen sc1
  buffer_store_dwordx4 v[20:23], v5, s[8:11], s61 offen sc1
  buffer_store_dwordx4 v[24:27], v5, s[8:11], s62 offen sc1
  s_endpgm
ST_prep_ker_18:
  s_waitcnt vmcnt(0)
  v_lshl_or_b32 v16, v33, 16, v32
  v_lshl_or_b32 v17, v35, 16, v34
  v_lshl_or_b32 v18, v37, 16, v36
  v_lshl_or_b32 v19, v39, 16, v38
  v_lshl_or_b32 v20, v41, 16, v40
  v_lshl_or_b32 v21, v43, 16, v42
  v_lshl_or_b32 v22, v45, 16, v44
  v_lshl_or_b32 v23, v47, 16, v46
  v_lshl_or_b32 v24, v49, 16, v48
  v_lshl_or_b32 v25, v51, 16, v50
  v_lshl_or_b32 v26, v53, 16, v52
  v_lshl_or_b32 v27, v55, 16, v54
  v_lshlrev_b32 v5, 4, v1
  buffer_store_dwordx4 v[16:19], v5, s[8:11], s51 offen sc1
  s_add_u32 s51, s51, s52
  buffer_store_dwordx4 v[20:23], v5, s[8:11], s51 offen sc1
  s_add_u32 s51, s51, s52
  buffer_store_dwordx4 v[24:27], v5, s[8:11], s51 offen sc1
  s_add_u32 s51, s51, s52
  s_endpgm
O_prep_ker_5:
  s_sub_u32 s20, s2, 174
  s_mul_i32 s20, s20, 155648
  s_add_u32 s20, s20, 20754432
  v_cmp_gt_u32 vcc, 256, v0
  s_nop 3
  s_and_saveexec_b64 s[30:31], vcc
  s_cbranch_execz END_prep_ker_1
  v_lshrrev_b32 v1, 1, v0
  v_lshrrev_b32 v2, 4, v1
  v_mul_u32_u24 v2, 19456, v2
  v_and_b32 v1, 15, v1
  v_mul_u32_u24 v1, 640, v1
  v_and_b32 v3, 1, v0
  v_mul_u32_u24 v3, 320, v3
  v_add3_u32 v1, v1, v2, v3
  v_add_u32 v1, 9504, v1
  v_mov_b32 v4, 0x3f803f80
  v_mov_b32 v8, 0
  v_mov_b32 v5, 0x3f803f80
  v_mov_b32 v9, 0
  v_mov_b32 v6, 0x3f803f80
  v_mov_b32 v10, 0
  v_mov_b32 v7, 0x3f803f80
  v_mov_b32 v11, 0
  buffer_store_dwordx4 v[4:7], v1, s[8:11], s20 offen
  buffer_store_dwordx4 v[8:11], v1, s[8:11], s20 offen offset:16
  s_add_u32 s20, s20, 48267264
  buffer_store_dwordx4 v[4:7], v1, s[8:11], s20 offen
  buffer_store_dwordx4 v[8:11], v1, s[8:11], s20 offen offset:16
  s_sub_u32 s22, s2, 174
  s_lshl_b32 s22, s22, 11
  s_add_u32 s22, s22, 61878272
  v_lshlrev_b32 v12, 3, v0
  v_mov_b32 v14, 0
  v_mov_b32 v15, 0
  buffer_store_dwordx2 v[14:15], v12, s[8:11], s22 offen
  s_add_u32 s22, s22, 48267264
  buffer_store_dwordx2 v[14:15], v12, s[8:11], s22 offen
  s_sub_u32 s22, s2, 174
  s_mul_i32 s22, s22, 12288
  s_add_u32 s22, s22, 61485056
  v_lshlrev_b32 v12, 4, v0
  v_mov_b32 v16, 0
  v_mov_b32 v17, 0
  v_mov_b32 v18, 0
  v_mov_b32 v19, 0
  s_add_u32 s23, s22, 0
  buffer_store_dwordx4 v[16:19], v12, s[8:11], s23 offen
  s_add_u32 s23, s22, 4096
  buffer_store_dwordx4 v[16:19], v12, s[8:11], s23 offen
  s_add_u32 s23, s22, 8192
  buffer_store_dwordx4 v[16:19], v12, s[8:11], s23 offen
  s_add_u32 s23, s22, 48267264
  buffer_store_dwordx4 v[16:19], v12, s[8:11], s23 offen
  s_add_u32 s23, s22, 48271360
  buffer_store_dwordx4 v[16:19], v12, s[8:11], s23 offen
  s_add_u32 s23, s22, 48275456
  buffer_store_dwordx4 v[16:19], v12, s[8:11], s23 offen
  s_getpc_b64 s[40:41]
PF_HERE:
  s_sub_u32 s40, s40, PF_HERE-prep_kernel
  s_subb_u32 s41, s41, 0
  s_mov_b32 s44, s40
  s_and_b32 s45, s41, 0xffff
  s_mov_b32 s46, TEXT_END-prep_kernel
  s_mov_b32 s47, 0x20000
  s_sub_u32 s22, s2, 174
  s_lshl_b32 s22, s22, 12
  v_lshlrev_b32 v12, 4, v0
  buffer_load_dwordx4 v[16:19], v12, s[44:47], s22 offen
  s_waitcnt vmcnt(0)
END_prep_ker_1:
  s_endpgm
prep_kernel_codeend:

.globl qkv_kernel
.p2align 8
.type qkv_kernel,@function
qkv_kernel:
  s_cmp_ge_u32 s2, 224
  s_cbranch_scc1 END_qkv_kern_19
  s_load_dwordx2 s[4:5], s[0:1], 64
  s_getpc_b64 s[84:85]
PC_qkv_kern_20:
  s_mov_b32 s88, s84
  s_and_b32 s89, s85, 0xffff
  s_mov_b32 s90, qkv_kernel_codeend-PC_qkv_kern_20
  s_mov_b32 s91, 0x20000
  v_lshlrev_b32 v10, 4, v0
  buffer_load_dwordx4 v[140:143], v10, s[88:91], 0 offen
  v_lshrrev_b32 v1, 6, v0
  s_nop 0
  v_readfirstlane_b32 s20, v1
  v_and_b32 v1, 63, v0
  v_lshlrev_b32 v2, 4, v1
  s_nop 1
  s_lshr_b32 s19, s20, 2
  s_and_b32 s20, s20, 3
  v_lshrrev_b32 v5, 5, v1
  v_and_b32 v6, 31, v1
  s_and_b32 s21, s2, 7
  s_lshr_b32 s22, s2, 3
  s_and_b32 s23, s21, 3
  s_lshl_b32 s23, s23, 2
  s_and_b32 s24, s22, 3
  s_add_u32 s23, s23, s24
  s_lshr_b32 s24, s21, 2
  s_mul_i32 s24, s24, 7
  s_lshr_b32 s25, s22, 2
  s_add_u32 s24, s24, s25
  s_lshl_b32 s25, s23, 2
  s_add_u32 s25, s25, s20
  s_waitcnt lgkmcnt(0)
  s_mov_b32 s8, s4
  s_and_b32 s9, s5, 65535
  s_mov_b32 s10, 0x10000000
  s_mov_b32 s11, 0x20000
  s_mov_b32 s12, s4
  s_and_b32 s13, s5, 65535
  s_mov_b32 s14, 0x10000000
  s_mov_b32 s15, 0x20000
  s_mul_i32 s32, s25, 36864
  s_add_u32 s32, s32, 16035840
  s_mul_i32 s30, s24, 147456
  s_add_u32 s30, s30, 0
  s_mov_b32 s28, 18
  s_cmp_eq_u32 s19, 0
  s_cbranch_scc1 SK_qkv_kern_21
  s_mul_i32 s31, s20, 2048
  s_add_u32 s30, s30, s31
  s_mov_b32 s33, 0
  s_mul_i32 s35, s20, 2048
  s_add_u32 s35, s35, 8192
  s_mov_b32 s36, s28
  s_add_u32 s34, s33, s31
  s_mov_b32 m0, s34
  s_nop 0
  buffer_load_dwordx4 v2, s[12:15], s30 offen lds
  buffer_load_dwordx4 v2, s[12:15], s30 offen offset:1024 lds
  s_add_u32 s30, s30, 8192
  s_add_u32 s34, s33, s35
  s_mov_b32 m0, s34
  s_nop 0
  buffer_load_dwordx4 v2, s[12:15], s32 offen lds
  buffer_load_dwordx4 v2, s[12:15], s32 offen offset:1024 lds
  s_add_u32 s32, s32, 2048
  s_add_u32 s33, s33, 16384
  s_cmp_ge_u32 s33, 147456
  s_cselect_b32 s33, 0, s33
  s_sub_u32 s36, s36, 1
  s_cmp_eq_u32 s36, 0
  s_cselect_b32 s14, 0, s14
  s_add_u32 s34, s33, s31
  s_mov_b32 m0, s34
  s_nop 0
  buffer_load_dwordx4 v2, s[12:15], s30 offen lds
  buffer_load_dwordx4 v2, s[12:15], s30 offen offset:1024 lds
  s_add_u32 s30, s30, 8192
  s_add_u32 s34, s33, s35
  s_mov_b32 m0, s34
  s_nop 0
  buffer_load_dwordx4 v2, s[12:15], s32 offen lds
  buffer_load_dwordx4 v2, s[12:15], s32 offen offset:1024 lds
  s_add_u32 s32, s32, 2048
  s_add_u32 s33, s33, 16384
  s_cmp_ge_u32 s33, 147456
  s_cselect_b32 s33, 0, s33
  s_sub_u32 s36, s36, 1
  s_cmp_eq_u32 s36, 0
  s_cselect_b32 s14, 0, s14
  s_add_u32 s34, s33, s31
  s_mov_b32 m0, s34
  s_nop 0
  buffer_load_dwordx4 v2, s[12:15], s30 offen lds
  buffer_load_dwordx4 v2, s[12:15], s30 offen offset:1024 lds
  s_add_u32 s30, s30, 8192
  s_add_u32 s34, s33, s35
  s_mov_b32 m0, s34
  s_nop 0
  buffer_load_dwordx4 v2, s[12:15], s32 offen lds
  buffer_load_dwordx4 v2, s[12:15], s32 offen offset:1024 lds
  s_add_u32 s32, s32, 2048
  s_add_u32 s33, s33, 16384
  s_cmp_ge_u32 s33, 147456
  s_cselect_b32 s33, 0, s33
  s_sub_u32 s36, s36, 1
  s_cmp_eq_u32 s36, 0
  s_cselect_b32 s14, 0, s14
  s_add_u32 s34, s33, s31
  s_mov_b32 m0, s34
  s_nop 0
  buffer_load_dwordx4 v2, s[12:15], s30 offen lds
  buffer_load_dwordx4 v2, s[12:15], s30 offen offset:1024 lds
  s_add_u32 s30, s30, 8192
  s_add_u32 s34, s33, s35
  s_mov_b32 m0, s34
  s_nop 0
  buffer_load_dwordx4 v2, s[12:15], s32 offen lds
  buffer_load_dwordx4 v2, s[12:15], s32 offen offset:1024 lds
  s_add_u32 s32, s32, 2048
  s_add_u32 s33, s33, 16384
  s_cmp_ge_u32 s33, 147456
  s_cselect_b32 s33, 0, s33
  s_sub_u32 s36, s36, 1
  s_cmp_eq_u32 s36, 0
  s_cselect_b32 s14, 0, s14
  s_add_u32 s34, s33, s31
  s_mov_b32 m0, s34
  s_nop 0
  buffer_load_dwordx4 v2, s[12:15], s30 offen lds
  buffer_load_dwordx4 v2, s[12:15], s30 offen offset:1024 lds
  s_add_u32 s30, s30, 8192
  s_add_u32 s34, s33, s35
  s_mov_b32 m0, s34
  s_nop 0
  buffer_load_dwordx4 v2, s[12:15], s32 offen lds
  buffer_load_dwordx4 v2, s[12:15], s32 offen offset:1024 lds
  s_add_u32 s32, s32, 2048
  s_add_u32 s33, s33, 16384
  s_cmp_ge_u32 s33, 147456
  s_cselect_b32 s33, 0, s33
  s_sub_u32 s36, s36, 1
  s_cmp_eq_u32 s36, 0
  s_cselect_b32 s14, 0, s14
  s_add_u32 s34, s33, s31
  s_mov_b32 m0, s34
  s_nop 0
  buffer_load_dwordx4 v2, s[12:15], s30 offen lds
  buffer_load_dwordx4 v2, s[12:15], s30 offen offset:1024 lds
  s_add_u32 s30, s30, 8192
  s_add_u32 s34, s33, s35
  s_mov_b32 m0, s34
  s_nop 0
  buffer_load_dwordx4 v2, s[12:15], s32 offen lds
  buffer_load_dwordx4 v2, s[12:15], s32 offen offset:1024 lds
  s_add_u32 s32, s32, 2048
  s_add_u32 s33, s33, 16384
  s_cmp_ge_u32 s33, 147456
  s_cselect_b32 s33, 0, s33
  s_sub_u32 s36, s36, 1
  s_cmp_eq_u32 s36, 0
  s_cselect_b32 s14, 0, s14
  s_add_u32 s34, s33, s31
  s_mov_b32 m0, s34
  s_nop 0
  buffer_load_dwordx4 v2, s[12:15], s30 offen lds
  buffer_load_dwordx4 v2, s[12:15], s30 offen offset:1024 lds
  s_add_u32 s30, s30, 8192
  s_add_u32 s34, s33, s35
  s_mov_b32 m0, s34
  s_nop 0
  buffer_load_dwordx4 v2, s[12:15], s32 offen lds
  buffer_load_dwordx4 v2, s[12:15], s32 offen offset:1024 lds
  s_add_u32 s32, s32, 2048
  s_add_u32 s33, s33, 16384
  s_cmp_ge_u32 s33, 147456
  s_cselect_b32 s33, 0, s33
  s_sub_u32 s36, s36, 1
  s_cmp_eq_u32 s36, 0
  s_cselect_b32 s14, 0, s14
  s_add_u32 s34, s33, s31
  s_mov_b32 m0, s34
  s_nop 0
  buffer_load_dwordx4 v2, s[12:15], s30 offen lds
  buffer_load_dwordx4 v2, s[12:15], s30 offen offset:1024 lds
  s_add_u32 s30, s30, 8192
  s_add_u32 s34, s33, s35
  s_mov_b32 m0, s34
  s_nop 0
  buffer_load_dwordx4 v2, s[12:15], s32 offen lds
  buffer_load_dwordx4 v2, s[12:15], s32 offen offset:1024 lds
  s_add_u32 s32, s32, 2048
  s_add_u32 s33, s33, 16384
  s_cmp_ge_u32 s33, 147456
  s_cselect_b32 s33, 0, s33
  s_sub_u32 s36, s36, 1
  s_cmp_eq_u32 s36, 0
  s_cselect_b32 s14, 0, s14
  s_waitcnt vmcnt(28)
  s_barrier
LL_qkv_kern_22:
  s_waitcnt vmcnt(24)
  s_barrier
  s_add_u32 s34, s33, s31
  s_mov_b32 m0, s34
  s_nop 0
  buffer_load_dwordx4 v2, s[12:15], s30 offen lds
  buffer_load_dwordx4 v2, s[12:15], s30 offen offset:1024 lds
  s_add_u32 s30, s30, 8192
  s_add_u32 s34, s33, s35
  s_mov_b32 m0, s34
  s_nop 0
  buffer_load_dwordx4 v2, s[12:15], s32 offen lds
  buffer_load_dwordx4 v2, s[12:15], s32 offen offset:1024 lds
  s_add_u32 s32, s32, 2048
  s_add_u32 s33, s33, 16384
  s_cmp_ge_u32 s33, 147456
  s_cselect_b32 s33, 0, s33
  s_sub_u32 s36, s36, 1
  s_cmp_eq_u32 s36, 0
  s_cselect_b32 s14, 0, s14
  s_sub_u32 s28, s28, 1
  s_cmp_lg_u32 s28, 0
  s_cbranch_scc1 LL_qkv_kern_22
  s_endpgm
SK_qkv_kern_21:
  s_setprio 1
  s_cmp_ge_u32 s24, 9
  s_cbranch_scc1 EL_qkv_kern_23
  s_mul_i32 s35, s20, 2048
  s_add_u32 s35, s35, 8192
  s_mov_b32 s40, 0
  v_mov_b32 v16, 0
  v_mov_b32 v17, 0
  v_mov_b32 v18, 0
  v_mov_b32 v19, 0
  v_mov_b32 v20, 0
  v_mov_b32 v21, 0
  v_mov_b32 v22, 0
  v_mov_b32 v23, 0
  v_mov_b32 v24, 0
  v_mov_b32 v25, 0
  v_mov_b32 v26, 0
  v_mov_b32 v27, 0
  v_mov_b32 v28, 0
  v_mov_b32 v29, 0
  v_mov_b32 v30, 0
  v_mov_b32 v31, 0
  v_mov_b32 v32, 0
  v_mov_b32 v33, 0
  v_mov_b32 v34, 0
  v_mov_b32 v35, 0
  v_mov_b32 v36, 0
  v_mov_b32 v37, 0
  v_mov_b32 v38, 0
  v_mov_b32 v39, 0
  v_mov_b32 v40, 0
  v_mov_b32 v41, 0
  v_mov_b32 v42, 0
  v_mov_b32 v43, 0
  v_mov_b32 v44, 0
  v_mov_b32 v45, 0
  v_mov_b32 v46, 0
  v_mov_b32 v47, 0
  v_mov_b32 v48, 0
  v_mov_b32 v49, 0
  v_mov_b32 v50, 0
  v_mov_b32 v51, 0
  v_mov_b32 v52, 0
  v_mov_b32 v53, 0
  v_mov_b32 v54, 0
  v_mov_b32 v55, 0
  v_mov_b32 v56, 0
  v_mov_b32 v57, 0
  v_mov_b32 v58, 0
  v_mov_b32 v59, 0
  v_mov_b32 v60, 0
  v_mov_b32 v61, 0
  v_mov_b32 v62, 0
  v_mov_b32 v63, 0
  v_mov_b32 v64, 0
  v_mov_b32 v65, 0
  v_mov_b32 v66, 0
  v_mov_b32 v67, 0
  v_mov_b32 v68, 0
  v_mov_b32 v69, 0
  v_mov_b32 v70, 0
  v_mov_b32 v71, 0
  v_mov_b32 v72, 0
  v_mov_b32 v73, 0
  v_mov_b32 v74, 0
  v_mov_b32 v75, 0
  v_mov_b32 v76, 0
  v_mov_b32 v77, 0
  v_mov_b32 v78, 0
  v_mov_b32 v79, 0
  v_mov_b32 v3, v2
  v_add_u32 v4, s35, v2
  s_barrier
  ds_read_b128 v[96:99], v4 offset:0
  ds_read_b128 v[80:83], v3 offset:0
  ds_read_b128 v[84:87], v3 offset:1024
  ds_read_b128 v[88:91], v3 offset:2048
  ds_read_b128 v[92:95], v3 offset:3072
LC_qkv_kern_25:
  s_waitcnt lgkmcnt(3)
  v_mfma_f32_32x32x16_bf16 v[16:31], v[80:83], v[96:99], v[16:31]
  ds_read_b128 v[116:119], v4 offset:1024
  ds_read_b128 v[100:103], v3 offset:4096
  s_add_u32 s40, s40, 16384
  s_cmp_ge_u32 s40, 147456
  s_cselect_b32 s40, 0, s40
  s_add_u32 s42, s40, s35
  s_waitcnt lgkmcnt(4)
  v_mfma_f32_32x32x16_bf16 v[32:47], v[84:87], v[96:99], v[32:47]
  ds_read_b128 v[104:107], v3 offset:5120
  v_add_u32 v12, s40, v2
  v_add_u32 v13, s42, v2
  s_waitcnt lgkmcnt(4)
  v_mfma_f32_32x32x16_bf16 v[48:63], v[88:91], v[96:99], v[48:63]
  ds_read_b128 v[108:111], v3 offset:6144
  s_barrier
  s_waitcnt lgkmcnt(4)
  v_mfma_f32_32x32x16_bf16 v[64:79], v[92:95], v[96:99], v[64:79]
  ds_read_b128 v[112:115], v3 offset:7168
  s_waitcnt lgkmcnt(3)
  v_mfma_f32_32x32x16_bf16 v[16:31], v[100:103], v[116:119], v[16:31]
  ds_read_b128 v[96:99], v13 offset:0
  ds_read_b128 v[80:83], v12 offset:0
  s_waitcnt lgkmcnt(4)
  v_mfma_f32_32x32x16_bf16 v[32:47], v[104:107], v[116:119], v[32:47]
  ds_read_b128 v[84:87], v12 offset:1024
  v_mov_b32 v3, v12
  v_mov_b32 v4, v13
  s_waitcnt lgkmcnt(4)
  v_mfma_f32_32x32x16_bf16 v[48:63], v[108:111], v[116:119], v[48:63]
  ds_read_b128 v[88:91], v12 offset:2048
  s_waitcnt lgkmcnt(4)
  v_mfma_f32_32x32x16_bf16 v[64:79], v[112:115], v[116:119], v[64:79]
  ds_read_b128 v[92:95], v12 offset:3072
  s_sub_u32 s28, s28, 1
  s_cmp_lg_u32 s28, 0
  s_cbranch_scc1 LC_qkv_kern_25
  s_branch EN_qkv_kern_24
EL_qkv_kern_23:
  s_mul_i32 s35, s20, 2048
  s_add_u32 s35, s35, 8192
  s_mov_b32 s40, 0
  v_mov_b32 v16, 0
  v_mov_b32 v17, 0
  v_mov_b32 v18, 0
  v_mov_b32 v19, 0
  v_mov_b32 v20, 0
  v_mov_b32 v21, 0
  v_mov_b32 v22, 0
  v_mov_b32 v23, 0
  v_mov_b32 v24, 0
  v_mov_b32 v25, 0
  v_mov_b32 v26, 0
  v_mov_b32 v27, 0
  v_mov_b32 v28, 0
  v_mov_b32 v29, 0
  v_mov_b32 v30, 0
  v_mov_b32 v31, 0
  v_mov_b32 v32, 0
  v_mov_b32 v33, 0
  v_mov_b32 v34, 0
  v_mov_b32 v35, 0
  v_mov_b32 v36, 0
  v_mov_b32 v37, 0
  v_mov_b32 v38, 0
  v_mov_b32 v39, 0
  v_mov_b32 v40, 0
  v_mov_b32 v41, 0
  v_mov_b32 v42, 0
  v_mov_b32 v43, 0
  v_mov_b32 v44, 0
  v_mov_b32 v45, 0
  v_mov_b32 v46, 0
  v_mov_b32 v47, 0
  v_mov_b32 v48, 0
  v_mov_b32 v49, 0
  v_mov_b32 v50, 0
  v_mov_b32 v51, 0
  v_mov_b32 v52, 0
  v_mov_b32 v53, 0
  v_mov_b32 v54, 0
  v_mov_b32 v55, 0
  v_mov_b32 v56, 0
  v_mov_b32 v57, 0
  v_mov_b32 v58, 0
  v_mov_b32 v59, 0
  v_mov_b32 v60, 0
  v_mov_b32 v61, 0
  v_mov_b32 v62, 0
  v_mov_b32 v63, 0
  v_mov_b32 v64, 0
  v_mov_b32 v65, 0
  v_mov_b32 v66, 0
  v_mov_b32 v67, 0
  v_mov_b32 v68, 0
  v_mov_b32 v69, 0
  v_mov_b32 v70, 0
  v_mov_b32 v71, 0
  v_mov_b32 v72, 0
  v_mov_b32 v73, 0
  v_mov_b32 v74, 0
  v_mov_b32 v75, 0
  v_mov_b32 v76, 0
  v_mov_b32 v77, 0
  v_mov_b32 v78, 0
  v_mov_b32 v79, 0
  v_mov_b32 v3, v2
  v_add_u32 v4, s35, v2
  s_barrier
  ds_read_b128 v[96:99], v4 offset:0
  ds_read_b128 v[80:83], v3 offset:0
  ds_read_b128 v[84:87], v3 offset:1024
  ds_read_b128 v[88:91], v3 offset:2048
  ds_read_b128 v[92:95], v3 offset:3072
LC_qkv_kern_26:
  s_waitcnt lgkmcnt(3)
  v_mfma_f32_32x32x16_bf16 v[16:31], v[96:99], v[80:83], v[16:31]
  ds_read_b128 v[116:119], v4 offset:1024
  ds_read_b128 v[100:103], v3 offset:4096
  s_add_u32 s40, s40, 16384
  s_cmp_ge_u32 s40, 147456
  s_cselect_b32 s40, 0, s40
  s_add_u32 s42, s40, s35
  s_waitcnt lgkmcnt(4)
  v_mfma_f32_32x32x16_bf16 v[32:47], v[96:99], v[84:87], v[32:47]
  ds_read_b128 v[104:107], v3 offset:5120
  v_add_u32 v12, s40, v2
  v_add_u32 v13, s42, v2
  s_waitcnt lgkmcnt(4)
  v_mfma_f32_32x32x16_bf16 v[48:63], v[96:99], v[88:91], v[48:63]
  ds_read_b128 v[108:111], v3 offset:6144
  s_barrier
  s_waitcnt lgkmcnt(4)
  v_mfma_f32_32x32x16_bf16 v[64:79], v[96:99], v[92:95], v[64:79]
  ds_read_b128 v[112:115], v3 offset:7168
  s_waitcnt lgkmcnt(3)
  v_mfma_f32_32x32x16_bf16 v[16:31], v[116:119], v[100:103], v[16:31]
  ds_read_b128 v[96:99], v13 offset:0
  ds_read_b128 v[80:83], v12 offset:0
  s_waitcnt lgkmcnt(4)
  v_mfma_f32_32x32x16_bf16 v[32:47], v[116:119], v[104:107], v[32:47]
  ds_read_b128 v[84:87], v12 offset:1024
  v_mov_b32 v3, v12
  v_mov_b32 v4, v13
  s_waitcnt lgkmcnt(4)
  v_mfma_f32_32x32x16_bf16 v[48:63], v[116:119], v[108:111], v[48:63]
  ds_read_b128 v[88:91], v12 offset:2048
  s_waitcnt lgkmcnt(4)
  v_mfma_f32_32x32x16_bf16 v[64:79], v[116:119], v[112:115], v[64:79]
  ds_read_b128 v[92:95], v12 offset:3072
  s_sub_u32 s28, s28, 1
  s_cmp_lg_u32 s28, 0
  s_cbranch_scc1 LC_qkv_kern_26
EN_qkv_kern_24:
  s_lshr_b32 s32, s25, 3
  s_and_b32 s33, s25, 7
  s_mul_i32 s34, s32, 19456
  s_add_u32 s34, s34, 20754432
  s_mov_b32 s35, 0x3eae1a93
  s_cmp_lt_u32 s24, 4
  s_cbranch_scc1 SW_qkv_kern_28
  s_cmp_lt_u32 s24, 8
  s_cbranch_scc1 SW_qkv_kern_29
  s_cmp_lt_u32 s24, 9
  s_cbranch_scc1 SW_qkv_kern_30
  s_branch SW_qkv_kern_31
SW_qkv_kern_28:
  s_lshl_b32 s36, s24, 3
  s_lshl_b32 s36, s36, 16
  s_lshl_b32 s37, s25, 10
  s_add_u32 s36, s36, s37
  s_add_u32 s36, s36, 18395136
  v_mul_f32 v16, s35, v16
  v_mul_f32 v17, s35, v17
  v_cvt_pk_bf16_f32 v120, v16, v17
  v_mul_f32 v18, s35, v18
  v_mul_f32 v19, s35, v19
  v_cvt_pk_bf16_f32 v121, v18, v19
  v_mul_f32 v20, s35, v20
  v_mul_f32 v21, s35, v21
  v_cvt_pk_bf16_f32 v122, v20, v21
  v_mul_f32 v22, s35, v22
  v_mul_f32 v23, s35, v23
  v_cvt_pk_bf16_f32 v123, v22, v23
  v_mul_f32 v24, s35, v24
  v_mul_f32 v25, s35, v25
  v_cvt_pk_bf16_f32 v124, v24, v25
  v_mul_f32 v26, s35, v26
  v_mul_f32 v27, s35, v27
  v_cvt_pk_bf16_f32 v125, v26, v27
  v_mul_f32 v28, s35, v28
  v_mul_f32 v29, s35, v29
  v_cvt_pk_bf16_f32 v126, v28, v29
  v_mul_f32 v30, s35, v30
  v_mul_f32 v31, s35, v31
  v_cvt_pk_bf16_f32 v127, v30, v31
  buffer_store_dwordx4 v[120:123], v2, s[8:11], s36 offen sc1
  s_add_u32 s36, s36, 65536
  buffer_store_dwordx4 v[124:127], v2, s[8:11], s36 offen sc1
  s_add_u32 s36, s36, 65536
  v_mul_f32 v32, s35, v32
  v_mul_f32 v33, s35, v33
  v_cvt_pk_bf16_f32 v128, v32, v33
  v_mul_f32 v34, s35, v34
  v_mul_f32 v35, s35, v35
  v_cvt_pk_bf16_f32 v129, v34, v35
  v_mul_f32 v36, s35, v36
  v_mul_f32 v37, s35, v37
  v_cvt_pk_bf16_f32 v130, v36, v37
  v_mul_f32 v38, s35, v38
  v_mul_f32 v39, s35, v39
  v_cvt_pk_bf16_f32 v131, v38, v39
  v_mul_f32 v40, s35, v40
  v_mul_f32 v41, s35, v41
  v_cvt_pk_bf16_f32 v132, v40, v41
  v_mul_f32 v42, s35, v42
  v_mul_f32 v43, s35, v43
  v_cvt_pk_bf16_f32 v133, v42, v43
  v_mul_f32 v44, s35, v44
  v_mul_f32 v45, s35, v45
  v_cvt_pk_bf16_f32 v134, v44, v45
  v_mul_f32 v46, s35, v46
  v_mul_f32 v47, s35, v47
  v_cvt_pk_bf16_f32 v135, v46, v47
  buffer_store_dwordx4 v[128:131], v2, s[8:11], s36 offen sc1
  s_add_u32 s36, s36, 65536
  buffer_store_dwordx4 v[132:135], v2, s[8:11], s36 offen sc1
  s_add_u32 s36, s36, 65536
  v_mul_f32 v48, s35, v48
  v_mul_f32 v49, s35, v49
  v_cvt_pk_bf16_f32 v136, v48, v49
  v_mul_f32 v50, s35, v50
  v_mul_f32 v51, s35, v51
  v_cvt_pk_bf16_f32 v137, v50, v51
  v_mul_f32 v52, s35, v52
  v_mul_f32 v53, s35, v53
  v_cvt_pk_bf16_f32 v138, v52, v53
  v_mul_f32 v54, s35, v54
  v_mul_f32 v55, s35, v55
  v_cvt_pk_bf16_f32 v139, v54, v55
  v_mul_f32 v56, s35, v56
  v_mul_f32 v57, s35, v57
  s_waitcnt vmcnt(4)
  v_cvt_pk_bf16_f32 v140, v56, v57
  v_mul_f32 v58, s35, v58
  v_mul_f32 v59, s35, v59
  v_cvt_pk_bf16_f32 v141, v58, v59
  v_mul_f32 v60, s35, v60
  v_mul_f32 v61, s35, v61
  v_cvt_pk_bf16_f32 v142, v60, v61
  v_mul_f32 v62, s35, v62
  v_mul_f32 v63, s35, v63
  v_cvt_pk_bf16_f32 v143, v62, v63
  buffer_store_dwordx4 v[136:139], v2, s[8:11], s36 offen sc1
  s_add_u32 s36, s36, 65536
  buffer_store_dwordx4 v[140:143], v2, s[8:11], s36 offen sc1
  s_add_u32 s36, s36, 65536
  v_mul_f32 v64, s35, v64
  v_mul_f32 v65, s35, v65
  v_cvt_pk_bf16_f32 v144, v64, v65
  v_mul_f32 v66, s35, v66
  v_mul_f32 v67, s35, v67
  v_cvt_pk_bf16_f32 v145, v66, v67
  v_mul_f32 v68, s35, v68
  v_mul_f32 v69, s35, v69
  v_cvt_pk_bf16_f32 v146, v68, v69
  v_mul_f32 v70, s35, v70
  v_mul_f32 v71, s35, v71
  v_cvt_pk_bf16_f32 v147, v70, v71
  v_mul_f32 v72, s35, v72
  v_mul_f32 v73, s35, v73
  v_cvt_pk_bf16_f32 v148, v72, v73
  v_mul_f32 v74, s35, v74
  v_mul_f32 v75, s35, v75
  v_cvt_pk_bf16_f32 v149, v74, v75
  v_mul_f32 v76, s35, v76
  v_mul_f32 v77, s35, v77
  v_cvt_pk_bf16_f32 v150, v76, v77
  v_mul_f32 v78, s35, v78
  v_mul_f32 v79, s35, v79
  v_cvt_pk_bf16_f32 v151, v78, v79
  buffer_store_dwordx4 v[144:147], v2, s[8:11], s36 offen sc1
  s_add_u32 s36, s36, 65536
  buffer_store_dwordx4 v[148:151], v2, s[8:11], s36 offen sc1
  s_add_u32 s36, s36, 65536
  s_branch SWE_qkv_kern_27
SW_qkv_kern_29:
  s_sub_u32 s36, s24, 4
  s_mul_i32 s36, s36, 1245184
  s_add_u32 s36, s36, s34
  s_lshl_b32 s37, s33, 10
  s_add_u32 s36, s36, s37
  v_cvt_pk_bf16_f32 v120, v16, v17
  v_cvt_pk_bf16_f32 v121, v18, v19
  v_cvt_pk_bf16_f32 v122, v20, v21
  v_cvt_pk_bf16_f32 v123, v22, v23
  v_cvt_pk_bf16_f32 v124, v24, v25
  v_cvt_pk_bf16_f32 v125, v26, v27
  v_cvt_pk_bf16_f32 v126, v28, v29
  v_cvt_pk_bf16_f32 v127, v30, v31
  buffer_store_dwordx4 v[120:123], v2, s[8:11], s36 offen sc1
  s_add_u32 s36, s36, 155648
  buffer_store_dwordx4 v[124:127], v2, s[8:11], s36 offen sc1
  s_add_u32 s36, s36, 155648
  v_cvt_pk_bf16_f32 v128, v32, v33
  v_cvt_pk_bf16_f32 v129, v34, v35
  v_cvt_pk_bf16_f32 v130, v36, v37
  v_cvt_pk_bf16_f32 v131, v38, v39
  v_cvt_pk_bf16_f32 v132, v40, v41
  v_cvt_pk_bf16_f32 v133, v42, v43
  v_cvt_pk_bf16_f32 v134, v44, v45
  v_cvt_pk_bf16_f32 v135, v46, v47
  buffer_store_dwordx4 v[128:131], v2, s[8:11], s36 offen sc1
  s_add_u32 s36, s36, 155648
  buffer_store_dwordx4 v[132:135], v2, s[8:11], s36 offen sc1
  s_add_u32 s36, s36, 155648
  v_cvt_pk_bf16_f32 v136, v48, v49
  v_cvt_pk_bf16_f32 v137, v50, v51
  v_cvt_pk_bf16_f32 v138, v52, v53
  v_cvt_pk_bf16_f32 v139, v54, v55
  s_waitcnt vmcnt(4)
  v_cvt_pk_bf16_f32 v140, v56, v57
  v_cvt_pk_bf16_f32 v141, v58, v59
  v_cvt_pk_bf16_f32 v142, v60, v61
  v_cvt_pk_bf16_f32 v143, v62, v63
  buffer_store_dwordx4 v[136:139], v2, s[8:11], s36 offen sc1
  s_add_u32 s36, s36, 155648
  buffer_store_dwordx4 v[140:143], v2, s[8:11], s36 offen sc1
  s_add_u32 s36, s36, 155648
  v_cvt_pk_bf16_f32 v144, v64, v65
  v_cvt_pk_bf16_f32 v145, v66, v67
  v_cvt_pk_bf16_f32 v146, v68, v69
  v_cvt_pk_bf16_f32 v147, v70, v71
  v_cvt_pk_bf16_f32 v148, v72, v73
  v_cvt_pk_bf16_f32 v149, v74, v75
  v_cvt_pk_bf16_f32 v150, v76, v77
  v_cvt_pk_bf16_f32 v151, v78, v79
  buffer_store_dwordx4 v[144:147], v2, s[8:11], s36 offen sc1
  s_add_u32 s36, s36, 155648
  buffer_store_dwordx4 v[148:151], v2, s[8:11], s36 offen sc1
  s_add_u32 s36, s36, 155648
  s_branch SWE_qkv_kern_27
SW_qkv_kern_30:
  v_lshlrev_b32 v8, 14, v5
  v_lshl_add_u32 v8, v6, 2, v8
  s_lshl_b32 s36, s25, 7
  s_add_u32 s36, s36, 20492288
  v_mul_f32 v16, s35, v16
  v_mul_f32 v17, s35, v17
  v_cvt_pk_bf16_f32 v120, v16, v17
  v_mul_f32 v18, s35, v18
  v_mul_f32 v19, s35, v19
  v_cvt_pk_bf16_f32 v121, v18, v19
  v_mul_f32 v20, s35, v20
  v_mul_f32 v21, s35, v21
  v_cvt_pk_bf16_f32 v122, v20, v21
  v_mul_f32 v22, s35, v22
  v_mul_f32 v23, s35, v23
  v_cvt_pk_bf16_f32 v123, v22, v23
  v_mul_f32 v24, s35, v24
  v_mul_f32 v25, s35, v25
  v_cvt_pk_bf16_f32 v124, v24, v25
  v_mul_f32 v26, s35, v26
  v_mul_f32 v27, s35, v27
  v_cvt_pk_bf16_f32 v125, v26, v27
  v_mul_f32 v28, s35, v28
  v_mul_f32 v29, s35, v29
  v_cvt_pk_bf16_f32 v126, v28, v29
  v_mul_f32 v30, s35, v30
  v_mul_f32 v31, s35, v31
  v_cvt_pk_bf16_f32 v127, v30, v31
  s_add_u32 s37, s36, 0
  buffer_store_dword v120, v8, s[8:11], s37 offen
  s_add_u32 s37, s36, 8192
  buffer_store_dword v121, v8, s[8:11], s37 offen
  s_add_u32 s37, s36, 32768
  buffer_store_dword v122, v8, s[8:11], s37 offen
  s_add_u32 s37, s36, 40960
  buffer_store_dword v123, v8, s[8:11], s37 offen
  s_add_u32 s37, s36, 65536
  buffer_store_dword v124, v8, s[8:11], s37 offen
  s_add_u32 s37, s36, 73728
  buffer_store_dword v125, v8, s[8:11], s37 offen
  s_add_u32 s37, s36, 98304
  buffer_store_dword v126, v8, s[8:11], s37 offen
  s_add_u32 s37, s36, 106496
  buffer_store_dword v127, v8, s[8:11], s37 offen
  v_mul_f32 v32, s35, v32
  v_mul_f32 v33, s35, v33
  v_cvt_pk_bf16_f32 v128, v32, v33
  v_mul_f32 v34, s35, v34
  v_mul_f32 v35, s35, v35
  v_cvt_pk_bf16_f32 v129, v34, v35
  v_mul_f32 v36, s35, v36
  v_mul_f32 v37, s35, v37
  v_cvt_pk_bf16_f32 v130, v36, v37
  v_mul_f32 v38, s35, v38
  v_mul_f32 v39, s35, v39
  v_cvt_pk_bf16_f32 v131, v38, v39
  v_mul_f32 v40, s35, v40
  v_mul_f32 v41, s35, v41
  v_cvt_pk_bf16_f32 v132, v40, v41
  v_mul_f32 v42, s35, v42
  v_mul_f32 v43, s35, v43
  v_cvt_pk_bf16_f32 v133, v42, v43
  v_mul_f32 v44, s35, v44
  v_mul_f32 v45, s35, v45
  v_cvt_pk_bf16_f32 v134, v44, v45
  v_mul_f32 v46, s35, v46
  v_mul_f32 v47, s35, v47
  v_cvt_pk_bf16_f32 v135, v46, v47
  s_add_u32 s37, s36, 131072
  buffer_store_dword v128, v8, s[8:11], s37 offen
  s_add_u32 s37, s36, 139264
  buffer_store_dword v129, v8, s[8:11], s37 offen
  s_add_u32 s37, s36, 163840
  buffer_store_dword v130, v8, s[8:11], s37 offen
  s_add_u32 s37, s36, 172032
  buffer_store_dword v131, v8, s[8:11], s37 offen
  s_add_u32 s37, s36, 196608
  buffer_store_dword v132, v8, s[8:11], s37 offen
  s_add_u32 s37, s36, 204800
  buffer_store_dword v133, v8, s[8:11], s37 offen
  s_add_u32 s37, s36, 229376
  buffer_store_dword v134, v8, s[8:11], s37 offen
  s_add_u32 s37, s36, 237568
  buffer_store_dword v135, v8, s[8:11], s37 offen
  v_mul_u32_u24 v7, 311296, v5
  v_lshl_add_u32 v7, v6, 2, v7
  s_lshl_b32 s36, s33, 7
  s_add_u32 s36, s36, s34
  s_add_u32 s36, s36, 8192
  v_cvt_pk_bf16_f32 v136, v48, v49
  v_cvt_pk_bf16_f32 v137, v50, v51
  v_cvt_pk_bf16_f32 v138, v52, v53
  v_cvt_pk_bf16_f32 v139, v54, v55
  s_waitcnt vmcnt(16)
  v_cvt_pk_bf16_f32 v140, v56, v57
  v_cvt_pk_bf16_f32 v141, v58, v59
  v_cvt_pk_bf16_f32 v142, v60, v61
  v_cvt_pk_bf16_f32 v143, v62, v63
  s_add_u32 s37, s36, 0
  buffer_store_dword v136, v7, s[8:11], s37 offen
  s_add_u32 s37, s36, 155648
  buffer_store_dword v137, v7, s[8:11], s37 offen
  s_add_u32 s37, s36, 622592
  buffer_store_dword v138, v7, s[8:11], s37 offen
  s_add_u32 s37, s36, 778240
  buffer_store_dword v139, v7, s[8:11], s37 offen
  s_add_u32 s37, s36, 1245184
  buffer_store_dword v140, v7, s[8:11], s37 offen
  s_add_u32 s37, s36, 1400832
  buffer_store_dword v141, v7, s[8:11], s37 offen
  s_add_u32 s37, s36, 1867776
  buffer_store_dword v142, v7, s[8:11], s37 offen
  s_add_u32 s37, s36, 2023424
  buffer_store_dword v143, v7, s[8:11], s37 offen
  v_cvt_pk_bf16_f32 v144, v64, v65
  v_cvt_pk_bf16_f32 v145, v66, v67
  v_cvt_pk_bf16_f32 v146, v68, v69
  v_cvt_pk_bf16_f32 v147, v70, v71
  v_cvt_pk_bf16_f32 v148, v72, v73
  v_cvt_pk_bf16_f32 v149, v74, v75
  v_cvt_pk_bf16_f32 v150, v76, v77
  v_cvt_pk_bf16_f32 v151, v78, v79
  s_add_u32 s37, s36, 2490368
  buffer_store_dword v144, v7, s[8:11], s37 offen
  s_add_u32 s37, s36, 2646016
  buffer_store_dword v145, v7, s[8:11], s37 offen
  s_add_u32 s37, s36, 3112960
  buffer_store_dword v146, v7, s[8:11], s37 offen
  s_add_u32 s37, s36, 3268608
  buffer_store_dword v147, v7, s[8:11], s37 offen
  s_add_u32 s37, s36, 3735552
  buffer_store_dword v148, v7, s[8:11], s37 offen
  s_add_u32 s37, s36, 3891200
  buffer_store_dword v149, v7, s[8:11], s37 offen
  s_add_u32 s37, s36, 4358144
  buffer_store_dword v150, v7, s[8:11], s37 offen
  s_add_u32 s37, s36, 4513792
  buffer_store_dword v151, v7, s[8:11], s37 offen
  s_branch SWE_qkv_kern_27
SW_qkv_kern_31:
  s_mul_i32 s36, s33, 1280
  s_add_u32 s36, s36, s34
  s_add_u32 s36, s36, 9216
  s_sub_u32 s37, s24, 9
  s_lshl_b32 s37, s37, 7
  v_mul_u32_u24 v9, 320, v5
  v_add_u32 v7, s37, v6
  v_mul_u32_u24 v8, 3641, v7
  v_lshrrev_b32 v8, 16, v8
  v_mul_u32_u24 v10, 18, v8
  v_sub_u32 v7, v7, v10
  v_mul_u32_u24 v8, 155648, v8
  v_lshl_add_u32 v8, v7, 4, v8
  v_add_u32 v8, v8, v9
  v_cvt_pk_bf16_f32 v120, v16, v17
  v_cvt_pk_bf16_f32 v121, v18, v19
  v_cvt_pk_bf16_f32 v122, v20, v21
  v_cvt_pk_bf16_f32 v123, v22, v23
  v_cvt_pk_bf16_f32 v124, v24, v25
  v_cvt_pk_bf16_f32 v125, v26, v27
  v_cvt_pk_bf16_f32 v126, v28, v29
  v_cvt_pk_bf16_f32 v127, v30, v31
  buffer_store_dwordx4 v[120:123], v8, s[8:11], s36 offen sc1
  buffer_store_dwordx4 v[124:127], v8, s[8:11], s36 offen offset:640 sc1
  v_add_u32 v7, s37, v6
  v_add_u32 v7, 32, v7
  v_mul_u32_u24 v8, 3641, v7
  v_lshrrev_b32 v8, 16, v8
  v_mul_u32_u24 v10, 18, v8
  v_sub_u32 v7, v7, v10
  v_mul_u32_u24 v8, 155648, v8
  v_lshl_add_u32 v8, v7, 4, v8
  v_add_u32 v8, v8, v9
  v_cvt_pk_bf16_f32 v128, v32, v33
  v_cvt_pk_bf16_f32 v129, v34, v35
  v_cvt_pk_bf16_f32 v130, v36, v37
  v_cvt_pk_bf16_f32 v131, v38, v39
  v_cvt_pk_bf16_f32 v132, v40, v41
  v_cvt_pk_bf16_f32 v133, v42, v43
  v_cvt_pk_bf16_f32 v134, v44, v45
  v_cvt_pk_bf16_f32 v135, v46, v47
  buffer_store_dwordx4 v[128:131], v8, s[8:11], s36 offen sc1
  buffer_store_dwordx4 v[132:135], v8, s[8:11], s36 offen offset:640 sc1
  s_cmp_eq_u32 s24, 13
  s_cbranch_scc1 END_qkv_kern_19
  v_add_u32 v7, s37, v6
  v_add_u32 v7, 64, v7
  v_mul_u32_u24 v8, 3641, v7
  v_lshrrev_b32 v8, 16, v8
  v_mul_u32_u24 v10, 18, v8
  v_sub_u32 v7, v7, v10
  v_mul_u32_u24 v8, 155648, v8
  v_lshl_add_u32 v8, v7, 4, v8
  v_add_u32 v8, v8, v9
  v_cvt_pk_bf16_f32 v136, v48, v49
  v_cvt_pk_bf16_f32 v137, v50, v51
  v_cvt_pk_bf16_f32 v138, v52, v53
  v_cvt_pk_bf16_f32 v139, v54, v55
  s_waitcnt vmcnt(4)
  v_cvt_pk_bf16_f32 v140, v56, v57
  v_cvt_pk_bf16_f32 v141, v58, v59
  v_cvt_pk_bf16_f32 v142, v60, v61
  v_cvt_pk_bf16_f32 v143, v62, v63
  buffer_store_dwordx4 v[136:139], v8, s[8:11], s36 offen sc1
  buffer_store_dwordx4 v[140:143], v8, s[8:11], s36 offen offset:640 sc1
  v_add_u32 v7, s37, v6
  v_add_u32 v7, 96, v7
  v_mul_u32_u24 v8, 3641, v7
  v_lshrrev_b32 v8, 16, v8
  v_mul_u32_u24 v10, 18, v8
  v_sub_u32 v7, v7, v10
  v_mul_u32_u24 v8, 155648, v8
  v_lshl_add_u32 v8, v7, 4, v8
  v_add_u32 v8, v8, v9
  v_cvt_pk_bf16_f32 v144, v64, v65
  v_cvt_pk_bf16_f32 v145, v66, v67
  v_cvt_pk_bf16_f32 v146, v68, v69
  v_cvt_pk_bf16_f32 v147, v70, v71
  v_cvt_pk_bf16_f32 v148, v72, v73
  v_cvt_pk_bf16_f32 v149, v74, v75
  v_cvt_pk_bf16_f32 v150, v76, v77
  v_cvt_pk_bf16_f32 v151, v78, v79
  buffer_store_dwordx4 v[144:147], v8, s[8:11], s36 offen sc1
  buffer_store_dwordx4 v[148:151], v8, s[8:11], s36 offen offset:640 sc1
SWE_qkv_kern_27:
  s_waitcnt vmcnt(0) lgkmcnt(0)
END_qkv_kern_19:
  s_endpgm
qkv_kernel_codeend:

.globl attn1_kernel
.p2align 8
.type attn1_kernel,@function
attn1_kernel:
  s_mov_b32 s18, 1
ATTN_BODY:
  s_cmp_ge_u32 s2, 256
  s_cbranch_scc1 END_attn1_ke_32
  s_load_dwordx2 s[4:5], s[0:1], 64
  s_getpc_b64 s[84:85]
PC_attn1_ke_33:
  s_mov_b32 s88, s84
  s_and_b32 s89, s85, 0xffff
  s_mov_b32 s90, attn1_kernel_codeend-PC_attn1_ke_33
  s_mov_b32 s91, 0x20000
  v_lshlrev_b32 v10, 4, v0
  buffer_load_dwordx4 v[112:115], v10, s[88:91], 0 offen
  v_lshrrev_b32 v1, 6, v0
  s_nop 0
  v_readfirstlane_b32 s20, v1
  v_and_b32 v1, 63, v0
  v_lshlrev_b32 v2, 4, v1
  v_lshrrev_b32 v7, 5, v1
  v_and_b32 v8, 31, v1
  s_and_b32 s21, s2, 7
  s_lshr_b32 s22, s2, 3
  s_lshl_b32 s23, s21, 2
  s_and_b32 s24, s22, 3
  s_add_u32 s23, s23, s24
  s_lshr_b32 s24, s22, 2
  s_lshl_b32 s25, s24, 3
  s_add_u32 s25, s25, s20
  s_waitcnt lgkmcnt(0)
  s_mov_b32 s8, s4
  s_and_b32 s9, s5, 65535
  s_mov_b32 s10, 0x10000000
  s_mov_b32 s11, 0x20000
  s_cmp_lt_u32 s20, 8
  s_cbranch_scc1 SK_attn1_ke_34
  s_mul_i32 s30, s23, 155648
  s_add_u32 s30, s30, 20754432
  s_mov_b32 s31, 0
  s_mov_b32 m0, s31
  s_nop 0
  buffer_load_dwordx4 v2, s[8:11], s30 offen lds
  buffer_load_dwordx4 v2, s[8:11], s30 offen offset:1024 lds
  buffer_load_dwordx4 v2, s[8:11], s30 offen offset:2048 lds
  buffer_load_dwordx4 v2, s[8:11], s30 offen offset:3072 lds
  s_add_u32 s30, s30, 4096
  s_add_u32 s31, s31, 4096
  s_mov_b32 m0, s31
  s_nop 0
  buffer_load_dwordx4 v2, s[8:11], s30 offen lds
  buffer_load_dwordx4 v2, s[8:11], s30 offen offset:1024 lds
  buffer_load_dwordx4 v2, s[8:11], s30 offen offset:2048 lds
  buffer_load_dwordx4 v2, s[8:11], s30 offen offset:3072 lds
  s_add_u32 s30, s30, 4096
  s_add_u32 s31, s31, 4096
  s_mov_b32 m0, s31
  s_nop 0
  buffer_load_dwordx4 v2, s[8:11], s30 offen lds
  buffer_load_dwordx4 v2, s[8:11], s30 offen offset:1024 lds
  buffer_load_dwordx4 v2, s[8:11], s30 offen offset:2048 lds
  buffer_load_dwordx4 v2, s[8:11], s30 offen offset:3072 lds
  s_add_u32 s30, s30, 4096
  s_add_u32 s31, s31, 4096
  s_mov_b32 m0, s31
  s_nop 0
  buffer_load_dwordx4 v2, s[8:11], s30 offen lds
  buffer_load_dwordx4 v2, s[8:11], s30 offen offset:1024 lds
  buffer_load_dwordx4 v2, s[8:11], s30 offen offset:2048 lds
  buffer_load_dwordx4 v2, s[8:11], s30 offen offset:3072 lds
  s_add_u32 s30, s30, 4096
  s_add_u32 s31, s31, 4096
  s_mov_b32 m0, s31
  s_nop 0
  buffer_load_dwordx4 v2, s[8:11], s30 offen lds
  buffer_load_dwordx4 v2, s[8:11], s30 offen offset:1024 lds
  buffer_load_dwordx4 v2, s[8:11], s30 offen offset:2048 lds
  s_add_u32 s30, s30, 3072
  s_add_u32 s31, s31, 3072
  s_mov_b32 m0, s31
  s_nop 0
  buffer_load_dwordx4 v2, s[8:11], s30 offen lds
  buffer_load_dwordx4 v2, s[8:11], s30 offen offset:1024 lds
  buffer_load_dwordx4 v2, s[8:11], s30 offen offset:2048 lds
  buffer_load_dwordx4 v2, s[8:11], s30 offen offset:3072 lds
  s_add_u32 s30, s30, 4096
  s_add_u32 s31, s31, 4096
  s_mov_b32 m0, s31
  s_nop 0
  buffer_load_dwordx4 v2, s[8:11], s30 offen lds
  buffer_load_dwordx4 v2, s[8:11], s30 offen offset:1024 lds
  buffer_load_dwordx4 v2, s[8:11], s30 offen offset:2048 lds
  buffer_load_dwordx4 v2, s[8:11], s30 offen offset:3072 lds
  s_add_u32 s30, s30, 4096
  s_add_u32 s31, s31, 4096
  s_mov_b32 m0, s31
  s_nop 0
  buffer_load_dwordx4 v2, s[8:11], s30 offen lds
  buffer_load_dwordx4 v2, s[8:11], s30 offen offset:1024 lds
  buffer_load_dwordx4 v2, s[8:11], s30 offen offset:2048 lds
  buffer_load_dwordx4 v2, s[8:11], s30 offen offset:3072 lds
  s_add_u32 s30, s30, 4096
  s_add_u32 s31, s31, 4096
  s_mov_b32 m0, s31
  s_nop 0
  buffer_load_dwordx4 v2, s[8:11], s30 offen lds
  buffer_load_dwordx4 v2, s[8:11], s30 offen offset:1024 lds
  buffer_load_dwordx4 v2, s[8:11], s30 offen offset:2048 lds
  buffer_load_dwordx4 v2, s[8:11], s30 offen offset:3072 lds
  s_add_u32 s30, s30, 4096
  s_add_u32 s31, s31, 4096
  s_mov_b32 m0, s31
  s_nop 0
  buffer_load_dwordx4 v2, s[8:11], s30 offen lds
  buffer_load_dwordx4 v2, s[8:11], s30 offen offset:1024 lds
  buffer_load_dwordx4 v2, s[8:11], s30 offen offset:2048 lds
  s_add_u32 s30, s30, 3072
  s_add_u32 s31, s31, 3072
  s_mov_b32 m0, s31
  s_nop 0
  buffer_load_dwordx4 v2, s[8:11], s30 offen lds
  buffer_load_dwordx4 v2, s[8:11], s30 offen offset:1024 lds
  buffer_load_dwordx4 v2, s[8:11], s30 offen offset:2048 lds
  buffer_load_dwordx4 v2, s[8:11], s30 offen offset:3072 lds
  s_add_u32 s30, s30, 4096
  s_add_u32 s31, s31, 4096
  s_mov_b32 m0, s31
  s_nop 0
  buffer_load_dwordx4 v2, s[8:11], s30 offen lds
  buffer_load_dwordx4 v2, s[8:11], s30 offen offset:1024 lds
  buffer_load_dwordx4 v2, s[8:11], s30 offen offset:2048 lds
  buffer_load_dwordx4 v2, s[8:11], s30 offen offset:3072 lds
  s_add_u32 s30, s30, 4096
  s_add_u32 s31, s31, 4096
  s_mov_b32 m0, s31
  s_nop 0
  buffer_load_dwordx4 v2, s[8:11], s30 offen lds
  buffer_load_dwordx4 v2, s[8:11], s30 offen offset:1024 lds
  buffer_load_dwordx4 v2, s[8:11], s30 offen offset:2048 lds
  buffer_load_dwordx4 v2, s[8:11], s30 offen offset:3072 lds
  s_add_u32 s30, s30, 4096
  s_add_u32 s31, s31, 4096
  s_mov_b32 m0, s31
  s_nop 0
  buffer_load_dwordx4 v2, s[8:11], s30 offen lds
  buffer_load_dwordx4 v2, s[8:11], s30 offen offset:1024 lds
  buffer_load_dwordx4 v2, s[8:11], s30 offen offset:2048 lds
  buffer_load_dwordx4 v2, s[8:11], s30 offen offset:3072 lds
  s_add_u32 s30, s30, 4096
  s_add_u32 s31, s31, 4096
  s_mov_b32 m0, s31
  s_nop 0
  buffer_load_dwordx4 v2, s[8:11], s30 offen lds
  buffer_load_dwordx4 v2, s[8:11], s30 offen offset:1024 lds
  buffer_load_dwordx4 v2, s[8:11], s30 offen offset:2048 lds
  s_add_u32 s30, s30, 3072
  s_add_u32 s31, s31, 3072
  s_waitcnt vmcnt(38)
  s_barrier
  s_mov_b32 m0, s31
  s_nop 0
  buffer_load_dwordx4 v2, s[8:11], s30 offen lds
  buffer_load_dwordx4 v2, s[8:11], s30 offen offset:1024 lds
  buffer_load_dwordx4 v2, s[8:11], s30 offen offset:2048 lds
  buffer_load_dwordx4 v2, s[8:11], s30 offen offset:3072 lds
  s_add_u32 s30, s30, 4096
  s_add_u32 s31, s31, 4096
  s_mov_b32 m0, s31
  s_nop 0
  buffer_load_dwordx4 v2, s[8:11], s30 offen lds
  buffer_load_dwordx4 v2, s[8:11], s30 offen offset:1024 lds
  buffer_load_dwordx4 v2, s[8:11], s30 offen offset:2048 lds
  buffer_load_dwordx4 v2, s[8:11], s30 offen offset:3072 lds
  s_add_u32 s30, s30, 4096
  s_add_u32 s31, s31, 4096
  s_mov_b32 m0, s31
  s_nop 0
  buffer_load_dwordx4 v2, s[8:11], s30 offen lds
  buffer_load_dwordx4 v2, s[8:11], s30 offen offset:1024 lds
  buffer_load_dwordx4 v2, s[8:11], s30 offen offset:2048 lds
  buffer_load_dwordx4 v2, s[8:11], s30 offen offset:3072 lds
  s_add_u32 s30, s30, 4096
  s_add_u32 s31, s31, 4096
  s_mov_b32 m0, s31
  s_nop 0
  buffer_load_dwordx4 v2, s[8:11], s30 offen lds
  buffer_load_dwordx4 v2, s[8:11], s30 offen offset:1024 lds
  buffer_load_dwordx4 v2, s[8:11], s30 offen offset:2048 lds
  buffer_load_dwordx4 v2, s[8:11], s30 offen offset:3072 lds
  s_add_u32 s30, s30, 4096
  s_add_u32 s31, s31, 4096
  s_mov_b32 m0, s31
  s_nop 0
  buffer_load_dwordx4 v2, s[8:11], s30 offen lds
  buffer_load_dwordx4 v2, s[8:11], s30 offen offset:1024 lds
  buffer_load_dwordx4 v2, s[8:11], s30 offen offset:2048 lds
  s_add_u32 s30, s30, 3072
  s_add_u32 s31, s31, 3072
  s_mov_b32 m0, s31
  s_nop 0
  buffer_load_dwordx4 v2, s[8:11], s30 offen lds
  buffer_load_dwordx4 v2, s[8:11], s30 offen offset:1024 lds
  buffer_load_dwordx4 v2, s[8:11], s30 offen offset:2048 lds
  buffer_load_dwordx4 v2, s[8:11], s30 offen offset:3072 lds
  s_add_u32 s30, s30, 4096
  s_add_u32 s31, s31, 4096
  s_mov_b32 m0, s31
  s_nop 0
  buffer_load_dwordx4 v2, s[8:11], s30 offen lds
  buffer_load_dwordx4 v2, s[8:11], s30 offen offset:1024 lds
  buffer_load_dwordx4 v2, s[8:11], s30 offen offset:2048 lds
  buffer_load_dwordx4 v2, s[8:11], s30 offen offset:3072 lds
  s_add_u32 s30, s30, 4096
  s_add_u32 s31, s31, 4096
  s_mov_b32 m0, s31
  s_nop 0
  buffer_load_dwordx4 v2, s[8:11], s30 offen lds
  buffer_load_dwordx4 v2, s[8:11], s30 offen offset:1024 lds
  buffer_load_dwordx4 v2, s[8:11], s30 offen offset:2048 lds
  buffer_load_dwordx4 v2, s[8:11], s30 offen offset:3072 lds
  s_add_u32 s30, s30, 4096
  s_add_u32 s31, s31, 4096
  s_mov_b32 m0, s31
  s_nop 0
  buffer_load_dwordx4 v2, s[8:11], s30 offen lds
  buffer_load_dwordx4 v2, s[8:11], s30 offen offset:1024 lds
  buffer_load_dwordx4 v2, s[8:11], s30 offen offset:2048 lds
  buffer_load_dwordx4 v2, s[8:11], s30 offen offset:3072 lds
  s_add_u32 s30, s30, 4096
  s_add_u32 s31, s31, 4096
  s_mov_b32 m0, s31
  s_nop 0
  buffer_load_dwordx4 v2, s[8:11], s30 offen lds
  buffer_load_dwordx4 v2, s[8:11], s30 offen offset:1024 lds
  buffer_load_dwordx4 v2, s[8:11], s30 offen offset:2048 lds
  s_add_u32 s30, s30, 3072
  s_add_u32 s31, s31, 3072
  s_mov_b32 m0, s31
  s_nop 0
  buffer_load_dwordx4 v2, s[8:11], s30 offen lds
  buffer_load_dwordx4 v2, s[8:11], s30 offen offset:1024 lds
  buffer_load_dwordx4 v2, s[8:11], s30 offen offset:2048 lds
  buffer_load_dwordx4 v2, s[8:11], s30 offen offset:3072 lds
  s_add_u32 s30, s30, 4096
  s_add_u32 s31, s31, 4096
  s_mov_b32 m0, s31
  s_nop 0
  buffer_load_dwordx4 v2, s[8:11], s30 offen lds
  buffer_load_dwordx4 v2, s[8:11], s30 offen offset:1024 lds
  buffer_load_dwordx4 v2, s[8:11], s30 offen offset:2048 lds
  buffer_load_dwordx4 v2, s[8:11], s30 offen offset:3072 lds
  s_add_u32 s30, s30, 4096
  s_add_u32 s31, s31, 4096
  s_mov_b32 m0, s31
  s_nop 0
  buffer_load_dwordx4 v2, s[8:11], s30 offen lds
  buffer_load_dwordx4 v2, s[8:11], s30 offen offset:1024 lds
  buffer_load_dwordx4 v2, s[8:11], s30 offen offset:2048 lds
  buffer_load_dwordx4 v2, s[8:11], s30 offen offset:3072 lds
  s_add_u32 s30, s30, 4096
  s_add_u32 s31, s31, 4096
  s_mov_b32 m0, s31
  s_nop 0
  buffer_load_dwordx4 v2, s[8:11], s30 offen lds
  buffer_load_dwordx4 v2, s[8:11], s30 offen offset:1024 lds
  buffer_load_dwordx4 v2, s[8:11], s30 offen offset:2048 lds
  buffer_load_dwordx4 v2, s[8:11], s30 offen offset:3072 lds
  s_add_u32 s30, s30, 4096
  s_add_u32 s31, s31, 4096
  s_mov_b32 m0, s31
  s_nop 0
  buffer_load_dwordx4 v2, s[8:11], s30 offen lds
  buffer_load_dwordx4 v2, s[8:11], s30 offen offset:1024 lds
  buffer_load_dwordx4 v2, s[8:11], s30 offen offset:2048 lds
  s_add_u32 s30, s30, 3072
  s_add_u32 s31, s31, 3072
  s_mov_b32 m0, s31
  s_nop 0
  buffer_load_dwordx4 v2, s[8:11], s30 offen lds
  buffer_load_dwordx4 v2, s[8:11], s30 offen offset:1024 lds
  buffer_load_dwordx4 v2, s[8:11], s30 offen offset:2048 lds
  buffer_load_dwordx4 v2, s[8:11], s30 offen offset:3072 lds
  s_add_u32 s30, s30, 4096
  s_add_u32 s31, s31, 4096
  s_mov_b32 m0, s31
  s_nop 0
  buffer_load_dwordx4 v2, s[8:11], s30 offen lds
  buffer_load_dwordx4 v2, s[8:11], s30 offen offset:1024 lds
  buffer_load_dwordx4 v2, s[8:11], s30 offen offset:2048 lds
  buffer_load_dwordx4 v2, s[8:11], s30 offen offset:3072 lds
  s_add_u32 s30, s30, 4096
  s_add_u32 s31, s31, 4096
  s_mov_b32 m0, s31
  s_nop 0
  buffer_load_dwordx4 v2, s[8:11], s30 offen lds
  buffer_load_dwordx4 v2, s[8:11], s30 offen offset:1024 lds
  buffer_load_dwordx4 v2, s[8:11], s30 offen offset:2048 lds
  buffer_load_dwordx4 v2, s[8:11], s30 offen offset:3072 lds
  s_add_u32 s30, s30, 4096
  s_add_u32 s31, s31, 4096
  s_mov_b32 m0, s31
  s_nop 0
  buffer_load_dwordx4 v2, s[8:11], s30 offen lds
  buffer_load_dwordx4 v2, s[8:11], s30 offen offset:1024 lds
  buffer_load_dwordx4 v2, s[8:11], s30 offen offset:2048 lds
  buffer_load_dwordx4 v2, s[8:11], s30 offen offset:3072 lds
  s_add_u32 s30, s30, 4096
  s_add_u32 s31, s31, 4096
  s_mov_b32 m0, s31
  s_nop 0
  buffer_load_dwordx4 v2, s[8:11], s30 offen lds
  buffer_load_dwordx4 v2, s[8:11], s30 offen offset:1024 lds
  buffer_load_dwordx4 v2, s[8:11], s30 offen offset:2048 lds
  s_add_u32 s30, s30, 3072
  s_add_u32 s31, s31, 3072
  s_mov_b32 m0, s31
  s_nop 0
  buffer_load_dwordx4 v2, s[8:11], s30 offen lds
  buffer_load_dwordx4 v2, s[8:11], s30 offen offset:1024 lds
  buffer_load_dwordx4 v2, s[8:11], s30 offen offset:2048 lds
  buffer_load_dwordx4 v2, s[8:11], s30 offen offset:3072 lds
  s_add_u32 s30, s30, 4096
  s_add_u32 s31, s31, 4096
  s_mov_b32 m0, s31
  s_nop 0
  buffer_load_dwordx4 v2, s[8:11], s30 offen lds
  buffer_load_dwordx4 v2, s[8:11], s30 offen offset:1024 lds
  buffer_load_dwordx4 v2, s[8:11], s30 offen offset:2048 lds
  buffer_load_dwordx4 v2, s[8:11], s30 offen offset:3072 lds
  s_add_u32 s30, s30, 4096
  s_add_u32 s31, s31, 4096
  s_mov_b32 m0, s31
  s_nop 0
  buffer_load_dwordx4 v2, s[8:11], s30 offen lds
  buffer_load_dwordx4 v2, s[8:11], s30 offen offset:1024 lds
  buffer_load_dwordx4 v2, s[8:11], s30 offen offset:2048 lds
  buffer_load_dwordx4 v2, s[8:11], s30 offen offset:3072 lds
  s_add_u32 s30, s30, 4096
  s_add_u32 s31, s31, 4096
  s_mov_b32 m0, s31
  s_nop 0
  buffer_load_dwordx4 v2, s[8:11], s30 offen lds
  buffer_load_dwordx4 v2, s[8:11], s30 offen offset:1024 lds
  buffer_load_dwordx4 v2, s[8:11], s30 offen offset:2048 lds
  buffer_load_dwordx4 v2, s[8:11], s30 offen offset:3072 lds
  s_add_u32 s30, s30, 4096
  s_add_u32 s31, s31, 4096
  s_mov_b32 m0, s31
  s_nop 0
  buffer_load_dwordx4 v2, s[8:11], s30 offen lds
  buffer_load_dwordx4 v2, s[8:11], s30 offen offset:1024 lds
  buffer_load_dwordx4 v2, s[8:11], s30 offen offset:2048 lds
  s_add_u32 s30, s30, 3072
  s_add_u32 s31, s31, 3072
  s_waitcnt vmcnt(0)
  s_barrier
  s_cmp_eq_u32 s18, 0
  s_cbranch_scc1 END_attn1_ke_32
  s_load_dwordx4 s[44:47], s[0:1], 32
  s_waitcnt lgkmcnt(0)
  s_mov_b32 s48, s44
  s_and_b32 s49, s45, 65535
  s_mov_b32 s50, 0x510000
  s_mov_b32 s51, 0x20000
  s_mov_b32 s52, s46
  s_and_b32 s53, s47, 65535
  s_mov_b32 s54, 0x510000
  s_mov_b32 s55, 0x20000
  v_lshrrev_b32 v23, 3, v1
  v_and_b32 v21, 7, v1
  v_lshlrev_b32 v21, 4, v21
  v_mul_u32_u24 v20, 9216, v23
  v_add_u32 v20, v20, v21
  v_mul_u32_u24 v23, 1152, v23
  v_add_u32 v21, v21, v23
  v_and_b32 v23, 3, v1
  v_and_b32 v22, 1, v23
  v_lshlrev_b32 v22, 1, v22
  v_lshrrev_b32 v23, 1, v23
  v_or_b32 v22, v22, v23
  v_lshlrev_b32 v22, 3, v22
  v_bfe_u32 v23, v1, 4, 1
  v_lshl_add_u32 v22, v23, 5, v22
  v_bfe_u32 v23, v1, 2, 2
  v_lshl_add_u32 v23, v7, 3, v23
  v_lshl_add_u32 v22, v23, 7, v22
  v_add_u32 v22, 155648, v22
  s_mov_b32 s64, 0
  v_lshrrev_b32 v23, 4, v1
  v_lshlrev_b32 v23, 3, v23
  v_bfe_u32 v40, v1, 2, 2
  v_add_u32 v23, v23, v40
  v_and_b32 v40, 3, v1
  v_lshlrev_b32 v40, 4, v40
  v_lshl_add_u32 v40, v23, 7, v40
  v_add_u32 v40, 155648, v40
  v_lshrrev_b32 v23, 3, v1
  v_mul_u32_u24 v41, 1152, v23
  v_bfe_u32 v23, v1, 1, 2
  v_mul_u32_u24 v23, 288, v23
  v_add_u32 v41, v41, v23
  v_and_b32 v23, 1, v1
  v_lshlrev_b32 v23, 4, v23
  v_add_u32 v41, v41, v23
  v_add_u32 v41, 256, v41
  v_lshrrev_b32 v23, 4, v1
  v_lshlrev_b32 v23, 3, v23
  v_bfe_u32 v46, v1, 2, 2
  v_add_u32 v23, v23, v46
  v_and_b32 v46, 3, v1
  v_lshlrev_b32 v46, 3, v46
  v_lshl_add_u32 v46, v23, 7, v46
  v_add_u32 v46, 155648, v46
  s_mov_b32 s32, s2
  s_mov_b32 s33, 0
  s_cmp_ge_u32 s32, 1296
  s_cbranch_scc1 BW2_attn1_ke_35
  s_mul_i32 s34, s32, 58255
  s_lshr_b32 s34, s34, 22
  s_mul_i32 s35, s34, 72
  s_sub_u32 s35, s32, s35
  s_mul_i32 s40, s34, 294912
  s_lshl_b32 s41, s35, 7
  s_add_u32 s40, s40, s41
  s_add_u32 s41, s33, 155648
  s_mov_b32 m0, s41
  s_nop 0
  buffer_load_dwordx4 v20, s[48:51], s40 offen lds
  s_add_u32 s40, s40, 73728
  s_add_u32 s41, s41, 1024
  s_mov_b32 m0, s41
  s_nop 0
  buffer_load_dwordx4 v20, s[48:51], s40 offen lds
  s_add_u32 s40, s40, 73728
  s_add_u32 s41, s41, 1024
  s_mov_b32 m0, s41
  s_nop 0
  buffer_load_dwordx4 v20, s[48:51], s40 offen lds
  s_add_u32 s40, s40, 73728
  s_add_u32 s41, s41, 1024
  s_mov_b32 m0, s41
  s_nop 0
  buffer_load_dwordx4 v20, s[48:51], s40 offen lds
  s_add_u32 s40, s40, 73728
  s_add_u32 s41, s41, 1024
  s_mul_i32 s56, s35, 73728
  s_lshl_b32 s41, s34, 11
  s_add_u32 s56, s56, s41
  s_add_u32 s56, s56, 2727936
  s_mov_b32 s57, 36864
  s_mov_b32 s58, 1
  s_mul_i32 s64, s34, 144
  s_lshl_b32 s41, s35, 1
  s_add_u32 s64, s64, s41
  s_lshl_b32 s64, s64, 7
  s_add_u32 s64, s64, 13344768
  s_branch BD_attn1_ke_36
BW2_attn1_ke_35:
  s_sub_u32 s42, s32, 1296
  s_mul_i32 s34, s42, 7282
  s_lshr_b32 s34, s34, 16
  s_mul_i32 s35, s34, 9
  s_sub_u32 s35, s42, s35
  s_mul_i32 s40, s34, 36864
  s_lshl_b32 s41, s35, 7
  s_add_u32 s40, s40, s41
  s_add_u32 s41, s33, 155648
  s_mov_b32 m0, s41
  s_nop 0
  buffer_load_dwordx4 v21, s[52:55], s40 offen lds
  s_add_u32 s40, s40, 9216
  s_add_u32 s41, s41, 1024
  s_mov_b32 m0, s41
  s_nop 0
  buffer_load_dwordx4 v21, s[52:55], s40 offen lds
  s_add_u32 s40, s40, 9216
  s_add_u32 s41, s41, 1024
  s_mov_b32 m0, s41
  s_nop 0
  buffer_load_dwordx4 v21, s[52:55], s40 offen lds
  s_add_u32 s40, s40, 9216
  s_add_u32 s41, s41, 1024
  s_mov_b32 m0, s41
  s_nop 0
  buffer_load_dwordx4 v21, s[52:55], s40 offen lds
  s_add_u32 s40, s40, 9216
  s_add_u32 s41, s41, 1024
  s_mul_i32 s41, s35, 21846
  s_lshr_b32 s41, s41, 16
  s_mul_i32 s56, s41, 1769472
  s_mul_i32 s41, s41, 3
  s_sub_u32 s41, s35, s41
  s_lshl_b32 s41, s41, 12
  s_add_u32 s56, s56, s41
  s_mul_i32 s41, s34, 12288
  s_add_u32 s56, s56, s41
  s_add_u32 s56, s56, 8036352
  s_mov_b32 s57, 2048
  s_mov_b32 s58, 1
BD_attn1_ke_36:
BGL_attn1_ke_37:
  s_mov_b32 s60, s56
  s_mov_b32 s61, s57
  s_mov_b32 s62, s58
  s_mov_b32 s59, s33
  s_mov_b32 s65, s64
  s_add_u32 s32, s32, 256
  s_xor_b32 s33, s33, 4096
  s_cmp_ge_u32 s32, 2592
  s_cselect_b32 s63, 1, 0
  s_cbranch_scc1 BGX_attn1_ke_39
  s_cmp_ge_u32 s32, 1296
  s_cbranch_scc1 BW2_attn1_ke_40
  s_mul_i32 s34, s32, 58255
  s_lshr_b32 s34, s34, 22
  s_mul_i32 s35, s34, 72
  s_sub_u32 s35, s32, s35
  s_mul_i32 s40, s34, 294912
  s_lshl_b32 s41, s35, 7
  s_add_u32 s40, s40, s41
  s_add_u32 s41, s33, 155648
  s_mov_b32 m0, s41
  s_nop 0
  buffer_load_dwordx4 v20, s[48:51], s40 offen lds
  s_add_u32 s40, s40, 73728
  s_add_u32 s41, s41, 1024
  s_mov_b32 m0, s41
  s_nop 0
  buffer_load_dwordx4 v20, s[48:51], s40 offen lds
  s_add_u32 s40, s40, 73728
  s_add_u32 s41, s41, 1024
  s_mov_b32 m0, s41
  s_nop 0
  buffer_load_dwordx4 v20, s[48:51], s40 offen lds
  s_add_u32 s40, s40, 73728
  s_add_u32 s41, s41, 1024
  s_mov_b32 m0, s41
  s_nop 0
  buffer_load_dwordx4 v20, s[48:51], s40 offen lds
  s_add_u32 s40, s40, 73728
  s_add_u32 s41, s41, 1024
  s_mul_i32 s56, s35, 73728
  s_lshl_b32 s41, s34, 11
  s_add_u32 s56, s56, s41
  s_add_u32 s56, s56, 2727936
  s_mov_b32 s57, 36864
  s_mov_b32 s58, 1
  s_mul_i32 s64, s34, 144
  s_lshl_b32 s41, s35, 1
  s_add_u32 s64, s64, s41
  s_lshl_b32 s64, s64, 7
  s_add_u32 s64, s64, 13344768
  s_branch BD_attn1_ke_41
BW2_attn1_ke_40:
  s_sub_u32 s42, s32, 1296
  s_mul_i32 s34, s42, 7282
  s_lshr_b32 s34, s34, 16
  s_mul_i32 s35, s34, 9
  s_sub_u32 s35, s42, s35
  s_mul_i32 s40, s34, 36864
  s_lshl_b32 s41, s35, 7
  s_add_u32 s40, s40, s41
  s_add_u32 s41, s33, 155648
  s_mov_b32 m0, s41
  s_nop 0
  buffer_load_dwordx4 v21, s[52:55], s40 offen lds
  s_add_u32 s40, s40, 9216
  s_add_u32 s41, s41, 1024
  s_mov_b32 m0, s41
  s_nop 0
  buffer_load_dwordx4 v21, s[52:55], s40 offen lds
  s_add_u32 s40, s40, 9216
  s_add_u32 s41, s41, 1024
  s_mov_b32 m0, s41
  s_nop 0
  buffer_load_dwordx4 v21, s[52:55], s40 offen lds
  s_add_u32 s40, s40, 9216
  s_add_u32 s41, s41, 1024
  s_mov_b32 m0, s41
  s_nop 0
  buffer_load_dwordx4 v21, s[52:55], s40 offen lds
  s_add_u32 s40, s40, 9216
  s_add_u32 s41, s41, 1024
  s_mul_i32 s41, s35, 21846
  s_lshr_b32 s41, s41, 16
  s_mul_i32 s56, s41, 1769472
  s_mul_i32 s41, s41, 3
  s_sub_u32 s41, s35, s41
  s_lshl_b32 s41, s41, 12
  s_add_u32 s56, s56, s41
  s_mul_i32 s41, s34, 12288
  s_add_u32 s56, s56, s41
  s_add_u32 s56, s56, 8036352
  s_mov_b32 s57, 2048
  s_mov_b32 s58, 1
BD_attn1_ke_41:
  s_waitcnt vmcnt(4)
  s_branch BGG_attn1_ke_42
BGX_attn1_ke_39:
  s_waitcnt vmcnt(0)
BGG_attn1_ke_42:
  s_cmp_eq_u32 s62, 1
  s_cbranch_scc1 B16_attn1_ke_43
  v_add_u32 v23, s59, v22
  ds_read_b64_tr_b16 v[24:25], v23 offset:0
  ds_read_b64_tr_b16 v[26:27], v23 offset:512
  ds_read_b64_tr_b16 v[28:29], v23 offset:2048
  ds_read_b64_tr_b16 v[30:31], v23 offset:2560
  ds_read_b64_tr_b16 v[32:33], v23 offset:64
  ds_read_b64_tr_b16 v[34:35], v23 offset:576
  ds_read_b64_tr_b16 v[36:37], v23 offset:2112
  ds_read_b64_tr_b16 v[38:39], v23 offset:2624
  s_waitcnt lgkmcnt(0)
  s_mul_i32 s40, s61, 0
  s_mul_i32 s41, s62, 0
  s_add_u32 s40, s40, s41
  s_add_u32 s40, s40, s60
  buffer_store_dwordx4 v[24:27], v2, s[8:11], s40 offen sc1
  s_mul_i32 s40, s61, 0
  s_mul_i32 s41, s62, 1
  s_add_u32 s40, s40, s41
  s_add_u32 s40, s40, s60
  buffer_store_dwordx4 v[28:31], v2, s[8:11], s40 offen sc1
  s_mul_i32 s40, s61, 1
  s_mul_i32 s41, s62, 0
  s_add_u32 s40, s40, s41
  s_add_u32 s40, s40, s60
  buffer_store_dwordx4 v[32:35], v2, s[8:11], s40 offen sc1
  s_mul_i32 s40, s61, 1
  s_mul_i32 s41, s62, 1
  s_add_u32 s40, s40, s41
  s_add_u32 s40, s40, s60
  buffer_store_dwordx4 v[36:39], v2, s[8:11], s40 offen sc1
  s_branch BNX_attn1_ke_44
B16_attn1_ke_43:
  v_add_u32 v23, s59, v40
  ds_read_b64_tr_b16 v[24:25], v23 offset:0
  ds_read_b64_tr_b16 v[26:27], v23 offset:512
  ds_read_b64_tr_b16 v[28:29], v23 offset:8
  ds_read_b64_tr_b16 v[30:31], v23 offset:520
  ds_read_b64_tr_b16 v[32:33], v23 offset:64
  ds_read_b64_tr_b16 v[34:35], v23 offset:576
  ds_read_b64_tr_b16 v[36:37], v23 offset:72
  ds_read_b64_tr_b16 v[38:39], v23 offset:584
  s_waitcnt lgkmcnt(0)
  s_add_u32 s40, s60, s61
  buffer_store_dwordx4 v[24:27], v2, s[8:11], s60 offen sc1
  buffer_store_dwordx4 v[28:31], v2, s[8:11], s60 offen offset:1024 sc1
  buffer_store_dwordx4 v[32:35], v2, s[8:11], s40 offen sc1
  buffer_store_dwordx4 v[36:39], v2, s[8:11], s40 offen offset:1024 sc1
BNX_attn1_ke_44:
  s_cmp_eq_u32 s63, 0
  s_cbranch_scc1 BGL_attn1_ke_37
  s_endpgm
SK_attn1_ke_34:
  s_lshl_b32 s26, s23, 6
  s_add_u32 s26, s26, s25
  s_lshl_b32 s26, s26, 10
  s_add_u32 s26, s26, 18395136
  buffer_load_dwordx4 v[12:15], v2, s[8:11], s26 offen
  s_lshl_b32 s27, s23, 13
  s_lshl_b32 s28, s25, 7
  s_add_u32 s27, s27, s28
  s_add_u32 s27, s27, 20492288
  v_lshlrev_b32 v6, 2, v8
  buffer_load_dword v16, v6, s[8:11], s27 offen
  v_mov_b32 v3, v2
  v_lshlrev_b32 v4, 2, v8
  v_add_u32 v4, 8192, v4
  v_min_u32 v6, 19, v8
  v_lshlrev_b32 v6, 4, v6
  v_mul_u32_u24 v5, 320, v7
  v_add_u32 v5, v5, v6
  v_add_u32 v5, 9216, v5
  v_mov_b32 v17, 0
  v_mov_b32 v85, 0
  v_mov_b32 v89, 0
  v_mov_b32 v18, 0
  v_mov_b32 v86, 0
  v_mov_b32 v90, 0
  v_mov_b32 v19, 0
  v_mov_b32 v87, 0
  v_mov_b32 v91, 0
  v_mov_b32 v52, 0
  v_mov_b32 v53, 0
  v_mov_b32 v54, 0
  v_mov_b32 v55, 0
  v_mov_b32 v56, 0
  v_mov_b32 v57, 0
  v_mov_b32 v58, 0
  v_mov_b32 v59, 0
  v_mov_b32 v60, 0
  v_mov_b32 v61, 0
  v_mov_b32 v62, 0
  v_mov_b32 v63, 0
  v_mov_b32 v64, 0
  v_mov_b32 v65, 0
  v_mov_b32 v66, 0
  v_mov_b32 v67, 0
  v_mov_b32 v72, 0
  v_mov_b32 v104, 0
  v_mov_b32 v73, 0
  v_mov_b32 v105, 0
  v_mov_b32 v74, 0
  v_mov_b32 v106, 0
  v_mov_b32 v75, 0
  v_mov_b32 v107, 0
  v_cmp_gt_u32 vcc, 32, v1
  s_waitcnt vmcnt(0)
  s_nop 1
  v_cndmask_b32 v16, 0, v16, vcc
  s_barrier
  ds_read_b128 v[76:79], v3 offset:0
  ds_read_b32 v84, v4 offset:0
  ds_read_b128 v[92:95], v5 offset:0
  ds_read_b128 v[80:83], v3 offset:1024
  ds_read_b32 v88, v4 offset:128
  s_waitcnt lgkmcnt(4)
  v_mfma_f32_32x32x16_bf16 v[20:35], v[76:79], v[12:15], 0
  s_waitcnt lgkmcnt(3)
  v_mfma_f32_32x32x8_bf16 v[20:35], v[84:85], v[16:17], v[20:35]
  s_mov_b32 s41, 8
LP_attn1_ke_46:
  s_lshr_b32 s43, s20, 2
  s_xor_b32 s43, s43, 0
  s_cmp_eq_u32 s43, 0
  s_cbranch_scc0 EL_attn1_ke_47
  s_setprio 1
  s_branch EN_attn1_ke_48
EL_attn1_ke_47:
  s_setprio 0
EN_attn1_ke_48:
  s_waitcnt lgkmcnt(1)
  v_mfma_f32_32x32x16_bf16 v[36:51], v[80:83], v[12:15], 0
  ds_read_b128 v[96:99], v5 offset:640
  s_nop 3
  v_exp_f32 v20, v20
  v_exp_f32 v21, v21
  v_exp_f32 v22, v22
  v_exp_f32 v23, v23
  v_mfma_f32_32x32x16_bf16 v[52:67], v[104:107], v[72:75], v[52:67]
  ds_read_b128 v[76:79], v3 offset:2048
  ds_read_b32 v84, v4 offset:256
  v_exp_f32 v24, v24
  v_exp_f32 v25, v25
  v_exp_f32 v26, v26
  v_exp_f32 v27, v27
  v_cvt_pk_bf16_f32 v68, v20, v21
  v_cvt_pk_bf16_f32 v69, v22, v23
  s_waitcnt lgkmcnt(3)
  v_mfma_f32_32x32x8_bf16 v[36:51], v[88:89], v[16:17], v[36:51]
  ds_read_b128 v[100:103], v5 offset:1280
  v_cvt_pk_bf16_f32 v70, v24, v25
  v_cvt_pk_bf16_f32 v71, v26, v27
  v_exp_f32 v28, v28
  v_exp_f32 v29, v29
  v_exp_f32 v30, v30
  v_exp_f32 v31, v31
  s_waitcnt lgkmcnt(4)
  v_mfma_f32_32x32x16_bf16 v[52:67], v[92:95], v[68:71], v[52:67]
  v_exp_f32 v32, v32
  v_exp_f32 v33, v33
  v_exp_f32 v34, v34
  v_exp_f32 v35, v35
  v_cvt_pk_bf16_f32 v72, v28, v29
  v_cvt_pk_bf16_f32 v73, v30, v31
  v_cvt_pk_bf16_f32 v74, v32, v33
  v_cvt_pk_bf16_f32 v75, v34, v35
  s_waitcnt lgkmcnt(2)
  v_mfma_f32_32x32x16_bf16 v[20:35], v[76:79], v[12:15], 0
  ds_read_b128 v[104:107], v5 offset:1920
  v_exp_f32 v36, v36
  v_exp_f32 v37, v37
  v_exp_f32 v38, v38
  v_exp_f32 v39, v39
  v_mfma_f32_32x32x16_bf16 v[52:67], v[96:99], v[72:75], v[52:67]
  ds_read_b128 v[80:83], v3 offset:3072
  ds_read_b32 v88, v4 offset:384
  v_exp_f32 v40, v40
  v_exp_f32 v41, v41
  v_exp_f32 v42, v42
  v_exp_f32 v43, v43
  v_cvt_pk_bf16_f32 v68, v36, v37
  v_cvt_pk_bf16_f32 v69, v38, v39
  s_waitcnt lgkmcnt(4)
  v_mfma_f32_32x32x8_bf16 v[20:35], v[84:85], v[16:17], v[20:35]
  ds_read_b128 v[92:95], v5 offset:2560
  v_cvt_pk_bf16_f32 v70, v40, v41
  v_cvt_pk_bf16_f32 v71, v42, v43
  v_exp_f32 v44, v44
  v_exp_f32 v45, v45
  v_exp_f32 v46, v46
  v_exp_f32 v47, v47
  s_waitcnt lgkmcnt(4)
  v_mfma_f32_32x32x16_bf16 v[52:67], v[100:103], v[68:71], v[52:67]
  v_exp_f32 v48, v48
  v_exp_f32 v49, v49
  v_exp_f32 v50, v50
  v_exp_f32 v51, v51
  v_cvt_pk_bf16_f32 v72, v44, v45
  v_cvt_pk_bf16_f32 v73, v46, v47
  v_cvt_pk_bf16_f32 v74, v48, v49
  v_cvt_pk_bf16_f32 v75, v50, v51
  s_waitcnt lgkmcnt(2)
  v_mfma_f32_32x32x16_bf16 v[36:51], v[80:83], v[12:15], 0
  ds_read_b128 v[96:99], v5 offset:3200
  v_exp_f32 v20, v20
  v_exp_f32 v21, v21
  v_exp_f32 v22, v22
  v_exp_f32 v23, v23
  v_mfma_f32_32x32x16_bf16 v[52:67], v[104:107], v[72:75], v[52:67]
  ds_read_b128 v[76:79], v3 offset:4096
  ds_read_b32 v84, v4 offset:512
  v_exp_f32 v24, v24
  v_exp_f32 v25, v25
  v_exp_f32 v26, v26
  v_exp_f32 v27, v27
  v_cvt_pk_bf16_f32 v68, v20, v21
  v_cvt_pk_bf16_f32 v69, v22, v23
  s_waitcnt lgkmcnt(4)
  v_mfma_f32_32x32x8_bf16 v[36:51], v[88:89], v[16:17], v[36:51]
  ds_read_b128 v[100:103], v5 offset:3840
  v_cvt_pk_bf16_f32 v70, v24, v25
  v_cvt_pk_bf16_f32 v71, v26, v27
  v_exp_f32 v28, v28
  v_exp_f32 v29, v29
  v_exp_f32 v30, v30
  v_exp_f32 v31, v31
  s_waitcnt lgkmcnt(4)
  v_mfma_f32_32x32x16_bf16 v[52:67], v[92:95], v[68:71], v[52:67]
  v_exp_f32 v32, v32
  v_exp_f32 v33, v33
  v_exp_f32 v34, v34
  v_exp_f32 v35, v35
  v_cvt_pk_bf16_f32 v72, v28, v29
  v_cvt_pk_bf16_f32 v73, v30, v31
  v_cvt_pk_bf16_f32 v74, v32, v33
  v_cvt_pk_bf16_f32 v75, v34, v35
  s_waitcnt lgkmcnt(2)
  v_mfma_f32_32x32x16_bf16 v[20:35], v[76:79], v[12:15], 0
  ds_read_b128 v[104:107], v5 offset:4480
  v_exp_f32 v36, v36
  v_exp_f32 v37, v37
  v_exp_f32 v38, v38
  v_exp_f32 v39, v39
  v_mfma_f32_32x32x16_bf16 v[52:67], v[96:99], v[72:75], v[52:67]
  ds_read_b128 v[80:83], v3 offset:5120
  ds_read_b32 v88, v4 offset:640
  v_exp_f32 v40, v40
  v_exp_f32 v41, v41
  v_exp_f32 v42, v42
  v_exp_f32 v43, v43
  v_cvt_pk_bf16_f32 v68, v36, v37
  v_cvt_pk_bf16_f32 v69, v38, v39
  s_waitcnt lgkmcnt(4)
  v_mfma_f32_32x32x8_bf16 v[20:35], v[84:85], v[16:17], v[20:35]
  ds_read_b128 v[92:95], v5 offset:5120
  v_cvt_pk_bf16_f32 v70, v40, v41
  v_cvt_pk_bf16_f32 v71, v42, v43
  v_exp_f32 v44, v44
  v_exp_f32 v45, v45
  v_exp_f32 v46, v46
  v_exp_f32 v47, v47
  s_waitcnt lgkmcnt(4)
  v_mfma_f32_32x32x16_bf16 v[52:67], v[100:103], v[68:71], v[52:67]
  v_exp_f32 v48, v48
  v_exp_f32 v49, v49
  v_exp_f32 v50, v50
  v_exp_f32 v51, v51
  v_cvt_pk_bf16_f32 v72, v44, v45
  v_cvt_pk_bf16_f32 v73, v46, v47
  v_cvt_pk_bf16_f32 v74, v48, v49
  v_cvt_pk_bf16_f32 v75, v50, v51
  s_lshr_b32 s43, s20, 2
  s_xor_b32 s43, s43, 1
  s_cmp_eq_u32 s43, 0
  s_cbranch_scc0 EL_attn1_ke_49
  s_setprio 1
  s_branch EN_attn1_ke_50
EL_attn1_ke_49:
  s_setprio 0
EN_attn1_ke_50:
  s_waitcnt lgkmcnt(2)
  v_mfma_f32_32x32x16_bf16 v[36:51], v[80:83], v[12:15], 0
  ds_read_b128 v[96:99], v5 offset:5760
  v_exp_f32 v20, v20
  v_exp_f32 v21, v21
  v_exp_f32 v22, v22
  v_exp_f32 v23, v23
  v_mfma_f32_32x32x16_bf16 v[52:67], v[104:107], v[72:75], v[52:67]
  ds_read_b128 v[76:79], v3 offset:6144
  ds_read_b32 v84, v4 offset:768
  v_exp_f32 v24, v24
  v_exp_f32 v25, v25
  v_exp_f32 v26, v26
  v_exp_f32 v27, v27
  v_cvt_pk_bf16_f32 v68, v20, v21
  v_cvt_pk_bf16_f32 v69, v22, v23
  s_waitcnt lgkmcnt(4)
  v_mfma_f32_32x32x8_bf16 v[36:51], v[88:89], v[16:17], v[36:51]
  ds_read_b128 v[100:103], v5 offset:6400
  v_cvt_pk_bf16_f32 v70, v24, v25
  v_cvt_pk_bf16_f32 v71, v26, v27
  v_exp_f32 v28, v28
  v_exp_f32 v29, v29
  v_exp_f32 v30, v30
  v_exp_f32 v31, v31
  s_waitcnt lgkmcnt(4)
  v_mfma_f32_32x32x16_bf16 v[52:67], v[92:95], v[68:71], v[52:67]
  v_exp_f32 v32, v32
  v_exp_f32 v33, v33
  v_exp_f32 v34, v34
  v_exp_f32 v35, v35
  v_cvt_pk_bf16_f32 v72, v28, v29
  v_cvt_pk_bf16_f32 v73, v30, v31
  v_cvt_pk_bf16_f32 v74, v32, v33
  v_cvt_pk_bf16_f32 v75, v34, v35
  s_waitcnt lgkmcnt(2)
  v_mfma_f32_32x32x16_bf16 v[20:35], v[76:79], v[12:15], 0
  ds_read_b128 v[104:107], v5 offset:7040
  v_exp_f32 v36, v36
  v_exp_f32 v37, v37
  v_exp_f32 v38, v38
  v_exp_f32 v39, v39
  v_mfma_f32_32x32x16_bf16 v[52:67], v[96:99], v[72:75], v[52:67]
  ds_read_b128 v[80:83], v3 offset:7168
  ds_read_b32 v88, v4 offset:896
  v_exp_f32 v40, v40
  v_exp_f32 v41, v41
  v_exp_f32 v42, v42
  v_exp_f32 v43, v43
  v_cvt_pk_bf16_f32 v68, v36, v37
  v_cvt_pk_bf16_f32 v69, v38, v39
  s_waitcnt lgkmcnt(4)
  v_mfma_f32_32x32x8_bf16 v[20:35], v[84:85], v[16:17], v[20:35]
  ds_read_b128 v[92:95], v5 offset:7680
  v_cvt_pk_bf16_f32 v70, v40, v41
  v_cvt_pk_bf16_f32 v71, v42, v43
  v_exp_f32 v44, v44
  v_exp_f32 v45, v45
  v_exp_f32 v46, v46
  v_exp_f32 v47, v47
  s_waitcnt lgkmcnt(4)
  v_mfma_f32_32x32x16_bf16 v[52:67], v[100:103], v[68:71], v[52:67]
  v_exp_f32 v48, v48
  v_exp_f32 v49, v49
  v_exp_f32 v50, v50
  v_exp_f32 v51, v51
  v_cvt_pk_bf16_f32 v72, v44, v45
  v_cvt_pk_bf16_f32 v73, v46, v47
  v_cvt_pk_bf16_f32 v74, v48, v49
  v_cvt_pk_bf16_f32 v75, v50, v51
  s_cmp_lg_u32 s41, 8
  s_cbranch_scc1 SK_attn1_ke_51
  s_barrier
SK_attn1_ke_51:
  s_waitcnt lgkmcnt(2)
  v_mfma_f32_32x32x16_bf16 v[36:51], v[80:83], v[12:15], 0
  ds_read_b128 v[96:99], v5 offset:8320
  v_exp_f32 v20, v20
  v_exp_f32 v21, v21
  v_exp_f32 v22, v22
  v_exp_f32 v23, v23
  v_mfma_f32_32x32x16_bf16 v[52:67], v[104:107], v[72:75], v[52:67]
  ds_read_b128 v[76:79], v3 offset:19456
  ds_read_b32 v84, v4 offset:19456
  v_exp_f32 v24, v24
  v_exp_f32 v25, v25
  v_exp_f32 v26, v26
  v_exp_f32 v27, v27
  v_cvt_pk_bf16_f32 v68, v20, v21
  v_cvt_pk_bf16_f32 v69, v22, v23
  s_waitcnt lgkmcnt(4)
  v_mfma_f32_32x32x8_bf16 v[36:51], v[88:89], v[16:17], v[36:51]
  ds_read_b128 v[100:103], v5 offset:8960
  v_cvt_pk_bf16_f32 v70, v24, v25
  v_cvt_pk_bf16_f32 v71, v26, v27
  v_exp_f32 v28, v28
  v_exp_f32 v29, v29
  v_exp_f32 v30, v30
  v_exp_f32 v31, v31
  s_waitcnt lgkmcnt(4)
  v_mfma_f32_32x32x16_bf16 v[52:67], v[92:95], v[68:71], v[52:67]
  v_exp_f32 v32, v32
  v_exp_f32 v33, v33
  v_exp_f32 v34, v34
  v_exp_f32 v35, v35
  v_cvt_pk_bf16_f32 v72, v28, v29
  v_cvt_pk_bf16_f32 v73, v30, v31
  v_cvt_pk_bf16_f32 v74, v32, v33
  v_cvt_pk_bf16_f32 v75, v34, v35
  s_waitcnt lgkmcnt(2)
  v_mfma_f32_32x32x16_bf16 v[20:35], v[76:79], v[12:15], 0
  ds_read_b128 v[104:107], v5 offset:9600
  v_exp_f32 v36, v36
  v_exp_f32 v37, v37
  v_exp_f32 v38, v38
  v_exp_f32 v39, v39
  v_mfma_f32_32x32x16_bf16 v[52:67], v[96:99], v[72:75], v[52:67]
  ds_read_b128 v[80:83], v3 offset:20480
  ds_read_b32 v88, v4 offset:19584
  v_exp_f32 v40, v40
  v_exp_f32 v41, v41
  v_exp_f32 v42, v42
  v_exp_f32 v43, v43
  v_cvt_pk_bf16_f32 v68, v36, v37
  v_cvt_pk_bf16_f32 v69, v38, v39
  s_waitcnt lgkmcnt(4)
  v_mfma_f32_32x32x8_bf16 v[20:35], v[84:85], v[16:17], v[20:35]
  ds_read_b128 v[92:95], v5 offset:19456
  v_cvt_pk_bf16_f32 v70, v40, v41
  v_cvt_pk_bf16_f32 v71, v42, v43
  v_exp_f32 v44, v44
  v_exp_f32 v45, v45
  v_exp_f32 v46, v46
  v_exp_f32 v47, v47
  s_waitcnt lgkmcnt(4)
  v_mfma_f32_32x32x16_bf16 v[52:67], v[100:103], v[68:71], v[52:67]
  v_exp_f32 v48, v48
  v_exp_f32 v49, v49
  v_exp_f32 v50, v50
  v_exp_f32 v51, v51
  v_cvt_pk_bf16_f32 v72, v44, v45
  v_cvt_pk_bf16_f32 v73, v46, v47
  v_cvt_pk_bf16_f32 v74, v48, v49
  v_cvt_pk_bf16_f32 v75, v50, v51
  v_add_u32 v3, 19456, v3
  v_add_u32 v4, 19456, v4
  v_add_u32 v5, 19456, v5
  s_sub_u32 s41, s41, 1
  s_cmp_lg_u32 s41, 0
  s_cbranch_scc1 LP_attn1_ke_46
  s_waitcnt lgkmcnt(3)
  v_mfma_f32_32x32x16_bf16 v[52:67], v[104:107], v[72:75], v[52:67]
  s_nop 11
  v_mov_b32 v108, v62
  v_mov_b32 v109, v62
  s_nop 1
  v_permlane32_swap_b32 v108, v109
  v_cmp_le_f32 vcc, 0x2b800000, v108
  s_mov_b32 s46, 0x5d800000
  v_cmp_le_f32 s[44:45], v108, s46
  s_nop 3
  s_and_b64 vcc, vcc, s[44:45]
  v_max3_f32 v110, abs(v52), abs(v53), abs(v54)
  v_max3_f32 v110, abs(v55), abs(v56), v110
  v_max3_f32 v110, abs(v57), abs(v58), v110
  v_max3_f32 v110, abs(v59), v110, v110
  v_max3_f32 v110, abs(v60), abs(v61), v110
  s_mov_b32 s46, 0x7b800000
  v_cmp_le_f32 s[44:45], v110, s46
  s_nop 3
  s_and_b64 vcc, vcc, s[44:45]
  s_cmp_eq_u64 vcc, -1
  s_cbranch_scc1 SK_attn1_ke_52
  v_mov_b32 v111, 0xff800000
  v_mov_b32 v52, 0
  v_mov_b32 v53, 0
  v_mov_b32 v54, 0
  v_mov_b32 v55, 0
  v_mov_b32 v56, 0
  v_mov_b32 v57, 0
  v_mov_b32 v58, 0
  v_mov_b32 v59, 0
  v_mov_b32 v60, 0
  v_mov_b32 v61, 0
  v_mov_b32 v62, 0
  v_mov_b32 v63, 0
  v_mov_b32 v64, 0
  v_mov_b32 v65, 0
  v_mov_b32 v66, 0
  v_mov_b32 v67, 0
  v_subrev_u32 v3, 155648, v3
  v_subrev_u32 v4, 155648, v4
  v_subrev_u32 v5, 155648, v5
  s_mov_b32 s41, 8
LP_attn1_ke_53:
  ds_read_b128 v[76:79], v3 offset:0
  ds_read_b32 v84, v4 offset:0
  s_waitcnt lgkmcnt(2)
  ds_read_b128 v[92:95], v5 offset:0
  ds_read_b128 v[96:99], v5 offset:640
  s_waitcnt lgkmcnt(3)
  v_mfma_f32_32x32x16_bf16 v[20:35], v[76:79], v[12:15], 0
  s_waitcnt lgkmcnt(2)
  v_mfma_f32_32x32x16_bf16 v[20:35], v[84:87], v[16:19], v[20:35]
  s_nop 11
  v_max3_f32 v112, v20, v21, v111
  v_max3_f32 v112, v22, v23, v112
  v_max3_f32 v112, v24, v25, v112
  v_max3_f32 v112, v26, v27, v112
  v_max3_f32 v112, v28, v29, v112
  v_max3_f32 v112, v30, v31, v112
  v_max3_f32 v112, v32, v33, v112
  v_max3_f32 v112, v34, v35, v112
  v_mov_b32 v113, v112
  s_nop 1
  v_permlane32_swap_b32 v113, v112
  v_max_f32 v112, v112, v113
  v_sub_f32 v113, v111, v112
  v_exp_f32 v113, v113
  v_mov_b32 v111, v112
  v_sub_f32 v20, v20, v112
  v_exp_f32 v20, v20
  v_mul_f32 v52, v52, v113
  v_sub_f32 v21, v21, v112
  v_exp_f32 v21, v21
  v_mul_f32 v53, v53, v113
  v_sub_f32 v22, v22, v112
  v_exp_f32 v22, v22
  v_mul_f32 v54, v54, v113
  v_sub_f32 v23, v23, v112
  v_exp_f32 v23, v23
  v_mul_f32 v55, v55, v113
  v_sub_f32 v24, v24, v112
  v_exp_f32 v24, v24
  v_mul_f32 v56, v56, v113
  v_sub_f32 v25, v25, v112
  v_exp_f32 v25, v25
  v_mul_f32 v57, v57, v113
  v_sub_f32 v26, v26, v112
  v_exp_f32 v26, v26
  v_mul_f32 v58, v58, v113
  v_sub_f32 v27, v27, v112
  v_exp_f32 v27, v27
  v_mul_f32 v59, v59, v113
  v_sub_f32 v28, v28, v112
  v_exp_f32 v28, v28
  v_mul_f32 v60, v60, v113
  v_sub_f32 v29, v29, v112
  v_exp_f32 v29, v29
  v_mul_f32 v61, v61, v113
  v_sub_f32 v30, v30, v112
  v_exp_f32 v30, v30
  v_mul_f32 v62, v62, v113
  v_sub_f32 v31, v31, v112
  v_exp_f32 v31, v31
  v_mul_f32 v63, v63, v113
  v_sub_f32 v32, v32, v112
  v_exp_f32 v32, v32
  v_mul_f32 v64, v64, v113
  v_sub_f32 v33, v33, v112
  v_exp_f32 v33, v33
  v_mul_f32 v65, v65, v113
  v_sub_f32 v34, v34, v112
  v_exp_f32 v34, v34
  v_mul_f32 v66, v66, v113
  v_sub_f32 v35, v35, v112
  v_exp_f32 v35, v35
  v_mul_f32 v67, v67, v113
  v_cvt_pk_bf16_f32 v68, v20, v21
  v_cvt_pk_bf16_f32 v69, v22, v23
  v_cvt_pk_bf16_f32 v70, v24, v25
  v_cvt_pk_bf16_f32 v71, v26, v27
  v_cvt_pk_bf16_f32 v72, v28, v29
  v_cvt_pk_bf16_f32 v73, v30, v31
  v_cvt_pk_bf16_f32 v74, v32, v33
  v_cvt_pk_bf16_f32 v75, v34, v35
  s_waitcnt lgkmcnt(1)
  v_mfma_f32_32x32x16_bf16 v[52:67], v[92:95], v[68:71], v[52:67]
  s_waitcnt lgkmcnt(0)
  s_nop 0
  v_mfma_f32_32x32x16_bf16 v[52:67], v[96:99], v[72:75], v[52:67]
  ds_read_b128 v[76:79], v3 offset:1024
  ds_read_b32 v84, v4 offset:128
  ds_read_b128 v[92:95], v5 offset:1280
  ds_read_b128 v[96:99], v5 offset:1920
  s_waitcnt lgkmcnt(3)
  v_mfma_f32_32x32x16_bf16 v[20:35], v[76:79], v[12:15], 0
  s_waitcnt lgkmcnt(2)
  v_mfma_f32_32x32x16_bf16 v[20:35], v[84:87], v[16:19], v[20:35]
  s_nop 11
  v_max3_f32 v112, v20, v21, v111
  v_max3_f32 v112, v22, v23, v112
  v_max3_f32 v112, v24, v25, v112
  v_max3_f32 v112, v26, v27, v112
  v_max3_f32 v112, v28, v29, v112
  v_max3_f32 v112, v30, v31, v112
  v_max3_f32 v112, v32, v33, v112
  v_max3_f32 v112, v34, v35, v112
  v_mov_b32 v113, v112
  s_nop 1
  v_permlane32_swap_b32 v113, v112
  v_max_f32 v112, v112, v113
  v_sub_f32 v113, v111, v112
  v_exp_f32 v113, v113
  v_mov_b32 v111, v112
  v_sub_f32 v20, v20, v112
  v_exp_f32 v20, v20
  v_mul_f32 v52, v52, v113
  v_sub_f32 v21, v21, v112
  v_exp_f32 v21, v21
  v_mul_f32 v53, v53, v113
  v_sub_f32 v22, v22, v112
  v_exp_f32 v22, v22
  v_mul_f32 v54, v54, v113
  v_sub_f32 v23, v23, v112
  v_exp_f32 v23, v23
  v_mul_f32 v55, v55, v113
  v_sub_f32 v24, v24, v112
  v_exp_f32 v24, v24
  v_mul_f32 v56, v56, v113
  v_sub_f32 v25, v25, v112
  v_exp_f32 v25, v25
  v_mul_f32 v57, v57, v113
  v_sub_f32 v26, v26, v112
  v_exp_f32 v26, v26
  v_mul_f32 v58, v58, v113
  v_sub_f32 v27, v27, v112
  v_exp_f32 v27, v27
  v_mul_f32 v59, v59, v113
  v_sub_f32 v28, v28, v112
  v_exp_f32 v28, v28
  v_mul_f32 v60, v60, v113
  v_sub_f32 v29, v29, v112
  v_exp_f32 v29, v29
  v_mul_f32 v61, v61, v113
  v_sub_f32 v30, v30, v112
  v_exp_f32 v30, v30
  v_mul_f32 v62, v62, v113
  v_sub_f32 v31, v31, v112
  v_exp_f32 v31, v31
  v_mul_f32 v63, v63, v113
  v_sub_f32 v32, v32, v112
  v_exp_f32 v32, v32
  v_mul_f32 v64, v64, v113
  v_sub_f32 v33, v33, v112
  v_exp_f32 v33, v33
  v_mul_f32 v65, v65, v113
  v_sub_f32 v34, v34, v112
  v_exp_f32 v34, v34
  v_mul_f32 v66, v66, v113
  v_sub_f32 v35, v35, v112
  v_exp_f32 v35, v35
  v_mul_f32 v67, v67, v113
  v_cvt_pk_bf16_f32 v68, v20, v21
  v_cvt_pk_bf16_f32 v69, v22, v23
  v_cvt_pk_bf16_f32 v70, v24, v25
  v_cvt_pk_bf16_f32 v71, v26, v27
  v_cvt_pk_bf16_f32 v72, v28, v29
  v_cvt_pk_bf16_f32 v73, v30, v31
  v_cvt_pk_bf16_f32 v74, v32, v33
  v_cvt_pk_bf16_f32 v75, v34, v35
  s_waitcnt lgkmcnt(1)
  v_mfma_f32_32x32x16_bf16 v[52:67], v[92:95], v[68:71], v[52:67]
  s_waitcnt lgkmcnt(0)
  s_nop 0
  v_mfma_f32_32x32x16_bf16 v[52:67], v[96:99], v[72:75], v[52:67]
  ds_read_b128 v[76:79], v3 offset:2048
  ds_read_b32 v84, v4 offset:256
  ds_read_b128 v[92:95], v5 offset:2560
  ds_read_b128 v[96:99], v5 offset:3200
  s_waitcnt lgkmcnt(3)
  v_mfma_f32_32x32x16_bf16 v[20:35], v[76:79], v[12:15], 0
  s_waitcnt lgkmcnt(2)
  v_mfma_f32_32x32x16_bf16 v[20:35], v[84:87], v[16:19], v[20:35]
  s_nop 11
  v_max3_f32 v112, v20, v21, v111
  v_max3_f32 v112, v22, v23, v112
  v_max3_f32 v112, v24, v25, v112
  v_max3_f32 v112, v26, v27, v112
  v_max3_f32 v112, v28, v29, v112
  v_max3_f32 v112, v30, v31, v112
  v_max3_f32 v112, v32, v33, v112
  v_max3_f32 v112, v34, v35, v112
  v_mov_b32 v113, v112
  s_nop 1
  v_permlane32_swap_b32 v113, v112
  v_max_f32 v112, v112, v113
  v_sub_f32 v113, v111, v112
  v_exp_f32 v113, v113
  v_mov_b32 v111, v112
  v_sub_f32 v20, v20, v112
  v_exp_f32 v20, v20
  v_mul_f32 v52, v52, v113
  v_sub_f32 v21, v21, v112
  v_exp_f32 v21, v21
  v_mul_f32 v53, v53, v113
  v_sub_f32 v22, v22, v112
  v_exp_f32 v22, v22
  v_mul_f32 v54, v54, v113
  v_sub_f32 v23, v23, v112
  v_exp_f32 v23, v23
  v_mul_f32 v55, v55, v113
  v_sub_f32 v24, v24, v112
  v_exp_f32 v24, v24
  v_mul_f32 v56, v56, v113
  v_sub_f32 v25, v25, v112
  v_exp_f32 v25, v25
  v_mul_f32 v57, v57, v113
  v_sub_f32 v26, v26, v112
  v_exp_f32 v26, v26
  v_mul_f32 v58, v58, v113
  v_sub_f32 v27, v27, v112
  v_exp_f32 v27, v27
  v_mul_f32 v59, v59, v113
  v_sub_f32 v28, v28, v112
  v_exp_f32 v28, v28
  v_mul_f32 v60, v60, v113
  v_sub_f32 v29, v29, v112
  v_exp_f32 v29, v29
  v_mul_f32 v61, v61, v113
  v_sub_f32 v30, v30, v112
  v_exp_f32 v30, v30
  v_mul_f32 v62, v62, v113
  v_sub_f32 v31, v31, v112
  v_exp_f32 v31, v31
  v_mul_f32 v63, v63, v113
  v_sub_f32 v32, v32, v112
  v_exp_f32 v32, v32
  v_mul_f32 v64, v64, v113
  v_sub_f32 v33, v33, v112
  v_exp_f32 v33, v33
  v_mul_f32 v65, v65, v113
  v_sub_f32 v34, v34, v112
  v_exp_f32 v34, v34
  v_mul_f32 v66, v66, v113
  v_sub_f32 v35, v35, v112
  v_exp_f32 v35, v35
  v_mul_f32 v67, v67, v113
  v_cvt_pk_bf16_f32 v68, v20, v21
  v_cvt_pk_bf16_f32 v69, v22, v23
  v_cvt_pk_bf16_f32 v70, v24, v25
  v_cvt_pk_bf16_f32 v71, v26, v27
  v_cvt_pk_bf16_f32 v72, v28, v29
  v_cvt_pk_bf16_f32 v73, v30, v31
  v_cvt_pk_bf16_f32 v74, v32, v33
  v_cvt_pk_bf16_f32 v75, v34, v35
  s_waitcnt lgkmcnt(1)
  v_mfma_f32_32x32x16_bf16 v[52:67], v[92:95], v[68:71], v[52:67]
  s_waitcnt lgkmcnt(0)
  s_nop 0
  v_mfma_f32_32x32x16_bf16 v[52:67], v[96:99], v[72:75], v[52:67]
  ds_read_b128 v[76:79], v3 offset:3072
  ds_read_b32 v84, v4 offset:384
  ds_read_b128 v[92:95], v5 offset:3840
  ds_read_b128 v[96:99], v5 offset:4480
  s_waitcnt lgkmcnt(3)
  v_mfma_f32_32x32x16_bf16 v[20:35], v[76:79], v[12:15], 0
  s_waitcnt lgkmcnt(2)
  v_mfma_f32_32x32x16_bf16 v[20:35], v[84:87], v[16:19], v[20:35]
  s_nop 11
  v_max3_f32 v112, v20, v21, v111
  v_max3_f32 v112, v22, v23, v112
  v_max3_f32 v112, v24, v25, v112
  v_max3_f32 v112, v26, v27, v112
  v_max3_f32 v112, v28, v29, v112
  v_max3_f32 v112, v30, v31, v112
  v_max3_f32 v112, v32, v33, v112
  v_max3_f32 v112, v34, v35, v112
  v_mov_b32 v113, v112
  s_nop 1
  v_permlane32_swap_b32 v113, v112
  v_max_f32 v112, v112, v113
  v_sub_f32 v113, v111, v112
  v_exp_f32 v113, v113
  v_mov_b32 v111, v112
  v_sub_f32 v20, v20, v112
  v_exp_f32 v20, v20
  v_mul_f32 v52, v52, v113
  v_sub_f32 v21, v21, v112
  v_exp_f32 v21, v21
  v_mul_f32 v53, v53, v113
  v_sub_f32 v22, v22, v112
  v_exp_f32 v22, v22
  v_mul_f32 v54, v54, v113
  v_sub_f32 v23, v23, v112
  v_exp_f32 v23, v23
  v_mul_f32 v55, v55, v113
  v_sub_f32 v24, v24, v112
  v_exp_f32 v24, v24
  v_mul_f32 v56, v56, v113
  v_sub_f32 v25, v25, v112
  v_exp_f32 v25, v25
  v_mul_f32 v57, v57, v113
  v_sub_f32 v26, v26, v112
  v_exp_f32 v26, v26
  v_mul_f32 v58, v58, v113
  v_sub_f32 v27, v27, v112
  v_exp_f32 v27, v27
  v_mul_f32 v59, v59, v113
  v_sub_f32 v28, v28, v112
  v_exp_f32 v28, v28
  v_mul_f32 v60, v60, v113
  v_sub_f32 v29, v29, v112
  v_exp_f32 v29, v29
  v_mul_f32 v61, v61, v113
  v_sub_f32 v30, v30, v112
  v_exp_f32 v30, v30
  v_mul_f32 v62, v62, v113
  v_sub_f32 v31, v31, v112
  v_exp_f32 v31, v31
  v_mul_f32 v63, v63, v113
  v_sub_f32 v32, v32, v112
  v_exp_f32 v32, v32
  v_mul_f32 v64, v64, v113
  v_sub_f32 v33, v33, v112
  v_exp_f32 v33, v33
  v_mul_f32 v65, v65, v113
  v_sub_f32 v34, v34, v112
  v_exp_f32 v34, v34
  v_mul_f32 v66, v66, v113
  v_sub_f32 v35, v35, v112
  v_exp_f32 v35, v35
  v_mul_f32 v67, v67, v113
  v_cvt_pk_bf16_f32 v68, v20, v21
  v_cvt_pk_bf16_f32 v69, v22, v23
  v_cvt_pk_bf16_f32 v70, v24, v25
  v_cvt_pk_bf16_f32 v71, v26, v27
  v_cvt_pk_bf16_f32 v72, v28, v29
  v_cvt_pk_bf16_f32 v73, v30, v31
  v_cvt_pk_bf16_f32 v74, v32, v33
  v_cvt_pk_bf16_f32 v75, v34, v35
  s_waitcnt lgkmcnt(1)
  v_mfma_f32_32x32x16_bf16 v[52:67], v[92:95], v[68:71], v[52:67]
  s_waitcnt lgkmcnt(0)
  s_nop 0
  v_mfma_f32_32x32x16_bf16 v[52:67], v[96:99], v[72:75], v[52:67]
  ds_read_b128 v[76:79], v3 offset:4096
  ds_read_b32 v84, v4 offset:512
  ds_read_b128 v[92:95], v5 offset:5120
  ds_read_b128 v[96:99], v5 offset:5760
  s_waitcnt lgkmcnt(3)
  v_mfma_f32_32x32x16_bf16 v[20:35], v[76:79], v[12:15], 0
  s_waitcnt lgkmcnt(2)
  v_mfma_f32_32x32x16_bf16 v[20:35], v[84:87], v[16:19], v[20:35]
  s_nop 11
  v_max3_f32 v112, v20, v21, v111
  v_max3_f32 v112, v22, v23, v112
  v_max3_f32 v112, v24, v25, v112
  v_max3_f32 v112, v26, v27, v112
  v_max3_f32 v112, v28, v29, v112
  v_max3_f32 v112, v30, v31, v112
  v_max3_f32 v112, v32, v33, v112
  v_max3_f32 v112, v34, v35, v112
  v_mov_b32 v113, v112
  s_nop 1
  v_permlane32_swap_b32 v113, v112
  v_max_f32 v112, v112, v113
  v_sub_f32 v113, v111, v112
  v_exp_f32 v113, v113
  v_mov_b32 v111, v112
  v_sub_f32 v20, v20, v112
  v_exp_f32 v20, v20
  v_mul_f32 v52, v52, v113
  v_sub_f32 v21, v21, v112
  v_exp_f32 v21, v21
  v_mul_f32 v53, v53, v113
  v_sub_f32 v22, v22, v112
  v_exp_f32 v22, v22
  v_mul_f32 v54, v54, v113
  v_sub_f32 v23, v23, v112
  v_exp_f32 v23, v23
  v_mul_f32 v55, v55, v113
  v_sub_f32 v24, v24, v112
  v_exp_f32 v24, v24
  v_mul_f32 v56, v56, v113
  v_sub_f32 v25, v25, v112
  v_exp_f32 v25, v25
  v_mul_f32 v57, v57, v113
  v_sub_f32 v26, v26, v112
  v_exp_f32 v26, v26
  v_mul_f32 v58, v58, v113
  v_sub_f32 v27, v27, v112
  v_exp_f32 v27, v27
  v_mul_f32 v59, v59, v113
  v_sub_f32 v28, v28, v112
  v_exp_f32 v28, v28
  v_mul_f32 v60, v60, v113
  v_sub_f32 v29, v29, v112
  v_exp_f32 v29, v29
  v_mul_f32 v61, v61, v113
  v_sub_f32 v30, v30, v112
  v_exp_f32 v30, v30
  v_mul_f32 v62, v62, v113
  v_sub_f32 v31, v31, v112
  v_exp_f32 v31, v31
  v_mul_f32 v63, v63, v113
  v_sub_f32 v32, v32, v112
  v_exp_f32 v32, v32
  v_mul_f32 v64, v64, v113
  v_sub_f32 v33, v33, v112
  v_exp_f32 v33, v33
  v_mul_f32 v65, v65, v113
  v_sub_f32 v34, v34, v112
  v_exp_f32 v34, v34
  v_mul_f32 v66, v66, v113
  v_sub_f32 v35, v35, v112
  v_exp_f32 v35, v35
  v_mul_f32 v67, v67, v113
  v_cvt_pk_bf16_f32 v68, v20, v21
  v_cvt_pk_bf16_f32 v69, v22, v23
  v_cvt_pk_bf16_f32 v70, v24, v25
  v_cvt_pk_bf16_f32 v71, v26, v27
  v_cvt_pk_bf16_f32 v72, v28, v29
  v_cvt_pk_bf16_f32 v73, v30, v31
  v_cvt_pk_bf16_f32 v74, v32, v33
  v_cvt_pk_bf16_f32 v75, v34, v35
  s_waitcnt lgkmcnt(1)
  v_mfma_f32_32x32x16_bf16 v[52:67], v[92:95], v[68:71], v[52:67]
  s_waitcnt lgkmcnt(0)
  s_nop 0
  v_mfma_f32_32x32x16_bf16 v[52:67], v[96:99], v[72:75], v[52:67]
  ds_read_b128 v[76:79], v3 offset:5120
  ds_read_b32 v84, v4 offset:640
  ds_read_b128 v[92:95], v5 offset:6400
  ds_read_b128 v[96:99], v5 offset:7040
  s_waitcnt lgkmcnt(3)
  v_mfma_f32_32x32x16_bf16 v[20:35], v[76:79], v[12:15], 0
  s_waitcnt lgkmcnt(2)
  v_mfma_f32_32x32x16_bf16 v[20:35], v[84:87], v[16:19], v[20:35]
  s_nop 11
  v_max3_f32 v112, v20, v21, v111
  v_max3_f32 v112, v22, v23, v112
  v_max3_f32 v112, v24, v25, v112
  v_max3_f32 v112, v26, v27, v112
  v_max3_f32 v112, v28, v29, v112
  v_max3_f32 v112, v30, v31, v112
  v_max3_f32 v112, v32, v33, v112
  v_max3_f32 v112, v34, v35, v112
  v_mov_b32 v113, v112
  s_nop 1
  v_permlane32_swap_b32 v113, v112
  v_max_f32 v112, v112, v113
  v_sub_f32 v113, v111, v112
  v_exp_f32 v113, v113
  v_mov_b32 v111, v112
  v_sub_f32 v20, v20, v112
  v_exp_f32 v20, v20
  v_mul_f32 v52, v52, v113
  v_sub_f32 v21, v21, v112
  v_exp_f32 v21, v21
  v_mul_f32 v53, v53, v113
  v_sub_f32 v22, v22, v112
  v_exp_f32 v22, v22
  v_mul_f32 v54, v54, v113
  v_sub_f32 v23, v23, v112
  v_exp_f32 v23, v23
  v_mul_f32 v55, v55, v113
  v_sub_f32 v24, v24, v112
  v_exp_f32 v24, v24
  v_mul_f32 v56, v56, v113
  v_sub_f32 v25, v25, v112
  v_exp_f32 v25, v25
  v_mul_f32 v57, v57, v113
  v_sub_f32 v26, v26, v112
  v_exp_f32 v26, v26
  v_mul_f32 v58, v58, v113
  v_sub_f32 v27, v27, v112
  v_exp_f32 v27, v27
  v_mul_f32 v59, v59, v113
  v_sub_f32 v28, v28, v112
  v_exp_f32 v28, v28
  v_mul_f32 v60, v60, v113
  v_sub_f32 v29, v29, v112
  v_exp_f32 v29, v29
  v_mul_f32 v61, v61, v113
  v_sub_f32 v30, v30, v112
  v_exp_f32 v30, v30
  v_mul_f32 v62, v62, v113
  v_sub_f32 v31, v31, v112
  v_exp_f32 v31, v31
  v_mul_f32 v63, v63, v113
  v_sub_f32 v32, v32, v112
  v_exp_f32 v32, v32
  v_mul_f32 v64, v64, v113
  v_sub_f32 v33, v33, v112
  v_exp_f32 v33, v33
  v_mul_f32 v65, v65, v113
  v_sub_f32 v34, v34, v112
  v_exp_f32 v34, v34
  v_mul_f32 v66, v66, v113
  v_sub_f32 v35, v35, v112
  v_exp_f32 v35, v35
  v_mul_f32 v67, v67, v113
  v_cvt_pk_bf16_f32 v68, v20, v21
  v_cvt_pk_bf16_f32 v69, v22, v23
  v_cvt_pk_bf16_f32 v70, v24, v25
  v_cvt_pk_bf16_f32 v71, v26, v27
  v_cvt_pk_bf16_f32 v72, v28, v29
  v_cvt_pk_bf16_f32 v73, v30, v31
  v_cvt_pk_bf16_f32 v74, v32, v33
  v_cvt_pk_bf16_f32 v75, v34, v35
  s_waitcnt lgkmcnt(1)
  v_mfma_f32_32x32x16_bf16 v[52:67], v[92:95], v[68:71], v[52:67]
  s_waitcnt lgkmcnt(0)
  s_nop 0
  v_mfma_f32_32x32x16_bf16 v[52:67], v[96:99], v[72:75], v[52:67]
  ds_read_b128 v[76:79], v3 offset:6144
  ds_read_b32 v84, v4 offset:768
  ds_read_b128 v[92:95], v5 offset:7680
  ds_read_b128 v[96:99], v5 offset:8320
  s_waitcnt lgkmcnt(3)
  v_mfma_f32_32x32x16_bf16 v[20:35], v[76:79], v[12:15], 0
  s_waitcnt lgkmcnt(2)
  v_mfma_f32_32x32x16_bf16 v[20:35], v[84:87], v[16:19], v[20:35]
  s_nop 11
  v_max3_f32 v112, v20, v21, v111
  v_max3_f32 v112, v22, v23, v112
  v_max3_f32 v112, v24, v25, v112
  v_max3_f32 v112, v26, v27, v112
  v_max3_f32 v112, v28, v29, v112
  v_max3_f32 v112, v30, v31, v112
  v_max3_f32 v112, v32, v33, v112
  v_max3_f32 v112, v34, v35, v112
  v_mov_b32 v113, v112
  s_nop 1
  v_permlane32_swap_b32 v113, v112
  v_max_f32 v112, v112, v113
  v_sub_f32 v113, v111, v112
  v_exp_f32 v113, v113
  v_mov_b32 v111, v112
  v_sub_f32 v20, v20, v112
  v_exp_f32 v20, v20
  v_mul_f32 v52, v52, v113
  v_sub_f32 v21, v21, v112
  v_exp_f32 v21, v21
  v_mul_f32 v53, v53, v113
  v_sub_f32 v22, v22, v112
  v_exp_f32 v22, v22
  v_mul_f32 v54, v54, v113
  v_sub_f32 v23, v23, v112
  v_exp_f32 v23, v23
  v_mul_f32 v55, v55, v113
  v_sub_f32 v24, v24, v112
  v_exp_f32 v24, v24
  v_mul_f32 v56, v56, v113
  v_sub_f32 v25, v25, v112
  v_exp_f32 v25, v25
  v_mul_f32 v57, v57, v113
  v_sub_f32 v26, v26, v112
  v_exp_f32 v26, v26
  v_mul_f32 v58, v58, v113
  v_sub_f32 v27, v27, v112
  v_exp_f32 v27, v27
  v_mul_f32 v59, v59, v113
  v_sub_f32 v28, v28, v112
  v_exp_f32 v28, v28
  v_mul_f32 v60, v60, v113
  v_sub_f32 v29, v29, v112
  v_exp_f32 v29, v29
  v_mul_f32 v61, v61, v113
  v_sub_f32 v30, v30, v112
  v_exp_f32 v30, v30
  v_mul_f32 v62, v62, v113
  v_sub_f32 v31, v31, v112
  v_exp_f32 v31, v31
  v_mul_f32 v63, v63, v113
  v_sub_f32 v32, v32, v112
  v_exp_f32 v32, v32
  v_mul_f32 v64, v64, v113
  v_sub_f32 v33, v33, v112
  v_exp_f32 v33, v33
  v_mul_f32 v65, v65, v113
  v_sub_f32 v34, v34, v112
  v_exp_f32 v34, v34
  v_mul_f32 v66, v66, v113
  v_sub_f32 v35, v35, v112
  v_exp_f32 v35, v35
  v_mul_f32 v67, v67, v113
  v_cvt_pk_bf16_f32 v68, v20, v21
  v_cvt_pk_bf16_f32 v69, v22, v23
  v_cvt_pk_bf16_f32 v70, v24, v25
  v_cvt_pk_bf16_f32 v71, v26, v27
  v_cvt_pk_bf16_f32 v72, v28, v29
  v_cvt_pk_bf16_f32 v73, v30, v31
  v_cvt_pk_bf16_f32 v74, v32, v33
  v_cvt_pk_bf16_f32 v75, v34, v35
  s_waitcnt lgkmcnt(1)
  v_mfma_f32_32x32x16_bf16 v[52:67], v[92:95], v[68:71], v[52:67]
  s_waitcnt lgkmcnt(0)
  s_nop 0
  v_mfma_f32_32x32x16_bf16 v[52:67], v[96:99], v[72:75], v[52:67]
  ds_read_b128 v[76:79], v3 offset:7168
  ds_read_b32 v84, v4 offset:896
  ds_read_b128 v[92:95], v5 offset:8960
  ds_read_b128 v[96:99], v5 offset:9600
  s_waitcnt lgkmcnt(3)
  v_mfma_f32_32x32x16_bf16 v[20:35], v[76:79], v[12:15], 0
  s_waitcnt lgkmcnt(2)
  v_mfma_f32_32x32x16_bf16 v[20:35], v[84:87], v[16:19], v[20:35]
  s_nop 11
  v_max3_f32 v112, v20, v21, v111
  v_max3_f32 v112, v22, v23, v112
  v_max3_f32 v112, v24, v25, v112
  v_max3_f32 v112, v26, v27, v112
  v_max3_f32 v112, v28, v29, v112
  v_max3_f32 v112, v30, v31, v112
  v_max3_f32 v112, v32, v33, v112
  v_max3_f32 v112, v34, v35, v112
  v_mov_b32 v113, v112
  s_nop 1
  v_permlane32_swap_b32 v113, v112
  v_max_f32 v112, v112, v113
  v_sub_f32 v113, v111, v112
  v_exp_f32 v113, v113
  v_mov_b32 v111, v112
  v_sub_f32 v20, v20, v112
  v_exp_f32 v20, v20
  v_mul_f32 v52, v52, v113
  v_sub_f32 v21, v21, v112
  v_exp_f32 v21, v21
  v_mul_f32 v53, v53, v113
  v_sub_f32 v22, v22, v112
  v_exp_f32 v22, v22
  v_mul_f32 v54, v54, v113
  v_sub_f32 v23, v23, v112
  v_exp_f32 v23, v23
  v_mul_f32 v55, v55, v113
  v_sub_f32 v24, v24, v112
  v_exp_f32 v24, v24
  v_mul_f32 v56, v56, v113
  v_sub_f32 v25, v25, v112
  v_exp_f32 v25, v25
  v_mul_f32 v57, v57, v113
  v_sub_f32 v26, v26, v112
  v_exp_f32 v26, v26
  v_mul_f32 v58, v58, v113
  v_sub_f32 v27, v27, v112
  v_exp_f32 v27, v27
  v_mul_f32 v59, v59, v113
  v_sub_f32 v28, v28, v112
  v_exp_f32 v28, v28
  v_mul_f32 v60, v60, v113
  v_sub_f32 v29, v29, v112
  v_exp_f32 v29, v29
  v_mul_f32 v61, v61, v113
  v_sub_f32 v30, v30, v112
  v_exp_f32 v30, v30
  v_mul_f32 v62, v62, v113
  v_sub_f32 v31, v31, v112
  v_exp_f32 v31, v31
  v_mul_f32 v63, v63, v113
  v_sub_f32 v32, v32, v112
  v_exp_f32 v32, v32
  v_mul_f32 v64, v64, v113
  v_sub_f32 v33, v33, v112
  v_exp_f32 v33, v33
  v_mul_f32 v65, v65, v113
  v_sub_f32 v34, v34, v112
  v_exp_f32 v34, v34
  v_mul_f32 v66, v66, v113
  v_sub_f32 v35, v35, v112
  v_exp_f32 v35, v35
  v_mul_f32 v67, v67, v113
  v_cvt_pk_bf16_f32 v68, v20, v21
  v_cvt_pk_bf16_f32 v69, v22, v23
  v_cvt_pk_bf16_f32 v70, v24, v25
  v_cvt_pk_bf16_f32 v71, v26, v27
  v_cvt_pk_bf16_f32 v72, v28, v29
  v_cvt_pk_bf16_f32 v73, v30, v31
  v_cvt_pk_bf16_f32 v74, v32, v33
  v_cvt_pk_bf16_f32 v75, v34, v35
  s_waitcnt lgkmcnt(1)
  v_mfma_f32_32x32x16_bf16 v[52:67], v[92:95], v[68:71], v[52:67]
  s_waitcnt lgkmcnt(0)
  s_nop 0
  v_mfma_f32_32x32x16_bf16 v[52:67], v[96:99], v[72:75], v[52:67]
  v_add_u32 v3, 19456, v3
  v_add_u32 v4, 19456, v4
  v_add_u32 v5, 19456, v5
  s_sub_u32 s41, s41, 1
  s_cmp_lg_u32 s41, 0
  s_cbranch_scc1 LP_attn1_ke_53
  s_nop 5
  v_mov_b32 v108, v62
  v_mov_b32 v109, v62
  s_nop 1
  v_permlane32_swap_b32 v108, v109
SK_attn1_ke_52:
  v_rcp_f32 v109, v108
  s_nop 0
  v_mul_f32 v52, v52, v109
  v_mul_f32 v53, v53, v109
  v_mul_f32 v54, v54, v109
  v_mul_f32 v55, v55, v109
  v_mul_f32 v56, v56, v109
  v_mul_f32 v57, v57, v109
  v_mul_f32 v58, v58, v109
  v_mul_f32 v59, v59, v109
  v_mul_f32 v60, v60, v109
  v_mul_f32 v61, v61, v109
  v_cvt_pk_bf16_f32 v68, v52, v53
  v_cvt_pk_bf16_f32 v69, v54, v55
  v_cvt_pk_bf16_f32 v70, v56, v57
  v_cvt_pk_bf16_f32 v71, v58, v59
  v_cvt_pk_bf16_f32 v72, v60, v61
  s_mul_i32 s26, s25, 36
  s_add_u32 s27, s26, s23
  s_lshl_b32 s27, s27, 10
  s_add_u32 s27, s27, 25800704
  buffer_store_dwordx4 v[68:71], v2, s[8:11], s27 offen sc1
  s_lshr_b32 s27, s23, 3
  s_add_u32 s27, s27, s26
  s_add_u32 s27, s27, 32
  s_lshl_b32 s27, s27, 10
  s_bfe_u32 s28, s23, 65538
  s_lshl_b32 s28, s28, 9
  s_add_u32 s27, s27, s28
  s_and_b32 s28, s23, 3
  s_lshl_b32 s28, s28, 2
  s_add_u32 s27, s27, s28
  s_add_u32 s27, s27, 25800704
  v_lshlrev_b32 v6, 4, v8
  s_mov_b64 exec, 0xffffffff
  buffer_store_dword v72, v6, s[8:11], s27 offen
  s_mov_b64 exec, -1
  s_waitcnt vmcnt(0) lgkmcnt(0)
END_attn1_ke_32:
  s_endpgm
attn1_kernel_codeend:
.globl attn2_kernel
.p2align 8
.type attn2_kernel,@function
attn2_kernel:
  s_mov_b32 s18, 0
  s_branch ATTN_BODY

.globl chain1_kernel
.p2align 8
.type chain1_kernel,@function
chain1_kernel:
  s_mov_b32 s18, 0
CHAIN_BODY:
  s_cmp_ge_u32 s2, 256
  s_cbranch_scc1 END_chain1_k_77
  s_load_dwordx2 s[4:5], s[0:1], 64
  s_load_dwordx2 s[6:7], s[0:1], 48
  s_getpc_b64 s[84:85]
PC_chain1_k_78:
  s_mov_b32 s88, s84
  s_and_b32 s89, s85, 0xffff
  s_mov_b32 s90, chain1_kernel_codeend-PC_chain1_k_78
  s_mov_b32 s91, 0x20000
  v_lshlrev_b32 v10, 4, v0
  buffer_load_dwordx4 v[200:203], v10, s[88:91], 0 offen
  s_mul_i32 s17, s18, 16384
  s_add_u32 s17, s17, 61878272
  s_waitcnt lgkmcnt(0)
  s_mov_b32 s8, s4
  s_and_b32 s9, s5, 65535
  s_mov_b32 s10, 0x10000000
  s_mov_b32 s11, 0x20000
  s_cmp_ge_u32 s2, 144
  s_cbranch_scc1 WE_chain1_k_79
  v_lshrrev_b32 v1, 6, v0
  s_nop 0
  v_readfirstlane_b32 s20, v1
  v_and_b32 v1, 63, v0
  v_lshlrev_b32 v2, 4, v1
  s_nop 1
  s_lshr_b32 s19, s20, 2
  s_and_b32 s20, s20, 3
  s_and_b32 s21, s2, 7
  s_lshr_b32 s22, s2, 3
  s_lshl_b32 s23, s21, 1
  s_and_b32 s24, s22, 1
  s_add_u32 s23, s23, s24
  s_lshr_b32 s24, s22, 1
  s_lshl_b32 s25, s23, 2
  s_add_u32 s25, s25, s20
  s_mov_b32 s12, s4
  s_and_b32 s13, s5, 65535
  s_mov_b32 s14, 0x10000000
  s_mov_b32 s15, 0x20000
  s_mul_i32 s32, s25, 36864
  s_add_u32 s32, s32, 25800704
  s_mul_i32 s30, s24, 73728
  s_add_u32 s30, s30, 2064384
  s_mov_b32 s28, 18
  s_mul_i32 s29, s25, 36864
  s_lshl_b32 s37, s24, 12
  s_add_u32 s29, s29, s37
  s_add_u32 s29, s29, 13676544
  s_add_u32 s49, s29, 45449216
  s_cmp_eq_u32 s19, 0
  s_cbranch_scc0 EL_chain1_k_80
  s_setprio 1
  buffer_load_dwordx4 v[72:75], v2, s[8:11], s29 offen
  buffer_load_dwordx4 v[76:79], v2, s[8:11], s29 offen offset:1024
  buffer_load_dwordx4 v[80:83], v2, s[8:11], s29 offen offset:2048
  buffer_load_dwordx4 v[84:87], v2, s[8:11], s29 offen offset:3072
  s_mul_i32 s35, s20, 2048
  s_add_u32 s35, s35, 4096
  s_mov_b32 s40, 0
  v_mov_b32 v16, 0
  v_mov_b32 v17, 0
  v_mov_b32 v18, 0
  v_mov_b32 v19, 0
  v_mov_b32 v20, 0
  v_mov_b32 v21, 0
  v_mov_b32 v22, 0
  v_mov_b32 v23, 0
  v_mov_b32 v24, 0
  v_mov_b32 v25, 0
  v_mov_b32 v26, 0
  v_mov_b32 v27, 0
  v_mov_b32 v28, 0
  v_mov_b32 v29, 0
  v_mov_b32 v30, 0
  v_mov_b32 v31, 0
  v_mov_b32 v32, 0
  v_mov_b32 v33, 0
  v_mov_b32 v34, 0
  v_mov_b32 v35, 0
  v_mov_b32 v36, 0
  v_mov_b32 v37, 0
  v_mov_b32 v38, 0
  v_mov_b32 v39, 0
  v_mov_b32 v40, 0
  v_mov_b32 v41, 0
  v_mov_b32 v42, 0
  v_mov_b32 v43, 0
  v_mov_b32 v44, 0
  v_mov_b32 v45, 0
  v_mov_b32 v46, 0
  v_mov_b32 v47, 0
  v_mov_b32 v3, v2
  v_add_u32 v4, s35, v2
  s_barrier
  ds_read_b128 v[56:59], v4 offset:0
  ds_read_b128 v[48:51], v3 offset:0
  ds_read_b128 v[52:55], v3 offset:1024
LC_chain1_k_82:
  s_waitcnt lgkmcnt(1)
  v_mfma_f32_32x32x16_bf16 v[16:31], v[48:51], v[56:59], v[16:31]
  ds_read_b128 v[68:71], v4 offset:1024
  ds_read_b128 v[60:63], v3 offset:2048
  s_add_u32 s40, s40, 12288
  s_cmp_ge_u32 s40, 122880
  s_cselect_b32 s40, 0, s40
  s_add_u32 s42, s40, s35
  s_waitcnt lgkmcnt(2)
  v_mfma_f32_32x32x16_bf16 v[32:47], v[52:55], v[56:59], v[32:47]
  ds_read_b128 v[64:67], v3 offset:3072
  v_add_u32 v12, s40, v2
  v_add_u32 v13, s42, v2
  s_barrier
  s_waitcnt lgkmcnt(1)
  v_mfma_f32_32x32x16_bf16 v[16:31], v[60:63], v[68:71], v[16:31]
  ds_read_b128 v[56:59], v13 offset:0
  ds_read_b128 v[48:51], v12 offset:0
  s_waitcnt lgkmcnt(2)
  v_mfma_f32_32x32x16_bf16 v[32:47], v[64:67], v[68:71], v[32:47]
  ds_read_b128 v[52:55], v12 offset:1024
  v_mov_b32 v3, v12
  v_mov_b32 v4, v13
  s_sub_u32 s28, s28, 1
  s_cmp_lg_u32 s28, 0
  s_cbranch_scc1 LC_chain1_k_82
  s_waitcnt vmcnt(3)
  v_lshlrev_b32 v90, 16, v72
  v_and_b32 v91, 0xffff0000, v72
  s_nop 0
  v_add_f32 v16, v16, v90
  v_add_f32 v17, v17, v91
  v_cvt_pk_bf16_f32 v72, v16, v17
  v_lshlrev_b32 v90, 16, v72
  v_and_b32 v91, 0xffff0000, v72
  v_add_f32 v88, v90, v91
  v_mul_f32 v89, v90, v90
  v_fmac_f32 v89, v91, v91
  v_lshlrev_b32 v90, 16, v73
  v_and_b32 v91, 0xffff0000, v73
  v_add_f32 v18, v18, v90
  v_add_f32 v19, v19, v91
  v_cvt_pk_bf16_f32 v73, v18, v19
  v_lshlrev_b32 v90, 16, v73
  v_and_b32 v91, 0xffff0000, v73
  v_add_f32 v88, v88, v90
  v_fmac_f32 v89, v90, v90
  v_add_f32 v88, v88, v91
  v_fmac_f32 v89, v91, v91
  v_lshlrev_b32 v90, 16, v74
  v_and_b32 v91, 0xffff0000, v74
  v_add_f32 v20, v20, v90
  v_add_f32 v21, v21, v91
  v_cvt_pk_bf16_f32 v74, v20, v21
  v_lshlrev_b32 v90, 16, v74
  v_and_b32 v91, 0xffff0000, v74
  v_add_f32 v88, v88, v90
  v_fmac_f32 v89, v90, v90
  v_add_f32 v88, v88, v91
  v_fmac_f32 v89, v91, v91
  v_lshlrev_b32 v90, 16, v75
  v_and_b32 v91, 0xffff0000, v75
  v_add_f32 v22, v22, v90
  v_add_f32 v23, v23, v91
  v_cvt_pk_bf16_f32 v75, v22, v23
  v_lshlrev_b32 v90, 16, v75
  v_and_b32 v91, 0xffff0000, v75
  v_add_f32 v88, v88, v90
  v_fmac_f32 v89, v90, v90
  v_add_f32 v88, v88, v91
  v_fmac_f32 v89, v91, v91
  s_waitcnt vmcnt(2)
  v_lshlrev_b32 v90, 16, v76
  v_and_b32 v91, 0xffff0000, v76
  v_add_f32 v24, v24, v90
  v_add_f32 v25, v25, v91
  v_cvt_pk_bf16_f32 v76, v24, v25
  v_lshlrev_b32 v90, 16, v76
  v_and_b32 v91, 0xffff0000, v76
  v_add_f32 v88, v88, v90
  v_fmac_f32 v89, v90, v90
  v_add_f32 v88, v88, v91
  v_fmac_f32 v89, v91, v91
  v_lshlrev_b32 v90, 16, v77
  v_and_b32 v91, 0xffff0000, v77
  v_add_f32 v26, v26, v90
  v_add_f32 v27, v27, v91
  v_cvt_pk_bf16_f32 v77, v26, v27
  v_lshlrev_b32 v90, 16, v77
  v_and_b32 v91, 0xffff0000, v77
  v_add_f32 v88, v88, v90
  v_fmac_f32 v89, v90, v90
  v_add_f32 v88, v88, v91
  v_fmac_f32 v89, v91, v91
  v_lshlrev_b32 v90, 16, v78
  v_and_b32 v91, 0xffff0000, v78
  v_add_f32 v28, v28, v90
  v_add_f32 v29, v29, v91
  v_cvt_pk_bf16_f32 v78, v28, v29
  v_lshlrev_b32 v90, 16, v78
  v_and_b32 v91, 0xffff0000, v78
  v_add_f32 v88, v88, v90
  v_fmac_f32 v89, v90, v90
  v_add_f32 v88, v88, v91
  v_fmac_f32 v89, v91, v91
  v_lshlrev_b32 v90, 16, v79
  v_and_b32 v91, 0xffff0000, v79
  v_add_f32 v30, v30, v90
  v_add_f32 v31, v31, v91
  v_cvt_pk_bf16_f32 v79, v30, v31
  v_lshlrev_b32 v90, 16, v79
  v_and_b32 v91, 0xffff0000, v79
  v_add_f32 v88, v88, v90
  v_fmac_f32 v89, v90, v90
  v_add_f32 v88, v88, v91
  v_fmac_f32 v89, v91, v91
  s_waitcnt vmcnt(1)
  v_lshlrev_b32 v90, 16, v80
  v_and_b32 v91, 0xffff0000, v80
  v_add_f32 v32, v32, v90
  v_add_f32 v33, v33, v91
  v_cvt_pk_bf16_f32 v80, v32, v33
  v_lshlrev_b32 v90, 16, v80
  v_and_b32 v91, 0xffff0000, v80
  v_add_f32 v88, v88, v90
  v_fmac_f32 v89, v90, v90
  v_add_f32 v88, v88, v91
  v_fmac_f32 v89, v91, v91
  v_lshlrev_b32 v90, 16, v81
  v_and_b32 v91, 0xffff0000, v81
  v_add_f32 v34, v34, v90
  v_add_f32 v35, v35, v91
  v_cvt_pk_bf16_f32 v81, v34, v35
  v_lshlrev_b32 v90, 16, v81
  v_and_b32 v91, 0xffff0000, v81
  v_add_f32 v88, v88, v90
  v_fmac_f32 v89, v90, v90
  v_add_f32 v88, v88, v91
  v_fmac_f32 v89, v91, v91
  v_lshlrev_b32 v90, 16, v82
  v_and_b32 v91, 0xffff0000, v82
  v_add_f32 v36, v36, v90
  v_add_f32 v37, v37, v91
  v_cvt_pk_bf16_f32 v82, v36, v37
  v_lshlrev_b32 v90, 16, v82
  v_and_b32 v91, 0xffff0000, v82
  v_add_f32 v88, v88, v90
  v_fmac_f32 v89, v90, v90
  v_add_f32 v88, v88, v91
  v_fmac_f32 v89, v91, v91
  v_lshlrev_b32 v90, 16, v83
  v_and_b32 v91, 0xffff0000, v83
  v_add_f32 v38, v38, v90
  v_add_f32 v39, v39, v91
  v_cvt_pk_bf16_f32 v83, v38, v39
  v_lshlrev_b32 v90, 16, v83
  v_and_b32 v91, 0xffff0000, v83
  v_add_f32 v88, v88, v90
  v_fmac_f32 v89, v90, v90
  v_add_f32 v88, v88, v91
  v_fmac_f32 v89, v91, v91
  s_waitcnt vmcnt(0)
  v_lshlrev_b32 v90, 16, v84
  v_and_b32 v91, 0xffff0000, v84
  v_add_f32 v40, v40, v90
  v_add_f32 v41, v41, v91
  v_cvt_pk_bf16_f32 v84, v40, v41
  v_lshlrev_b32 v90, 16, v84
  v_and_b32 v91, 0xffff0000, v84
  v_add_f32 v88, v88, v90
  v_fmac_f32 v89, v90, v90
  v_add_f32 v88, v88, v91
  v_fmac_f32 v89, v91, v91
  v_lshlrev_b32 v90, 16, v85
  v_and_b32 v91, 0xffff0000, v85
  v_add_f32 v42, v42, v90
  v_add_f32 v43, v43, v91
  v_cvt_pk_bf16_f32 v85, v42, v43
  v_lshlrev_b32 v90, 16, v85
  v_and_b32 v91, 0xffff0000, v85
  v_add_f32 v88, v88, v90
  v_fmac_f32 v89, v90, v90
  v_add_f32 v88, v88, v91
  v_fmac_f32 v89, v91, v91
  v_lshlrev_b32 v90, 16, v86
  v_and_b32 v91, 0xffff0000, v86
  v_add_f32 v44, v44, v90
  v_add_f32 v45, v45, v91
  v_cvt_pk_bf16_f32 v86, v44, v45
  v_lshlrev_b32 v90, 16, v86
  v_and_b32 v91, 0xffff0000, v86
  v_add_f32 v88, v88, v90
  v_fmac_f32 v89, v90, v90
  v_add_f32 v88, v88, v91
  v_fmac_f32 v89, v91, v91
  v_lshlrev_b32 v90, 16, v87
  v_and_b32 v91, 0xffff0000, v87
  v_add_f32 v46, v46, v90
  v_add_f32 v47, v47, v91
  v_cvt_pk_bf16_f32 v87, v46, v47
  v_lshlrev_b32 v90, 16, v87
  v_and_b32 v91, 0xffff0000, v87
  v_add_f32 v88, v88, v90
  v_fmac_f32 v89, v90, v90
  v_add_f32 v88, v88, v91
  v_fmac_f32 v89, v91, v91
  buffer_store_dwordx4 v[72:75], v2, s[8:11], s49 offen sc1
  buffer_store_dwordx4 v[76:79], v2, s[8:11], s49 offen offset:1024 sc1
  buffer_store_dwordx4 v[80:83], v2, s[8:11], s49 offen offset:2048 sc1
  buffer_store_dwordx4 v[84:87], v2, s[8:11], s49 offen offset:3072 sc1
  s_mul_i32 s32, s25, 9
  s_add_u32 s32, s32, s24
  s_lshl_b32 s32, s32, 9
  s_add_u32 s32, s32, 28160000
  v_lshlrev_b32 v7, 3, v1
  buffer_store_dwordx2 v[88:89], v7, s[8:11], s32 offen sc1
  s_branch EN_chain1_k_81
EL_chain1_k_80:
  s_mul_i32 s31, s20, 1024
  s_add_u32 s30, s30, s31
  s_mov_b32 s33, 0
  s_mul_i32 s35, s20, 2048
  s_add_u32 s35, s35, 4096
  s_mov_b32 s36, s28
  s_add_u32 s34, s33, s31
  s_mov_b32 m0, s34
  s_nop 0
  buffer_load_dwordx4 v2, s[12:15], s30 offen lds
  s_add_u32 s30, s30, 4096
  s_add_u32 s34, s33, s35
  s_mov_b32 m0, s34
  s_nop 0
  buffer_load_dwordx4 v2, s[12:15], s32 offen lds
  buffer_load_dwordx4 v2, s[12:15], s32 offen offset:1024 lds
  s_add_u32 s32, s32, 2048
  s_add_u32 s33, s33, 12288
  s_cmp_ge_u32 s33, 122880
  s_cselect_b32 s33, 0, s33
  s_sub_u32 s36, s36, 1
  s_cmp_eq_u32 s36, 0
  s_cselect_b32 s14, 0, s14
  s_add_u32 s34, s33, s31
  s_mov_b32 m0, s34
  s_nop 0
  buffer_load_dwordx4 v2, s[12:15], s30 offen lds
  s_add_u32 s30, s30, 4096
  s_add_u32 s34, s33, s35
  s_mov_b32 m0, s34
  s_nop 0
  buffer_load_dwordx4 v2, s[12:15], s32 offen lds
  buffer_load_dwordx4 v2, s[12:15], s32 offen offset:1024 lds
  s_add_u32 s32, s32, 2048
  s_add_u32 s33, s33, 12288
  s_cmp_ge_u32 s33, 122880
  s_cselect_b32 s33, 0, s33
  s_sub_u32 s36, s36, 1
  s_cmp_eq_u32 s36, 0
  s_cselect_b32 s14, 0, s14
  s_add_u32 s34, s33, s31
  s_mov_b32 m0, s34
  s_nop 0
  buffer_load_dwordx4 v2, s[12:15], s30 offen lds
  s_add_u32 s30, s30, 4096
  s_add_u32 s34, s33, s35
  s_mov_b32 m0, s34
  s_nop 0
  buffer_load_dwordx4 v2, s[12:15], s32 offen lds
  buffer_load_dwordx4 v2, s[12:15], s32 offen offset:1024 lds
  s_add_u32 s32, s32, 2048
  s_add_u32 s33, s33, 12288
  s_cmp_ge_u32 s33, 122880
  s_cselect_b32 s33, 0, s33
  s_sub_u32 s36, s36, 1
  s_cmp_eq_u32 s36, 0
  s_cselect_b32 s14, 0, s14
  s_add_u32 s34, s33, s31
  s_mov_b32 m0, s34
  s_nop 0
  buffer_load_dwordx4 v2, s[12:15], s30 offen lds
  s_add_u32 s30, s30, 4096
  s_add_u32 s34, s33, s35
  s_mov_b32 m0, s34
  s_nop 0
  buffer_load_dwordx4 v2, s[12:15], s32 offen lds
  buffer_load_dwordx4 v2, s[12:15], s32 offen offset:1024 lds
  s_add_u32 s32, s32, 2048
  s_add_u32 s33, s33, 12288
  s_cmp_ge_u32 s33, 122880
  s_cselect_b32 s33, 0, s33
  s_sub_u32 s36, s36, 1
  s_cmp_eq_u32 s36, 0
  s_cselect_b32 s14, 0, s14
  s_add_u32 s34, s33, s31
  s_mov_b32 m0, s34
  s_nop 0
  buffer_load_dwordx4 v2, s[12:15], s30 offen lds
  s_add_u32 s30, s30, 4096
  s_add_u32 s34, s33, s35
  s_mov_b32 m0, s34
  s_nop 0
  buffer_load_dwordx4 v2, s[12:15], s32 offen lds
  buffer_load_dwordx4 v2, s[12:15], s32 offen offset:1024 lds
  s_add_u32 s32, s32, 2048
  s_add_u32 s33, s33, 12288
  s_cmp_ge_u32 s33, 122880
  s_cselect_b32 s33, 0, s33
  s_sub_u32 s36, s36, 1
  s_cmp_eq_u32 s36, 0
  s_cselect_b32 s14, 0, s14
  s_add_u32 s34, s33, s31
  s_mov_b32 m0, s34
  s_nop 0
  buffer_load_dwordx4 v2, s[12:15], s30 offen lds
  s_add_u32 s30, s30, 4096
  s_add_u32 s34, s33, s35
  s_mov_b32 m0, s34
  s_nop 0
  buffer_load_dwordx4 v2, s[12:15], s32 offen lds
  buffer_load_dwordx4 v2, s[12:15], s32 offen offset:1024 lds
  s_add_u32 s32, s32, 2048
  s_add_u32 s33, s33, 12288
  s_cmp_ge_u32 s33, 122880
  s_cselect_b32 s33, 0, s33
  s_sub_u32 s36, s36, 1
  s_cmp_eq_u32 s36, 0
  s_cselect_b32 s14, 0, s14
  s_add_u32 s34, s33, s31
  s_mov_b32 m0, s34
  s_nop 0
  buffer_load_dwordx4 v2, s[12:15], s30 offen lds
  s_add_u32 s30, s30, 4096
  s_add_u32 s34, s33, s35
  s_mov_b32 m0, s34
  s_nop 0
  buffer_load_dwordx4 v2, s[12:15], s32 offen lds
  buffer_load_dwordx4 v2, s[12:15], s32 offen offset:1024 lds
  s_add_u32 s32, s32, 2048
  s_add_u32 s33, s33, 12288
  s_cmp_ge_u32 s33, 122880
  s_cselect_b32 s33, 0, s33
  s_sub_u32 s36, s36, 1
  s_cmp_eq_u32 s36, 0
  s_cselect_b32 s14, 0, s14
  s_add_u32 s34, s33, s31
  s_mov_b32 m0, s34
  s_nop 0
  buffer_load_dwordx4 v2, s[12:15], s30 offen lds
  s_add_u32 s30, s30, 4096
  s_add_u32 s34, s33, s35
  s_mov_b32 m0, s34
  s_nop 0
  buffer_load_dwordx4 v2, s[12:15], s32 offen lds
  buffer_load_dwordx4 v2, s[12:15], s32 offen offset:1024 lds
  s_add_u32 s32, s32, 2048
  s_add_u32 s33, s33, 12288
  s_cmp_ge_u32 s33, 122880
  s_cselect_b32 s33, 0, s33
  s_sub_u32 s36, s36, 1
  s_cmp_eq_u32 s36, 0
  s_cselect_b32 s14, 0, s14
  s_add_u32 s34, s33, s31
  s_mov_b32 m0, s34
  s_nop 0
  buffer_load_dwordx4 v2, s[12:15], s30 offen lds
  s_add_u32 s30, s30, 4096
  s_add_u32 s34, s33, s35
  s_mov_b32 m0, s34
  s_nop 0
  buffer_load_dwordx4 v2, s[12:15], s32 offen lds
  buffer_load_dwordx4 v2, s[12:15], s32 offen offset:1024 lds
  s_add_u32 s32, s32, 2048
  s_add_u32 s33, s33, 12288
  s_cmp_ge_u32 s33, 122880
  s_cselect_b32 s33, 0, s33
  s_sub_u32 s36, s36, 1
  s_cmp_eq_u32 s36, 0
  s_cselect_b32 s14, 0, s14
  s_waitcnt vmcnt(24)
  s_barrier
LL_chain1_k_83:
  s_waitcnt vmcnt(21)
  s_barrier
  s_add_u32 s34, s33, s31
  s_mov_b32 m0, s34
  s_nop 0
  buffer_load_dwordx4 v2, s[12:15], s30 offen lds
  s_add_u32 s30, s30, 4096
  s_add_u32 s34, s33, s35
  s_mov_b32 m0, s34
  s_nop 0
  buffer_load_dwordx4 v2, s[12:15], s32 offen lds
  buffer_load_dwordx4 v2, s[12:15], s32 offen offset:1024 lds
  s_add_u32 s32, s32, 2048
  s_add_u32 s33, s33, 12288
  s_cmp_ge_u32 s33, 122880
  s_cselect_b32 s33, 0, s33
  s_sub_u32 s36, s36, 1
  s_cmp_eq_u32 s36, 0
  s_cselect_b32 s14, 0, s14
  s_sub_u32 s28, s28, 1
  s_cmp_lg_u32 s28, 0
  s_cbranch_scc1 LL_chain1_k_83
EN_chain1_k_81:
  s_waitcnt vmcnt(0) lgkmcnt(0)
  s_barrier
  s_cmp_lg_u32 s19, 1
  s_cbranch_scc1 SD_chain1_k_84
  s_cmp_lg_u32 s20, 0
  s_cbranch_scc1 SD_chain1_k_84
  v_lshrrev_b32 v14, 3, v1
  v_lshlrev_b32 v14, 2, v14
  v_and_b32 v15, 7, v1
  v_lshlrev_b32 v15, 5, v15
  v_add_u32 v14, v14, v15
  s_lshr_b32 s46, s23, 2
  s_and_b32 s47, s23, 3
  s_lshl_b32 s47, s47, 3
  s_add_u32 s46, s46, s47
  v_add_u32 v14, s46, v14
  v_lshlrev_b32 v14, 8, v14
  s_mul_i32 s46, s18, 48267264
  s_add_u32 s46, s46, 61485056
  v_mov_b32 v15, 1
  s_mov_b64 exec, 65535
  buffer_atomic_add v15, v14, s[8:11], s46 offen sc1
  s_mov_b64 exec, -1
SD_chain1_k_84:
WE_chain1_k_79:
  s_waitcnt vmcnt(0) lgkmcnt(0)
  s_nop 15
PHS_f1:
  s_getpc_b64 s[84:85]
PHP_f1:
  s_mov_b32 s88, s84
  s_and_b32 s89, s85, 0xffff
  s_mov_b32 s90, PHS_f2-PHP_f1
  s_mov_b32 s91, 0x20000
  v_lshlrev_b32 v251, 4, v0
  buffer_load_dwordx4 v[252:255], v251, s[88:91], 0 offen
  v_lshrrev_b32 v1, 6, v0
  s_nop 0
  v_readfirstlane_b32 s20, v1
  v_and_b32 v1, 63, v0
  v_lshlrev_b32 v2, 4, v1
  s_nop 1
  s_lshr_b32 s19, s20, 2
  s_and_b32 s20, s20, 3
  s_and_b32 s21, s2, 7
  s_lshr_b32 s22, s2, 3
  s_and_b32 s23, s21, 3
  s_lshl_b32 s23, s23, 2
  s_and_b32 s24, s22, 3
  s_add_u32 s23, s23, s24
  s_lshr_b32 s24, s21, 2
  s_lshl_b32 s24, s24, 3
  s_lshr_b32 s25, s22, 2
  s_add_u32 s24, s24, s25
  s_lshl_b32 s25, s23, 2
  s_add_u32 s25, s25, s20
  s_mov_b32 s12, s4
  s_and_b32 s13, s5, 65535
  s_mov_b32 s14, 0x10000000
  s_mov_b32 s15, 0x20000
  s_cmp_lg_u32 s19, 0
  s_cbranch_scc1 PD_chain1_k_86
  s_cmp_lg_u32 s20, 0
  s_cbranch_scc1 PD_chain1_k_86
  s_mul_i32 s46, s18, 48267264
  s_add_u32 s46, s46, 61485056
  s_lshl_b32 s47, s2, 8
  s_add_u32 s46, s46, s47
  s_mov_b32 s47, 300000
  v_mov_b32 v14, 0
PW_chain1_k_85:
  buffer_load_dword v252, v14, s[8:11], s46 offen sc1
  s_waitcnt vmcnt(0)
  v_readfirstlane_b32 s48, v252
  s_nop 3
  s_cmp_ge_u32 s48, 9
  s_cbranch_scc1 PW_chain1_k_85_x
  s_sub_u32 s47, s47, 1
  s_cmp_lg_u32 s47, 0
  s_cbranch_scc1 PW_chain1_k_85
PW_chain1_k_85_x:
PD_chain1_k_86:
  s_cmp_eq_u32 s19, 0
  s_cbranch_scc0 EL_chain1_k_88
  s_barrier
  s_setprio 1
  s_mul_i32 s26, s25, 4608
  s_add_u32 s26, s26, 28160000
  v_lshlrev_b32 v8, 3, v1
  buffer_load_dwordx2 v[228:229], v8, s[8:11], s26 offen sc1
  buffer_load_dwordx2 v[230:231], v8, s[8:11], s26 offen offset:512 sc1
  buffer_load_dwordx2 v[232:233], v8, s[8:11], s26 offen offset:1024 sc1
  buffer_load_dwordx2 v[234:235], v8, s[8:11], s26 offen offset:1536 sc1
  buffer_load_dwordx2 v[236:237], v8, s[8:11], s26 offen offset:2048 sc1
  buffer_load_dwordx2 v[238:239], v8, s[8:11], s26 offen offset:2560 sc1
  buffer_load_dwordx2 v[240:241], v8, s[8:11], s26 offen offset:3072 sc1
  buffer_load_dwordx2 v[242:243], v8, s[8:11], s26 offen offset:3584 sc1
  s_add_u32 s27, s26, 4096
  buffer_load_dwordx2 v[244:245], v8, s[8:11], s27 offen sc1
  s_mul_i32 s36, s25, 36864
  s_add_u32 s36, s36, 59125760
  v_lshrrev_b32 v9, 4, v1
  v_lshlrev_b32 v9, 9, v9
  v_and_b32 v10, 15, v1
  v_lshl_add_u32 v9, v10, 4, v9
  buffer_load_dwordx4 v[16:19], v9, s[8:11], s36 offen sc1
  buffer_load_dwordx4 v[20:23], v9, s[8:11], s36 offen offset:256 sc1
  buffer_load_dwordx4 v[24:27], v9, s[8:11], s36 offen offset:2048 sc1
  buffer_load_dwordx4 v[28:31], v9, s[8:11], s36 offen offset:2304 sc1
  s_add_u32 s36, s36, 4096
  buffer_load_dwordx4 v[32:35], v9, s[8:11], s36 offen sc1
  buffer_load_dwordx4 v[36:39], v9, s[8:11], s36 offen offset:256 sc1
  buffer_load_dwordx4 v[40:43], v9, s[8:11], s36 offen offset:2048 sc1
  buffer_load_dwordx4 v[44:47], v9, s[8:11], s36 offen offset:2304 sc1
  s_add_u32 s36, s36, 4096
  buffer_load_dwordx4 v[48:51], v9, s[8:11], s36 offen sc1
  buffer_load_dwordx4 v[52:55], v9, s[8:11], s36 offen offset:256 sc1
  buffer_load_dwordx4 v[56:59], v9, s[8:11], s36 offen offset:2048 sc1
  buffer_load_dwordx4 v[60:63], v9, s[8:11], s36 offen offset:2304 sc1
  s_add_u32 s36, s36, 4096
  s_mul_i32 s38, s25, 294912
  s_mul_i32 s39, s24, 18432
  s_add_u32 s38, s38, s39
  s_add_u32 s38, s38, 28454912
  s_waitcnt vmcnt(19)
  v_add_f32 v4, v228, v230
  v_add_f32 v5, v229, v231
  s_waitcnt vmcnt(18)
  v_add_f32 v4, v4, v232
  v_add_f32 v5, v5, v233
  s_waitcnt vmcnt(17)
  v_add_f32 v4, v4, v234
  v_add_f32 v5, v5, v235
  s_waitcnt vmcnt(16)
  v_add_f32 v4, v4, v236
  v_add_f32 v5, v5, v237
  s_waitcnt vmcnt(15)
  v_add_f32 v4, v4, v238
  v_add_f32 v5, v5, v239
  s_waitcnt vmcnt(14)
  v_add_f32 v4, v4, v240
  v_add_f32 v5, v5, v241
  s_waitcnt vmcnt(13)
  v_add_f32 v4, v4, v242
  v_add_f32 v5, v5, v243
  s_waitcnt vmcnt(12)
  v_add_f32 v4, v4, v244
  v_add_f32 v5, v5, v245
  v_mov_b32 v8, v4
  s_nop 1
  v_permlane32_swap_b32 v8, v4
  v_add_f32 v4, v4, v8
  v_mov_b32 v8, v5
  s_nop 1
  v_permlane32_swap_b32 v8, v5
  v_add_f32 v5, v5, v8
  v_mul_f32 v4, 0x3ae38e39, v4
  v_mul_f32 v5, 0x3ae38e39, v5
  v_fma_f32 v5, -v4, v4, v5
  v_max_f32 v5, 0, v5
  v_cvt_pk_bf16_f32 v5, v5, v5
  v_and_b32 v5, 0xffff0000, v5
  v_add_f32 v5, 0x3727c5ac, v5
  v_cvt_pk_bf16_f32 v5, v5, v5
  v_and_b32 v5, 0xffff0000, v5
  v_sqrt_f32 v5, v5
  s_nop 0
  v_cvt_pk_bf16_f32 v5, v5, v5
  v_and_b32 v5, 0xffff0000, v5
  v_rcp_f32 v5, v5
  v_cvt_pk_bf16_f32 v4, v4, v4
  v_and_b32 v4, 0xffff0000, v4
  v_mul_f32 v5, 0xbfb8aa3b, v5
  v_mul_f32 v6, v4, v5
  v_sub_f32 v6, 0, v6
  v_mov_b32 v4, v5
  v_mov_b32 v12, v4
  s_nop 1
  v_permlane16_swap_b32 v12, v4
  v_mov_b32 v13, v4
  v_mov_b32 v4, v12
  v_mov_b32 v12, v13
  v_mov_b32 v14, v6
  s_nop 1
  v_permlane16_swap_b32 v14, v6
  v_mov_b32 v15, v6
  v_mov_b32 v6, v14
  v_mov_b32 v14, v15
  s_mov_b32 s40, 0
  v_mov_b32 v3, v2
  buffer_load_dwordx4 v[64:67], v9, s[8:11], s36 offen sc1
  s_waitcnt vmcnt(12)
  v_lshlrev_b32 v228, 16, v16
  v_and_b32 v229, 0xffff0000, v16
  v_lshlrev_b32 v230, 16, v17
  v_and_b32 v231, 0xffff0000, v17
  v_lshlrev_b32 v232, 16, v18
  v_and_b32 v233, 0xffff0000, v18
  v_lshlrev_b32 v234, 16, v19
  v_and_b32 v235, 0xffff0000, v19
  v_pk_fma_f32 v[228:229], v[228:229], v[4:5], v[6:7] op_sel_hi:[1,0,0]
  v_pk_fma_f32 v[230:231], v[230:231], v[4:5], v[6:7] op_sel_hi:[1,0,0]
  v_pk_fma_f32 v[232:233], v[232:233], v[4:5], v[6:7] op_sel_hi:[1,0,0]
  v_pk_fma_f32 v[234:235], v[234:235], v[4:5], v[6:7] op_sel_hi:[1,0,0]
  v_cvt_pk_bf16_f32 v16, v228, v229
  v_cvt_pk_bf16_f32 v17, v230, v231
  v_cvt_pk_bf16_f32 v18, v232, v233
  v_cvt_pk_bf16_f32 v19, v234, v235
  buffer_load_dwordx4 v[68:71], v9, s[8:11], s36 offen offset:256 sc1
  s_waitcnt vmcnt(12)
  v_lshlrev_b32 v236, 16, v20
  v_and_b32 v237, 0xffff0000, v20
  v_lshlrev_b32 v238, 16, v21
  v_and_b32 v239, 0xffff0000, v21
  v_lshlrev_b32 v240, 16, v22
  v_and_b32 v241, 0xffff0000, v22
  v_lshlrev_b32 v242, 16, v23
  v_and_b32 v243, 0xffff0000, v23
  v_pk_fma_f32 v[236:237], v[236:237], v[12:13], v[14:15] op_sel_hi:[1,0,0]
  v_pk_fma_f32 v[238:239], v[238:239], v[12:13], v[14:15] op_sel_hi:[1,0,0]
  v_pk_fma_f32 v[240:241], v[240:241], v[12:13], v[14:15] op_sel_hi:[1,0,0]
  v_pk_fma_f32 v[242:243], v[242:243], v[12:13], v[14:15] op_sel_hi:[1,0,0]
  v_cvt_pk_bf16_f32 v20, v236, v237
  v_cvt_pk_bf16_f32 v21, v238, v239
  v_cvt_pk_bf16_f32 v22, v240, v241
  v_cvt_pk_bf16_f32 v23, v242, v243
  buffer_load_dwordx4 v[72:75], v9, s[8:11], s36 offen offset:2048 sc1
  s_waitcnt vmcnt(12)
  v_lshlrev_b32 v228, 16, v24
  v_and_b32 v229, 0xffff0000, v24
  v_lshlrev_b32 v230, 16, v25
  v_and_b32 v231, 0xffff0000, v25
  v_lshlrev_b32 v232, 16, v26
  v_and_b32 v233, 0xffff0000, v26
  v_lshlrev_b32 v234, 16, v27
  v_and_b32 v235, 0xffff0000, v27
  v_pk_fma_f32 v[228:229], v[228:229], v[4:5], v[6:7] op_sel_hi:[1,0,0]
  v_pk_fma_f32 v[230:231], v[230:231], v[4:5], v[6:7] op_sel_hi:[1,0,0]
  v_pk_fma_f32 v[232:233], v[232:233], v[4:5], v[6:7] op_sel_hi:[1,0,0]
  v_pk_fma_f32 v[234:235], v[234:235], v[4:5], v[6:7] op_sel_hi:[1,0,0]
  v_cvt_pk_bf16_f32 v24, v228, v229
  v_cvt_pk_bf16_f32 v25, v230, v231
  v_cvt_pk_bf16_f32 v26, v232, v233
  v_cvt_pk_bf16_f32 v27, v234, v235
  buffer_load_dwordx4 v[76:79], v9, s[8:11], s36 offen offset:2304 sc1
  s_add_u32 s36, s36, 4096
  s_waitcnt vmcnt(12)
  v_lshlrev_b32 v236, 16, v28
  v_and_b32 v237, 0xffff0000, v28
  v_lshlrev_b32 v238, 16, v29
  v_and_b32 v239, 0xffff0000, v29
  v_lshlrev_b32 v240, 16, v30
  v_and_b32 v241, 0xffff0000, v30
  v_lshlrev_b32 v242, 16, v31
  v_and_b32 v243, 0xffff0000, v31
  v_pk_fma_f32 v[236:237], v[236:237], v[12:13], v[14:15] op_sel_hi:[1,0,0]
  v_pk_fma_f32 v[238:239], v[238:239], v[12:13], v[14:15] op_sel_hi:[1,0,0]
  v_pk_fma_f32 v[240:241], v[240:241], v[12:13], v[14:15] op_sel_hi:[1,0,0]
  v_pk_fma_f32 v[242:243], v[242:243], v[12:13], v[14:15] op_sel_hi:[1,0,0]
  v_cvt_pk_bf16_f32 v28, v236, v237
  v_cvt_pk_bf16_f32 v29, v238, v239
  v_cvt_pk_bf16_f32 v30, v240, v241
  v_cvt_pk_bf16_f32 v31, v242, v243
  buffer_load_dwordx4 v[80:83], v9, s[8:11], s36 offen sc1
  s_waitcnt vmcnt(12)
  v_lshlrev_b32 v228, 16, v32
  v_and_b32 v229, 0xffff0000, v32
  v_lshlrev_b32 v230, 16, v33
  v_and_b32 v231, 0xffff0000, v33
  v_lshlrev_b32 v232, 16, v34
  v_and_b32 v233, 0xffff0000, v34
  v_lshlrev_b32 v234, 16, v35
  v_and_b32 v235, 0xffff0000, v35
  v_pk_fma_f32 v[228:229], v[228:229], v[4:5], v[6:7] op_sel_hi:[1,0,0]
  v_pk_fma_f32 v[230:231], v[230:231], v[4:5], v[6:7] op_sel_hi:[1,0,0]
  v_pk_fma_f32 v[232:233], v[232:233], v[4:5], v[6:7] op_sel_hi:[1,0,0]
  v_pk_fma_f32 v[234:235], v[234:235], v[4:5], v[6:7] op_sel_hi:[1,0,0]
  v_cvt_pk_bf16_f32 v32, v228, v229
  v_cvt_pk_bf16_f32 v33, v230, v231
  v_cvt_pk_bf16_f32 v34, v232, v233
  v_cvt_pk_bf16_f32 v35, v234, v235
  buffer_load_dwordx4 v[84:87], v9, s[8:11], s36 offen offset:256 sc1
  s_waitcnt vmcnt(12)
  v_lshlrev_b32 v236, 16, v36
  v_and_b32 v237, 0xffff0000, v36
  v_lshlrev_b32 v238, 16, v37
  v_and_b32 v239, 0xffff0000, v37
  v_lshlrev_b32 v240, 16, v38
  v_and_b32 v241, 0xffff0000, v38
  v_lshlrev_b32 v242, 16, v39
  v_and_b32 v243, 0xffff0000, v39
  v_pk_fma_f32 v[236:237], v[236:237], v[12:13], v[14:15] op_sel_hi:[1,0,0]
  v_pk_fma_f32 v[238:239], v[238:239], v[12:13], v[14:15] op_sel_hi:[1,0,0]
  v_pk_fma_f32 v[240:241], v[240:241], v[12:13], v[14:15] op_sel_hi:[1,0,0]
  v_pk_fma_f32 v[242:243], v[242:243], v[12:13], v[14:15] op_sel_hi:[1,0,0]
  v_cvt_pk_bf16_f32 v36, v236, v237
  v_cvt_pk_bf16_f32 v37, v238, v239
  v_cvt_pk_bf16_f32 v38, v240, v241
  v_cvt_pk_bf16_f32 v39, v242, v243
  buffer_load_dwordx4 v[88:91], v9, s[8:11], s36 offen offset:2048 sc1
  s_waitcnt vmcnt(12)
  v_lshlrev_b32 v228, 16, v40
  v_and_b32 v229, 0xffff0000, v40
  v_lshlrev_b32 v230, 16, v41
  v_and_b32 v231, 0xffff0000, v41
  v_lshlrev_b32 v232, 16, v42
  v_and_b32 v233, 0xffff0000, v42
  v_lshlrev_b32 v234, 16, v43
  v_and_b32 v235, 0xffff0000, v43
  v_pk_fma_f32 v[228:229], v[228:229], v[4:5], v[6:7] op_sel_hi:[1,0,0]
  v_pk_fma_f32 v[230:231], v[230:231], v[4:5], v[6:7] op_sel_hi:[1,0,0]
  v_pk_fma_f32 v[232:233], v[232:233], v[4:5], v[6:7] op_sel_hi:[1,0,0]
  v_pk_fma_f32 v[234:235], v[234:235], v[4:5], v[6:7] op_sel_hi:[1,0,0]
  v_cvt_pk_bf16_f32 v40, v228, v229
  v_cvt_pk_bf16_f32 v41, v230, v231
  v_cvt_pk_bf16_f32 v42, v232, v233
  v_cvt_pk_bf16_f32 v43, v234, v235
  buffer_load_dwordx4 v[92:95], v9, s[8:11], s36 offen offset:2304 sc1
  s_add_u32 s36, s36, 4096
  s_waitcnt vmcnt(12)
  v_lshlrev_b32 v236, 16, v44
  v_and_b32 v237, 0xffff0000, v44
  v_lshlrev_b32 v238, 16, v45
  v_and_b32 v239, 0xffff0000, v45
  v_lshlrev_b32 v240, 16, v46
  v_and_b32 v241, 0xffff0000, v46
  v_lshlrev_b32 v242, 16, v47
  v_and_b32 v243, 0xffff0000, v47
  v_pk_fma_f32 v[236:237], v[236:237], v[12:13], v[14:15] op_sel_hi:[1,0,0]
  v_pk_fma_f32 v[238:239], v[238:239], v[12:13], v[14:15] op_sel_hi:[1,0,0]
  v_pk_fma_f32 v[240:241], v[240:241], v[12:13], v[14:15] op_sel_hi:[1,0,0]
  v_pk_fma_f32 v[242:243], v[242:243], v[12:13], v[14:15] op_sel_hi:[1,0,0]
  v_cvt_pk_bf16_f32 v44, v236, v237
  v_cvt_pk_bf16_f32 v45, v238, v239
  v_cvt_pk_bf16_f32 v46, v240, v241
  v_cvt_pk_bf16_f32 v47, v242, v243
  buffer_load_dwordx4 v[96:99], v9, s[8:11], s36 offen sc1
  s_waitcnt vmcnt(12)
  v_lshlrev_b32 v228, 16, v48
  v_and_b32 v229, 0xffff0000, v48
  v_lshlrev_b32 v230, 16, v49
  v_and_b32 v231, 0xffff0000, v49
  v_lshlrev_b32 v232, 16, v50
  v_and_b32 v233, 0xffff0000, v50
  v_lshlrev_b32 v234, 16, v51
  v_and_b32 v235, 0xffff0000, v51
  v_pk_fma_f32 v[228:229], v[228:229], v[4:5], v[6:7] op_sel_hi:[1,0,0]
  v_pk_fma_f32 v[230:231], v[230:231], v[4:5], v[6:7] op_sel_hi:[1,0,0]
  v_pk_fma_f32 v[232:233], v[232:233], v[4:5], v[6:7] op_sel_hi:[1,0,0]
  v_pk_fma_f32 v[234:235], v[234:235], v[4:5], v[6:7] op_sel_hi:[1,0,0]
  v_cvt_pk_bf16_f32 v48, v228, v229
  v_cvt_pk_bf16_f32 v49, v230, v231
  v_cvt_pk_bf16_f32 v50, v232, v233
  v_cvt_pk_bf16_f32 v51, v234, v235
  buffer_load_dwordx4 v[100:103], v9, s[8:11], s36 offen offset:256 sc1
  s_waitcnt vmcnt(12)
  v_lshlrev_b32 v236, 16, v52
  v_and_b32 v237, 0xffff0000, v52
  v_lshlrev_b32 v238, 16, v53
  v_and_b32 v239, 0xffff0000, v53
  v_lshlrev_b32 v240, 16, v54
  v_and_b32 v241, 0xffff0000, v54
  v_lshlrev_b32 v242, 16, v55
  v_and_b32 v243, 0xffff0000, v55
  v_pk_fma_f32 v[236:237], v[236:237], v[12:13], v[14:15] op_sel_hi:[1,0,0]
  v_pk_fma_f32 v[238:239], v[238:239], v[12:13], v[14:15] op_sel_hi:[1,0,0]
  v_pk_fma_f32 v[240:241], v[240:241], v[12:13], v[14:15] op_sel_hi:[1,0,0]
  v_pk_fma_f32 v[242:243], v[242:243], v[12:13], v[14:15] op_sel_hi:[1,0,0]
  v_cvt_pk_bf16_f32 v52, v236, v237
  v_cvt_pk_bf16_f32 v53, v238, v239
  v_cvt_pk_bf16_f32 v54, v240, v241
  v_cvt_pk_bf16_f32 v55, v242, v243
  buffer_load_dwordx4 v[104:107], v9, s[8:11], s36 offen offset:2048 sc1
  s_waitcnt vmcnt(12)
  v_lshlrev_b32 v228, 16, v56
  v_and_b32 v229, 0xffff0000, v56
  v_lshlrev_b32 v230, 16, v57
  v_and_b32 v231, 0xffff0000, v57
  v_lshlrev_b32 v232, 16, v58
  v_and_b32 v233, 0xffff0000, v58
  v_lshlrev_b32 v234, 16, v59
  v_and_b32 v235, 0xffff0000, v59
  v_pk_fma_f32 v[228:229], v[228:229], v[4:5], v[6:7] op_sel_hi:[1,0,0]
  v_pk_fma_f32 v[230:231], v[230:231], v[4:5], v[6:7] op_sel_hi:[1,0,0]
  v_pk_fma_f32 v[232:233], v[232:233], v[4:5], v[6:7] op_sel_hi:[1,0,0]
  v_pk_fma_f32 v[234:235], v[234:235], v[4:5], v[6:7] op_sel_hi:[1,0,0]
  v_cvt_pk_bf16_f32 v56, v228, v229
  v_cvt_pk_bf16_f32 v57, v230, v231
  v_cvt_pk_bf16_f32 v58, v232, v233
  v_cvt_pk_bf16_f32 v59, v234, v235
  buffer_load_dwordx4 v[108:111], v9, s[8:11], s36 offen offset:2304 sc1
  s_add_u32 s36, s36, 4096
  s_waitcnt vmcnt(12)
  v_lshlrev_b32 v236, 16, v60
  v_and_b32 v237, 0xffff0000, v60
  v_lshlrev_b32 v238, 16, v61
  v_and_b32 v239, 0xffff0000, v61
  v_lshlrev_b32 v240, 16, v62
  v_and_b32 v241, 0xffff0000, v62
  v_lshlrev_b32 v242, 16, v63
  v_and_b32 v243, 0xffff0000, v63
  v_pk_fma_f32 v[236:237], v[236:237], v[12:13], v[14:15] op_sel_hi:[1,0,0]
  v_pk_fma_f32 v[238:239], v[238:239], v[12:13], v[14:15] op_sel_hi:[1,0,0]
  v_pk_fma_f32 v[240:241], v[240:241], v[12:13], v[14:15] op_sel_hi:[1,0,0]
  v_pk_fma_f32 v[242:243], v[242:243], v[12:13], v[14:15] op_sel_hi:[1,0,0]
  v_cvt_pk_bf16_f32 v60, v236, v237
  v_cvt_pk_bf16_f32 v61, v238, v239
  v_cvt_pk_bf16_f32 v62, v240, v241
  v_cvt_pk_bf16_f32 v63, v242, v243
  buffer_load_dwordx4 v[112:115], v9, s[8:11], s36 offen sc1
  s_waitcnt vmcnt(12)
  v_lshlrev_b32 v228, 16, v64
  v_and_b32 v229, 0xffff0000, v64
  v_lshlrev_b32 v230, 16, v65
  v_and_b32 v231, 0xffff0000, v65
  v_lshlrev_b32 v232, 16, v66
  v_and_b32 v233, 0xffff0000, v66
  v_lshlrev_b32 v234, 16, v67
  v_and_b32 v235, 0xffff0000, v67
  v_pk_fma_f32 v[228:229], v[228:229], v[4:5], v[6:7] op_sel_hi:[1,0,0]
  v_pk_fma_f32 v[230:231], v[230:231], v[4:5], v[6:7] op_sel_hi:[1,0,0]
  v_pk_fma_f32 v[232:233], v[232:233], v[4:5], v[6:7] op_sel_hi:[1,0,0]
  v_pk_fma_f32 v[234:235], v[234:235], v[4:5], v[6:7] op_sel_hi:[1,0,0]
  v_cvt_pk_bf16_f32 v64, v228, v229
  v_cvt_pk_bf16_f32 v65, v230, v231
  v_cvt_pk_bf16_f32 v66, v232, v233
  v_cvt_pk_bf16_f32 v67, v234, v235
  buffer_load_dwordx4 v[116:119], v9, s[8:11], s36 offen offset:256 sc1
  s_waitcnt vmcnt(12)
  v_lshlrev_b32 v236, 16, v68
  v_and_b32 v237, 0xffff0000, v68
  v_lshlrev_b32 v238, 16, v69
  v_and_b32 v239, 0xffff0000, v69
  v_lshlrev_b32 v240, 16, v70
  v_and_b32 v241, 0xffff0000, v70
  v_lshlrev_b32 v242, 16, v71
  v_and_b32 v243, 0xffff0000, v71
  v_pk_fma_f32 v[236:237], v[236:237], v[12:13], v[14:15] op_sel_hi:[1,0,0]
  v_pk_fma_f32 v[238:239], v[238:239], v[12:13], v[14:15] op_sel_hi:[1,0,0]
  v_pk_fma_f32 v[240:241], v[240:241], v[12:13], v[14:15] op_sel_hi:[1,0,0]
  v_pk_fma_f32 v[242:243], v[242:243], v[12:13], v[14:15] op_sel_hi:[1,0,0]
  v_cvt_pk_bf16_f32 v68, v236, v237
  v_cvt_pk_bf16_f32 v69, v238, v239
  v_cvt_pk_bf16_f32 v70, v240, v241
  v_cvt_pk_bf16_f32 v71, v242, v243
  buffer_load_dwordx4 v[120:123], v9, s[8:11], s36 offen offset:2048 sc1
  s_waitcnt vmcnt(12)
  v_lshlrev_b32 v228, 16, v72
  v_and_b32 v229, 0xffff0000, v72
  v_lshlrev_b32 v230, 16, v73
  v_and_b32 v231, 0xffff0000, v73
  v_lshlrev_b32 v232, 16, v74
  v_and_b32 v233, 0xffff0000, v74
  v_lshlrev_b32 v234, 16, v75
  v_and_b32 v235, 0xffff0000, v75
  v_pk_fma_f32 v[228:229], v[228:229], v[4:5], v[6:7] op_sel_hi:[1,0,0]
  v_pk_fma_f32 v[230:231], v[230:231], v[4:5], v[6:7] op_sel_hi:[1,0,0]
  v_pk_fma_f32 v[232:233], v[232:233], v[4:5], v[6:7] op_sel_hi:[1,0,0]
  v_pk_fma_f32 v[234:235], v[234:235], v[4:5], v[6:7] op_sel_hi:[1,0,0]
  v_cvt_pk_bf16_f32 v72, v228, v229
  v_cvt_pk_bf16_f32 v73, v230, v231
  v_cvt_pk_bf16_f32 v74, v232, v233
  v_cvt_pk_bf16_f32 v75, v234, v235
  buffer_load_dwordx4 v[124:127], v9, s[8:11], s36 offen offset:2304 sc1
  s_add_u32 s36, s36, 4096
  s_waitcnt vmcnt(12)
  v_lshlrev_b32 v236, 16, v76
  v_and_b32 v237, 0xffff0000, v76
  v_lshlrev_b32 v238, 16, v77
  v_and_b32 v239, 0xffff0000, v77
  v_lshlrev_b32 v240, 16, v78
  v_and_b32 v241, 0xffff0000, v78
  v_lshlrev_b32 v242, 16, v79
  v_and_b32 v243, 0xffff0000, v79
  v_pk_fma_f32 v[236:237], v[236:237], v[12:13], v[14:15] op_sel_hi:[1,0,0]
  v_pk_fma_f32 v[238:239], v[238:239], v[12:13], v[14:15] op_sel_hi:[1,0,0]
  v_pk_fma_f32 v[240:241], v[240:241], v[12:13], v[14:15] op_sel_hi:[1,0,0]
  v_pk_fma_f32 v[242:243], v[242:243], v[12:13], v[14:15] op_sel_hi:[1,0,0]
  v_cvt_pk_bf16_f32 v76, v236, v237
  v_cvt_pk_bf16_f32 v77, v238, v239
  v_cvt_pk_bf16_f32 v78, v240, v241
  v_cvt_pk_bf16_f32 v79, v242, v243
  s_barrier
  ds_read_b128 v[192:195], v3 offset:0
  ds_read_b128 v[196:199], v3 offset:1024
  ds_read_b128 v[200:203], v3 offset:2048
  ds_read_b128 v[204:207], v3 offset:3072
  ds_read_b128 v[208:211], v3 offset:4096
  ds_read_b128 v[212:215], v3 offset:5120
  ds_read_b128 v[216:219], v3 offset:6144
  ds_read_b128 v[220:223], v3 offset:7168
  buffer_load_dwordx4 v[128:131], v9, s[8:11], s36 offen sc1
  s_waitcnt vmcnt(12)
  v_lshlrev_b32 v228, 16, v80
  v_and_b32 v229, 0xffff0000, v80
  v_lshlrev_b32 v230, 16, v81
  v_and_b32 v231, 0xffff0000, v81
  v_lshlrev_b32 v232, 16, v82
  v_and_b32 v233, 0xffff0000, v82
  v_lshlrev_b32 v234, 16, v83
  v_and_b32 v235, 0xffff0000, v83
  v_pk_fma_f32 v[228:229], v[228:229], v[4:5], v[6:7] op_sel_hi:[1,0,0]
  v_pk_fma_f32 v[230:231], v[230:231], v[4:5], v[6:7] op_sel_hi:[1,0,0]
  v_pk_fma_f32 v[232:233], v[232:233], v[4:5], v[6:7] op_sel_hi:[1,0,0]
  v_pk_fma_f32 v[234:235], v[234:235], v[4:5], v[6:7] op_sel_hi:[1,0,0]
  v_cvt_pk_bf16_f32 v80, v228, v229
  v_cvt_pk_bf16_f32 v81, v230, v231
  v_cvt_pk_bf16_f32 v82, v232, v233
  v_cvt_pk_bf16_f32 v83, v234, v235
  s_waitcnt lgkmcnt(7)
  v_mfma_f32_16x16x32_bf16 v[160:163], v[192:195], v[16:19], 0
  ds_read_b128 v[224:227], v3 offset:8192
  v_mfma_f32_16x16x32_bf16 v[168:171], v[192:195], v[20:23], 0
  buffer_load_dwordx4 v[132:135], v9, s[8:11], s36 offen offset:256 sc1
  s_waitcnt vmcnt(12)
  v_lshlrev_b32 v236, 16, v84
  v_and_b32 v237, 0xffff0000, v84
  v_lshlrev_b32 v238, 16, v85
  v_and_b32 v239, 0xffff0000, v85
  v_lshlrev_b32 v240, 16, v86
  v_and_b32 v241, 0xffff0000, v86
  v_lshlrev_b32 v242, 16, v87
  v_and_b32 v243, 0xffff0000, v87
  v_pk_fma_f32 v[236:237], v[236:237], v[12:13], v[14:15] op_sel_hi:[1,0,0]
  v_pk_fma_f32 v[238:239], v[238:239], v[12:13], v[14:15] op_sel_hi:[1,0,0]
  v_pk_fma_f32 v[240:241], v[240:241], v[12:13], v[14:15] op_sel_hi:[1,0,0]
  v_pk_fma_f32 v[242:243], v[242:243], v[12:13], v[14:15] op_sel_hi:[1,0,0]
  v_cvt_pk_bf16_f32 v84, v236, v237
  v_cvt_pk_bf16_f32 v85, v238, v239
  v_cvt_pk_bf16_f32 v86, v240, v241
  v_cvt_pk_bf16_f32 v87, v242, v243
  s_waitcnt lgkmcnt(7)
  v_mfma_f32_16x16x32_bf16 v[164:167], v[196:199], v[16:19], 0
  ds_read_b128 v[192:195], v3 offset:9216
  v_mfma_f32_16x16x32_bf16 v[172:175], v[196:199], v[20:23], 0
  buffer_load_dwordx4 v[136:139], v9, s[8:11], s36 offen offset:2048 sc1
  s_waitcnt vmcnt(12)
  v_lshlrev_b32 v228, 16, v88
  v_and_b32 v229, 0xffff0000, v88
  v_lshlrev_b32 v230, 16, v89
  v_and_b32 v231, 0xffff0000, v89
  v_lshlrev_b32 v232, 16, v90
  v_and_b32 v233, 0xffff0000, v90
  v_lshlrev_b32 v234, 16, v91
  v_and_b32 v235, 0xffff0000, v91
  v_pk_fma_f32 v[228:229], v[228:229], v[4:5], v[6:7] op_sel_hi:[1,0,0]
  v_pk_fma_f32 v[230:231], v[230:231], v[4:5], v[6:7] op_sel_hi:[1,0,0]
  v_pk_fma_f32 v[232:233], v[232:233], v[4:5], v[6:7] op_sel_hi:[1,0,0]
  v_pk_fma_f32 v[234:235], v[234:235], v[4:5], v[6:7] op_sel_hi:[1,0,0]
  v_cvt_pk_bf16_f32 v88, v228, v229
  v_cvt_pk_bf16_f32 v89, v230, v231
  v_cvt_pk_bf16_f32 v90, v232, v233
  v_cvt_pk_bf16_f32 v91, v234, v235
  s_waitcnt lgkmcnt(7)
  v_mfma_f32_16x16x32_bf16 v[160:163], v[200:203], v[24:27], v[160:163]
  ds_read_b128 v[196:199], v3 offset:10240
  v_mfma_f32_16x16x32_bf16 v[168:171], v[200:203], v[28:31], v[168:171]
  buffer_load_dwordx4 v[140:143], v9, s[8:11], s36 offen offset:2304 sc1
  s_add_u32 s36, s36, 4096
  s_waitcnt vmcnt(12)
  v_lshlrev_b32 v236, 16, v92
  v_and_b32 v237, 0xffff0000, v92
  v_lshlrev_b32 v238, 16, v93
  v_and_b32 v239, 0xffff0000, v93
  v_lshlrev_b32 v240, 16, v94
  v_and_b32 v241, 0xffff0000, v94
  v_lshlrev_b32 v242, 16, v95
  v_and_b32 v243, 0xffff0000, v95
  v_pk_fma_f32 v[236:237], v[236:237], v[12:13], v[14:15] op_sel_hi:[1,0,0]
  v_pk_fma_f32 v[238:239], v[238:239], v[12:13], v[14:15] op_sel_hi:[1,0,0]
  v_pk_fma_f32 v[240:241], v[240:241], v[12:13], v[14:15] op_sel_hi:[1,0,0]
  v_pk_fma_f32 v[242:243], v[242:243], v[12:13], v[14:15] op_sel_hi:[1,0,0]
  v_cvt_pk_bf16_f32 v92, v236, v237
  v_cvt_pk_bf16_f32 v93, v238, v239
  v_cvt_pk_bf16_f32 v94, v240, v241
  v_cvt_pk_bf16_f32 v95, v242, v243
  s_waitcnt lgkmcnt(7)
  v_mfma_f32_16x16x32_bf16 v[164:167], v[204:207], v[24:27], v[164:167]
  ds_read_b128 v[200:203], v3 offset:11264
  v_mfma_f32_16x16x32_bf16 v[172:175], v[204:207], v[28:31], v[172:175]
  buffer_load_dwordx4 v[144:147], v9, s[8:11], s36 offen sc1
  s_waitcnt vmcnt(12)
  v_lshlrev_b32 v228, 16, v96
  v_and_b32 v229, 0xffff0000, v96
  v_lshlrev_b32 v230, 16, v97
  v_and_b32 v231, 0xffff0000, v97
  v_lshlrev_b32 v232, 16, v98
  v_and_b32 v233, 0xffff0000, v98
  v_lshlrev_b32 v234, 16, v99
  v_and_b32 v235, 0xffff0000, v99
  v_pk_fma_f32 v[228:229], v[228:229], v[4:5], v[6:7] op_sel_hi:[1,0,0]
  v_pk_fma_f32 v[230:231], v[230:231], v[4:5], v[6:7] op_sel_hi:[1,0,0]
  v_pk_fma_f32 v[232:233], v[232:233], v[4:5], v[6:7] op_sel_hi:[1,0,0]
  v_pk_fma_f32 v[234:235], v[234:235], v[4:5], v[6:7] op_sel_hi:[1,0,0]
  v_cvt_pk_bf16_f32 v96, v228, v229
  v_cvt_pk_bf16_f32 v97, v230, v231
  v_cvt_pk_bf16_f32 v98, v232, v233
  v_cvt_pk_bf16_f32 v99, v234, v235
  s_waitcnt lgkmcnt(7)
  v_mfma_f32_16x16x32_bf16 v[160:163], v[208:211], v[32:35], v[160:163]
  ds_read_b128 v[204:207], v3 offset:12288
  v_mfma_f32_16x16x32_bf16 v[168:171], v[208:211], v[36:39], v[168:171]
  buffer_load_dwordx4 v[148:151], v9, s[8:11], s36 offen offset:256 sc1
  s_waitcnt vmcnt(12)
  v_lshlrev_b32 v236, 16, v100
  v_and_b32 v237, 0xffff0000, v100
  v_lshlrev_b32 v238, 16, v101
  v_and_b32 v239, 0xffff0000, v101
  v_lshlrev_b32 v240, 16, v102
  v_and_b32 v241, 0xffff0000, v102
  v_lshlrev_b32 v242, 16, v103
  v_and_b32 v243, 0xffff0000, v103
  v_pk_fma_f32 v[236:237], v[236:237], v[12:13], v[14:15] op_sel_hi:[1,0,0]
  v_pk_fma_f32 v[238:239], v[238:239], v[12:13], v[14:15] op_sel_hi:[1,0,0]
  v_pk_fma_f32 v[240:241], v[240:241], v[12:13], v[14:15] op_sel_hi:[1,0,0]
  v_pk_fma_f32 v[242:243], v[242:243], v[12:13], v[14:15] op_sel_hi:[1,0,0]
  v_cvt_pk_bf16_f32 v100, v236, v237
  v_cvt_pk_bf16_f32 v101, v238, v239
  v_cvt_pk_bf16_f32 v102, v240, v241
  v_cvt_pk_bf16_f32 v103, v242, v243
  s_waitcnt lgkmcnt(7)
  v_mfma_f32_16x16x32_bf16 v[164:167], v[212:215], v[32:35], v[164:167]
  ds_read_b128 v[208:211], v3 offset:13312
  v_mfma_f32_16x16x32_bf16 v[172:175], v[212:215], v[36:39], v[172:175]
  buffer_load_dwordx4 v[152:155], v9, s[8:11], s36 offen offset:2048 sc1
  s_waitcnt vmcnt(12)
  v_lshlrev_b32 v228, 16, v104
  v_and_b32 v229, 0xffff0000, v104
  v_lshlrev_b32 v230, 16, v105
  v_and_b32 v231, 0xffff0000, v105
  v_lshlrev_b32 v232, 16, v106
  v_and_b32 v233, 0xffff0000, v106
  v_lshlrev_b32 v234, 16, v107
  v_and_b32 v235, 0xffff0000, v107
  v_pk_fma_f32 v[228:229], v[228:229], v[4:5], v[6:7] op_sel_hi:[1,0,0]
  v_pk_fma_f32 v[230:231], v[230:231], v[4:5], v[6:7] op_sel_hi:[1,0,0]
  v_pk_fma_f32 v[232:233], v[232:233], v[4:5], v[6:7] op_sel_hi:[1,0,0]
  v_pk_fma_f32 v[234:235], v[234:235], v[4:5], v[6:7] op_sel_hi:[1,0,0]
  v_cvt_pk_bf16_f32 v104, v228, v229
  v_cvt_pk_bf16_f32 v105, v230, v231
  v_cvt_pk_bf16_f32 v106, v232, v233
  v_cvt_pk_bf16_f32 v107, v234, v235
  s_waitcnt lgkmcnt(7)
  v_mfma_f32_16x16x32_bf16 v[160:163], v[216:219], v[40:43], v[160:163]
  ds_read_b128 v[212:215], v3 offset:14336
  v_mfma_f32_16x16x32_bf16 v[168:171], v[216:219], v[44:47], v[168:171]
  buffer_load_dwordx4 v[156:159], v9, s[8:11], s36 offen offset:2304 sc1
  s_add_u32 s36, s36, 4096
  s_waitcnt vmcnt(12)
  v_lshlrev_b32 v236, 16, v108
  v_and_b32 v237, 0xffff0000, v108
  v_lshlrev_b32 v238, 16, v109
  v_and_b32 v239, 0xffff0000, v109
  v_lshlrev_b32 v240, 16, v110
  v_and_b32 v241, 0xffff0000, v110
  v_lshlrev_b32 v242, 16, v111
  v_and_b32 v243, 0xffff0000, v111
  v_pk_fma_f32 v[236:237], v[236:237], v[12:13], v[14:15] op_sel_hi:[1,0,0]
  v_pk_fma_f32 v[238:239], v[238:239], v[12:13], v[14:15] op_sel_hi:[1,0,0]
  v_pk_fma_f32 v[240:241], v[240:241], v[12:13], v[14:15] op_sel_hi:[1,0,0]
  v_pk_fma_f32 v[242:243], v[242:243], v[12:13], v[14:15] op_sel_hi:[1,0,0]
  v_cvt_pk_bf16_f32 v108, v236, v237
  v_cvt_pk_bf16_f32 v109, v238, v239
  v_cvt_pk_bf16_f32 v110, v240, v241
  v_cvt_pk_bf16_f32 v111, v242, v243
  s_waitcnt lgkmcnt(7)
  v_mfma_f32_16x16x32_bf16 v[164:167], v[220:223], v[40:43], v[164:167]
  ds_read_b128 v[216:219], v3 offset:15360
  v_mfma_f32_16x16x32_bf16 v[172:175], v[220:223], v[44:47], v[172:175]
  s_waitcnt vmcnt(11)
  v_lshlrev_b32 v228, 16, v112
  v_and_b32 v229, 0xffff0000, v112
  v_lshlrev_b32 v230, 16, v113
  v_and_b32 v231, 0xffff0000, v113
  v_lshlrev_b32 v232, 16, v114
  v_and_b32 v233, 0xffff0000, v114
  v_lshlrev_b32 v234, 16, v115
  v_and_b32 v235, 0xffff0000, v115
  v_pk_fma_f32 v[228:229], v[228:229], v[4:5], v[6:7] op_sel_hi:[1,0,0]
  v_pk_fma_f32 v[230:231], v[230:231], v[4:5], v[6:7] op_sel_hi:[1,0,0]
  v_pk_fma_f32 v[232:233], v[232:233], v[4:5], v[6:7] op_sel_hi:[1,0,0]
  v_pk_fma_f32 v[234:235], v[234:235], v[4:5], v[6:7] op_sel_hi:[1,0,0]
  v_cvt_pk_bf16_f32 v112, v228, v229
  v_cvt_pk_bf16_f32 v113, v230, v231
  v_cvt_pk_bf16_f32 v114, v232, v233
  v_cvt_pk_bf16_f32 v115, v234, v235
  s_waitcnt lgkmcnt(7)
  v_mfma_f32_16x16x32_bf16 v[160:163], v[224:227], v[48:51], v[160:163]
  ds_read_b128 v[220:223], v3 offset:16384
  v_mfma_f32_16x16x32_bf16 v[168:171], v[224:227], v[52:55], v[168:171]
  s_waitcnt vmcnt(10)
  v_lshlrev_b32 v236, 16, v116
  v_and_b32 v237, 0xffff0000, v116
  v_lshlrev_b32 v238, 16, v117
  v_and_b32 v239, 0xffff0000, v117
  v_lshlrev_b32 v240, 16, v118
  v_and_b32 v241, 0xffff0000, v118
  v_lshlrev_b32 v242, 16, v119
  v_and_b32 v243, 0xffff0000, v119
  v_pk_fma_f32 v[236:237], v[236:237], v[12:13], v[14:15] op_sel_hi:[1,0,0]
  v_pk_fma_f32 v[238:239], v[238:239], v[12:13], v[14:15] op_sel_hi:[1,0,0]
  v_pk_fma_f32 v[240:241], v[240:241], v[12:13], v[14:15] op_sel_hi:[1,0,0]
  v_pk_fma_f32 v[242:243], v[242:243], v[12:13], v[14:15] op_sel_hi:[1,0,0]
  v_cvt_pk_bf16_f32 v116, v236, v237
  v_cvt_pk_bf16_f32 v117, v238, v239
  v_cvt_pk_bf16_f32 v118, v240, v241
  v_cvt_pk_bf16_f32 v119, v242, v243
  s_waitcnt lgkmcnt(7)
  v_mfma_f32_16x16x32_bf16 v[164:167], v[192:195], v[48:51], v[164:167]
  ds_read_b128 v[224:227], v3 offset:17408
  v_mfma_f32_16x16x32_bf16 v[172:175], v[192:195], v[52:55], v[172:175]
  s_waitcnt vmcnt(9)
  v_lshlrev_b32 v228, 16, v120
  v_and_b32 v229, 0xffff0000, v120
  v_lshlrev_b32 v230, 16, v121
  v_and_b32 v231, 0xffff0000, v121
  v_lshlrev_b32 v232, 16, v122
  v_and_b32 v233, 0xffff0000, v122
  v_lshlrev_b32 v234, 16, v123
  v_and_b32 v235, 0xffff0000, v123
  v_pk_fma_f32 v[228:229], v[228:229], v[4:5], v[6:7] op_sel_hi:[1,0,0]
  v_pk_fma_f32 v[230:231], v[230:231], v[4:5], v[6:7] op_sel_hi:[1,0,0]
  v_pk_fma_f32 v[232:233], v[232:233], v[4:5], v[6:7] op_sel_hi:[1,0,0]
  v_pk_fma_f32 v[234:235], v[234:235], v[4:5], v[6:7] op_sel_hi:[1,0,0]
  v_cvt_pk_bf16_f32 v120, v228, v229
  v_cvt_pk_bf16_f32 v121, v230, v231
  v_cvt_pk_bf16_f32 v122, v232, v233
  v_cvt_pk_bf16_f32 v123, v234, v235
  s_waitcnt lgkmcnt(7)
  v_mfma_f32_16x16x32_bf16 v[160:163], v[196:199], v[56:59], v[160:163]
  ds_read_b128 v[192:195], v3 offset:18432
  v_mfma_f32_16x16x32_bf16 v[168:171], v[196:199], v[60:63], v[168:171]
  s_waitcnt vmcnt(8)
  v_lshlrev_b32 v236, 16, v124
  v_and_b32 v237, 0xffff0000, v124
  v_lshlrev_b32 v238, 16, v125
  v_and_b32 v239, 0xffff0000, v125
  v_lshlrev_b32 v240, 16, v126
  v_and_b32 v241, 0xffff0000, v126
  v_lshlrev_b32 v242, 16, v127
  v_and_b32 v243, 0xffff0000, v127
  v_pk_fma_f32 v[236:237], v[236:237], v[12:13], v[14:15] op_sel_hi:[1,0,0]
  v_pk_fma_f32 v[238:239], v[238:239], v[12:13], v[14:15] op_sel_hi:[1,0,0]
  v_pk_fma_f32 v[240:241], v[240:241], v[12:13], v[14:15] op_sel_hi:[1,0,0]
  v_pk_fma_f32 v[242:243], v[242:243], v[12:13], v[14:15] op_sel_hi:[1,0,0]
  v_cvt_pk_bf16_f32 v124, v236, v237
  v_cvt_pk_bf16_f32 v125, v238, v239
  v_cvt_pk_bf16_f32 v126, v240, v241
  v_cvt_pk_bf16_f32 v127, v242, v243
  s_waitcnt lgkmcnt(7)
  v_mfma_f32_16x16x32_bf16 v[164:167], v[200:203], v[56:59], v[164:167]
  ds_read_b128 v[196:199], v3 offset:19456
  v_mfma_f32_16x16x32_bf16 v[172:175], v[200:203], v[60:63], v[172:175]
  s_waitcnt vmcnt(7)
  v_lshlrev_b32 v228, 16, v128
  v_and_b32 v229, 0xffff0000, v128
  v_lshlrev_b32 v230, 16, v129
  v_and_b32 v231, 0xffff0000, v129
  v_lshlrev_b32 v232, 16, v130
  v_and_b32 v233, 0xffff0000, v130
  v_lshlrev_b32 v234, 16, v131
  v_and_b32 v235, 0xffff0000, v131
  v_pk_fma_f32 v[228:229], v[228:229], v[4:5], v[6:7] op_sel_hi:[1,0,0]
  v_pk_fma_f32 v[230:231], v[230:231], v[4:5], v[6:7] op_sel_hi:[1,0,0]
  v_pk_fma_f32 v[232:233], v[232:233], v[4:5], v[6:7] op_sel_hi:[1,0,0]
  v_pk_fma_f32 v[234:235], v[234:235], v[4:5], v[6:7] op_sel_hi:[1,0,0]
  v_cvt_pk_bf16_f32 v128, v228, v229
  v_cvt_pk_bf16_f32 v129, v230, v231
  v_cvt_pk_bf16_f32 v130, v232, v233
  v_cvt_pk_bf16_f32 v131, v234, v235
  s_waitcnt lgkmcnt(7)
  v_mfma_f32_16x16x32_bf16 v[160:163], v[204:207], v[64:67], v[160:163]
  ds_read_b128 v[200:203], v3 offset:20480
  v_mfma_f32_16x16x32_bf16 v[168:171], v[204:207], v[68:71], v[168:171]
  s_waitcnt vmcnt(6)
  v_lshlrev_b32 v236, 16, v132
  v_and_b32 v237, 0xffff0000, v132
  v_lshlrev_b32 v238, 16, v133
  v_and_b32 v239, 0xffff0000, v133
  v_lshlrev_b32 v240, 16, v134
  v_and_b32 v241, 0xffff0000, v134
  v_lshlrev_b32 v242, 16, v135
  v_and_b32 v243, 0xffff0000, v135
  v_pk_fma_f32 v[236:237], v[236:237], v[12:13], v[14:15] op_sel_hi:[1,0,0]
  v_pk_fma_f32 v[238:239], v[238:239], v[12:13], v[14:15] op_sel_hi:[1,0,0]
  v_pk_fma_f32 v[240:241], v[240:241], v[12:13], v[14:15] op_sel_hi:[1,0,0]
  v_pk_fma_f32 v[242:243], v[242:243], v[12:13], v[14:15] op_sel_hi:[1,0,0]
  v_cvt_pk_bf16_f32 v132, v236, v237
  v_cvt_pk_bf16_f32 v133, v238, v239
  v_cvt_pk_bf16_f32 v134, v240, v241
  v_cvt_pk_bf16_f32 v135, v242, v243
  s_waitcnt lgkmcnt(7)
  v_mfma_f32_16x16x32_bf16 v[164:167], v[208:211], v[64:67], v[164:167]
  ds_read_b128 v[204:207], v3 offset:21504
  v_mfma_f32_16x16x32_bf16 v[172:175], v[208:211], v[68:71], v[172:175]
  s_waitcnt vmcnt(5)
  v_lshlrev_b32 v228, 16, v136
  v_and_b32 v229, 0xffff0000, v136
  v_lshlrev_b32 v230, 16, v137
  v_and_b32 v231, 0xffff0000, v137
  v_lshlrev_b32 v232, 16, v138
  v_and_b32 v233, 0xffff0000, v138
  v_lshlrev_b32 v234, 16, v139
  v_and_b32 v235, 0xffff0000, v139
  v_pk_fma_f32 v[228:229], v[228:229], v[4:5], v[6:7] op_sel_hi:[1,0,0]
  v_pk_fma_f32 v[230:231], v[230:231], v[4:5], v[6:7] op_sel_hi:[1,0,0]
  v_pk_fma_f32 v[232:233], v[232:233], v[4:5], v[6:7] op_sel_hi:[1,0,0]
  v_pk_fma_f32 v[234:235], v[234:235], v[4:5], v[6:7] op_sel_hi:[1,0,0]
  v_cvt_pk_bf16_f32 v136, v228, v229
  v_cvt_pk_bf16_f32 v137, v230, v231
  v_cvt_pk_bf16_f32 v138, v232, v233
  v_cvt_pk_bf16_f32 v139, v234, v235
  s_waitcnt lgkmcnt(7)
  v_mfma_f32_16x16x32_bf16 v[160:163], v[212:215], v[72:75], v[160:163]
  ds_read_b128 v[208:211], v3 offset:22528
  v_mfma_f32_16x16x32_bf16 v[168:171], v[212:215], v[76:79], v[168:171]
  s_waitcnt vmcnt(4)
  v_lshlrev_b32 v236, 16, v140
  v_and_b32 v237, 0xffff0000, v140
  v_lshlrev_b32 v238, 16, v141
  v_and_b32 v239, 0xffff0000, v141
  v_lshlrev_b32 v240, 16, v142
  v_and_b32 v241, 0xffff0000, v142
  v_lshlrev_b32 v242, 16, v143
  v_and_b32 v243, 0xffff0000, v143
  v_pk_fma_f32 v[236:237], v[236:237], v[12:13], v[14:15] op_sel_hi:[1,0,0]
  v_pk_fma_f32 v[238:239], v[238:239], v[12:13], v[14:15] op_sel_hi:[1,0,0]
  v_pk_fma_f32 v[240:241], v[240:241], v[12:13], v[14:15] op_sel_hi:[1,0,0]
  v_pk_fma_f32 v[242:243], v[242:243], v[12:13], v[14:15] op_sel_hi:[1,0,0]
  v_cvt_pk_bf16_f32 v140, v236, v237
  v_cvt_pk_bf16_f32 v141, v238, v239
  v_cvt_pk_bf16_f32 v142, v240, v241
  v_cvt_pk_bf16_f32 v143, v242, v243
  s_waitcnt lgkmcnt(7)
  v_mfma_f32_16x16x32_bf16 v[164:167], v[216:219], v[72:75], v[164:167]
  ds_read_b128 v[212:215], v3 offset:23552
  v_mfma_f32_16x16x32_bf16 v[172:175], v[216:219], v[76:79], v[172:175]
  s_waitcnt vmcnt(3)
  v_lshlrev_b32 v228, 16, v144
  v_and_b32 v229, 0xffff0000, v144
  v_lshlrev_b32 v230, 16, v145
  v_and_b32 v231, 0xffff0000, v145
  v_lshlrev_b32 v232, 16, v146
  v_and_b32 v233, 0xffff0000, v146
  v_lshlrev_b32 v234, 16, v147
  v_and_b32 v235, 0xffff0000, v147
  v_pk_fma_f32 v[228:229], v[228:229], v[4:5], v[6:7] op_sel_hi:[1,0,0]
  v_pk_fma_f32 v[230:231], v[230:231], v[4:5], v[6:7] op_sel_hi:[1,0,0]
  v_pk_fma_f32 v[232:233], v[232:233], v[4:5], v[6:7] op_sel_hi:[1,0,0]
  v_pk_fma_f32 v[234:235], v[234:235], v[4:5], v[6:7] op_sel_hi:[1,0,0]
  v_cvt_pk_bf16_f32 v144, v228, v229
  v_cvt_pk_bf16_f32 v145, v230, v231
  v_cvt_pk_bf16_f32 v146, v232, v233
  v_cvt_pk_bf16_f32 v147, v234, v235
  s_waitcnt lgkmcnt(7)
  v_mfma_f32_16x16x32_bf16 v[160:163], v[220:223], v[80:83], v[160:163]
  ds_read_b128 v[216:219], v3 offset:24576
  v_mfma_f32_16x16x32_bf16 v[168:171], v[220:223], v[84:87], v[168:171]
  s_waitcnt vmcnt(2)
  v_lshlrev_b32 v236, 16, v148
  v_and_b32 v237, 0xffff0000, v148
  v_lshlrev_b32 v238, 16, v149
  v_and_b32 v239, 0xffff0000, v149
  v_lshlrev_b32 v240, 16, v150
  v_and_b32 v241, 0xffff0000, v150
  v_lshlrev_b32 v242, 16, v151
  v_and_b32 v243, 0xffff0000, v151
  v_pk_fma_f32 v[236:237], v[236:237], v[12:13], v[14:15] op_sel_hi:[1,0,0]
  v_pk_fma_f32 v[238:239], v[238:239], v[12:13], v[14:15] op_sel_hi:[1,0,0]
  v_pk_fma_f32 v[240:241], v[240:241], v[12:13], v[14:15] op_sel_hi:[1,0,0]
  v_pk_fma_f32 v[242:243], v[242:243], v[12:13], v[14:15] op_sel_hi:[1,0,0]
  v_cvt_pk_bf16_f32 v148, v236, v237
  v_cvt_pk_bf16_f32 v149, v238, v239
  v_cvt_pk_bf16_f32 v150, v240, v241
  v_cvt_pk_bf16_f32 v151, v242, v243
  s_waitcnt lgkmcnt(7)
  v_mfma_f32_16x16x32_bf16 v[164:167], v[224:227], v[80:83], v[164:167]
  ds_read_b128 v[220:223], v3 offset:25600
  v_mfma_f32_16x16x32_bf16 v[172:175], v[224:227], v[84:87], v[172:175]
  s_waitcnt vmcnt(1)
  v_lshlrev_b32 v228, 16, v152
  v_and_b32 v229, 0xffff0000, v152
  v_lshlrev_b32 v230, 16, v153
  v_and_b32 v231, 0xffff0000, v153
  v_lshlrev_b32 v232, 16, v154
  v_and_b32 v233, 0xffff0000, v154
  v_lshlrev_b32 v234, 16, v155
  v_and_b32 v235, 0xffff0000, v155
  v_pk_fma_f32 v[228:229], v[228:229], v[4:5], v[6:7] op_sel_hi:[1,0,0]
  v_pk_fma_f32 v[230:231], v[230:231], v[4:5], v[6:7] op_sel_hi:[1,0,0]
  v_pk_fma_f32 v[232:233], v[232:233], v[4:5], v[6:7] op_sel_hi:[1,0,0]
  v_pk_fma_f32 v[234:235], v[234:235], v[4:5], v[6:7] op_sel_hi:[1,0,0]
  v_cvt_pk_bf16_f32 v152, v228, v229
  v_cvt_pk_bf16_f32 v153, v230, v231
  v_cvt_pk_bf16_f32 v154, v232, v233
  v_cvt_pk_bf16_f32 v155, v234, v235
  s_waitcnt lgkmcnt(7)
  v_mfma_f32_16x16x32_bf16 v[160:163], v[192:195], v[88:91], v[160:163]
  ds_read_b128 v[224:227], v3 offset:26624
  v_mfma_f32_16x16x32_bf16 v[168:171], v[192:195], v[92:95], v[168:171]
  s_waitcnt vmcnt(0)
  v_lshlrev_b32 v236, 16, v156
  v_and_b32 v237, 0xffff0000, v156
  v_lshlrev_b32 v238, 16, v157
  v_and_b32 v239, 0xffff0000, v157
  v_lshlrev_b32 v240, 16, v158
  v_and_b32 v241, 0xffff0000, v158
  v_lshlrev_b32 v242, 16, v159
  v_and_b32 v243, 0xffff0000, v159
  v_pk_fma_f32 v[236:237], v[236:237], v[12:13], v[14:15] op_sel_hi:[1,0,0]
  v_pk_fma_f32 v[238:239], v[238:239], v[12:13], v[14:15] op_sel_hi:[1,0,0]
  v_pk_fma_f32 v[240:241], v[240:241], v[12:13], v[14:15] op_sel_hi:[1,0,0]
  v_pk_fma_f32 v[242:243], v[242:243], v[12:13], v[14:15] op_sel_hi:[1,0,0]
  v_cvt_pk_bf16_f32 v156, v236, v237
  v_cvt_pk_bf16_f32 v157, v238, v239
  v_cvt_pk_bf16_f32 v158, v240, v241
  v_cvt_pk_bf16_f32 v159, v242, v243
  s_waitcnt lgkmcnt(7)
  v_mfma_f32_16x16x32_bf16 v[164:167], v[196:199], v[88:91], v[164:167]
  ds_read_b128 v[192:195], v3 offset:27648
  v_mfma_f32_16x16x32_bf16 v[172:175], v[196:199], v[92:95], v[172:175]
  s_waitcnt lgkmcnt(7)
  v_mfma_f32_16x16x32_bf16 v[160:163], v[200:203], v[96:99], v[160:163]
  ds_read_b128 v[196:199], v3 offset:28672
  v_mfma_f32_16x16x32_bf16 v[168:171], v[200:203], v[100:103], v[168:171]
  s_add_u32 s40, s40, 36864
  s_cmp_ge_u32 s40, 147456
  s_cselect_b32 s40, 0, s40
  s_waitcnt lgkmcnt(7)
  v_mfma_f32_16x16x32_bf16 v[164:167], v[204:207], v[96:99], v[164:167]
  ds_read_b128 v[200:203], v3 offset:29696
  v_mfma_f32_16x16x32_bf16 v[172:175], v[204:207], v[100:103], v[172:175]
  s_waitcnt lgkmcnt(7)
  v_mfma_f32_16x16x32_bf16 v[160:163], v[208:211], v[104:107], v[160:163]
  ds_read_b128 v[204:207], v3 offset:30720
  v_mfma_f32_16x16x32_bf16 v[168:171], v[208:211], v[108:111], v[168:171]
  s_waitcnt lgkmcnt(7)
  v_mfma_f32_16x16x32_bf16 v[164:167], v[212:215], v[104:107], v[164:167]
  ds_read_b128 v[208:211], v3 offset:31744
  v_mfma_f32_16x16x32_bf16 v[172:175], v[212:215], v[108:111], v[172:175]
  s_waitcnt lgkmcnt(7)
  v_mfma_f32_16x16x32_bf16 v[160:163], v[216:219], v[112:115], v[160:163]
  ds_read_b128 v[212:215], v3 offset:32768
  v_mfma_f32_16x16x32_bf16 v[168:171], v[216:219], v[116:119], v[168:171]
  s_waitcnt lgkmcnt(7)
  v_mfma_f32_16x16x32_bf16 v[164:167], v[220:223], v[112:115], v[164:167]
  ds_read_b128 v[216:219], v3 offset:33792
  v_mfma_f32_16x16x32_bf16 v[172:175], v[220:223], v[116:119], v[172:175]
  s_waitcnt lgkmcnt(7)
  v_mfma_f32_16x16x32_bf16 v[160:163], v[224:227], v[120:123], v[160:163]
  ds_read_b128 v[220:223], v3 offset:34816
  v_mfma_f32_16x16x32_bf16 v[168:171], v[224:227], v[124:127], v[168:171]
  s_waitcnt lgkmcnt(7)
  v_mfma_f32_16x16x32_bf16 v[164:167], v[192:195], v[120:123], v[164:167]
  ds_read_b128 v[224:227], v3 offset:35840
  v_mfma_f32_16x16x32_bf16 v[172:175], v[192:195], v[124:127], v[172:175]
  s_barrier
  v_add_u32 v3, s40, v2
  s_waitcnt lgkmcnt(7)
  v_mfma_f32_16x16x32_bf16 v[160:163], v[196:199], v[128:131], v[160:163]
  ds_read_b128 v[192:195], v3 offset:0
  v_mfma_f32_16x16x32_bf16 v[168:171], v[196:199], v[132:135], v[168:171]
  s_waitcnt lgkmcnt(7)
  v_mfma_f32_16x16x32_bf16 v[164:167], v[200:203], v[128:131], v[164:167]
  ds_read_b128 v[196:199], v3 offset:1024
  v_mfma_f32_16x16x32_bf16 v[172:175], v[200:203], v[132:135], v[172:175]
  s_waitcnt lgkmcnt(7)
  v_mfma_f32_16x16x32_bf16 v[160:163], v[204:207], v[136:139], v[160:163]
  ds_read_b128 v[200:203], v3 offset:2048
  v_mfma_f32_16x16x32_bf16 v[168:171], v[204:207], v[140:143], v[168:171]
  s_waitcnt lgkmcnt(7)
  v_mfma_f32_16x16x32_bf16 v[164:167], v[208:211], v[136:139], v[164:167]
  ds_read_b128 v[204:207], v3 offset:3072
  v_mfma_f32_16x16x32_bf16 v[172:175], v[208:211], v[140:143], v[172:175]
  s_waitcnt lgkmcnt(7)
  v_mfma_f32_16x16x32_bf16 v[160:163], v[212:215], v[144:147], v[160:163]
  ds_read_b128 v[208:211], v3 offset:4096
  v_mfma_f32_16x16x32_bf16 v[168:171], v[212:215], v[148:151], v[168:171]
  s_waitcnt lgkmcnt(7)
  v_mfma_f32_16x16x32_bf16 v[164:167], v[216:219], v[144:147], v[164:167]
  ds_read_b128 v[212:215], v3 offset:5120
  v_mfma_f32_16x16x32_bf16 v[172:175], v[216:219], v[148:151], v[172:175]
  s_waitcnt lgkmcnt(7)
  v_mfma_f32_16x16x32_bf16 v[160:163], v[220:223], v[152:155], v[160:163]
  ds_read_b128 v[216:219], v3 offset:6144
  v_mfma_f32_16x16x32_bf16 v[168:171], v[220:223], v[156:159], v[168:171]
  s_waitcnt lgkmcnt(7)
  v_mfma_f32_16x16x32_bf16 v[164:167], v[224:227], v[152:155], v[164:167]
  ds_read_b128 v[220:223], v3 offset:7168
  v_mfma_f32_16x16x32_bf16 v[172:175], v[224:227], v[156:159], v[172:175]
  s_mov_b32 s41, 4
LP_chain1_k_87:
  s_waitcnt lgkmcnt(2)
  v_mfma_f32_16x16x32_bf16 v[176:179], v[192:195], v[16:19], 0
  ds_read_b128 v[224:227], v3 offset:8192
  v_mfma_f32_16x16x32_bf16 v[184:187], v[192:195], v[20:23], 0
  v_mfma_f32_16x16x32_bf16 v[180:183], v[196:199], v[16:19], 0
  ds_read_b128 v[192:195], v3 offset:9216
  v_mfma_f32_16x16x32_bf16 v[188:191], v[196:199], v[20:23], 0
  v_mfma_f32_16x16x32_bf16 v[176:179], v[200:203], v[24:27], v[176:179]
  ds_read_b128 v[196:199], v3 offset:10240
  v_exp_f32 v228, v160
  v_mfma_f32_16x16x32_bf16 v[184:187], v[200:203], v[28:31], v[184:187]
  v_exp_f32 v229, v161
  v_mfma_f32_16x16x32_bf16 v[180:183], v[204:207], v[24:27], v[180:183]
  ds_read_b128 v[200:203], v3 offset:11264
  v_add_f32 v228, 1.0, v228
  v_mfma_f32_16x16x32_bf16 v[188:191], v[204:207], v[28:31], v[188:191]
  v_exp_f32 v230, v162
  v_mfma_f32_16x16x32_bf16 v[176:179], v[208:211], v[32:35], v[176:179]
  ds_read_b128 v[204:207], v3 offset:12288
  v_add_f32 v229, 1.0, v229
  v_mfma_f32_16x16x32_bf16 v[184:187], v[208:211], v[36:39], v[184:187]
  v_rcp_f32 v228, v228
  v_mfma_f32_16x16x32_bf16 v[180:183], v[212:215], v[32:35], v[180:183]
  ds_read_b128 v[208:211], v3 offset:13312
  v_exp_f32 v231, v163
  v_mfma_f32_16x16x32_bf16 v[188:191], v[212:215], v[36:39], v[188:191]
  v_add_f32 v230, 1.0, v230
  s_waitcnt lgkmcnt(2)
  v_mfma_f32_16x16x32_bf16 v[176:179], v[216:219], v[40:43], v[176:179]
  ds_read_b128 v[212:215], v3 offset:14336
  v_rcp_f32 v229, v229
  v_mul_f32 v228, v160, v228
  v_mfma_f32_16x16x32_bf16 v[184:187], v[216:219], v[44:47], v[184:187]
  v_exp_f32 v232, v164
  v_mfma_f32_16x16x32_bf16 v[180:183], v[220:223], v[40:43], v[180:183]
  ds_read_b128 v[216:219], v3 offset:15360
  v_add_f32 v231, 1.0, v231
  v_mfma_f32_16x16x32_bf16 v[188:191], v[220:223], v[44:47], v[188:191]
  v_rcp_f32 v230, v230
  v_mfma_f32_16x16x32_bf16 v[176:179], v[224:227], v[48:51], v[176:179]
  ds_read_b128 v[220:223], v3 offset:16384
  v_mul_f32 v229, v161, v229
  v_cvt_pk_bf16_f32 v244, v228, v229
  v_mfma_f32_16x16x32_bf16 v[184:187], v[224:227], v[52:55], v[184:187]
  v_exp_f32 v233, v165
  v_mfma_f32_16x16x32_bf16 v[180:183], v[192:195], v[48:51], v[180:183]
  ds_read_b128 v[224:227], v3 offset:17408
  v_add_f32 v232, 1.0, v232
  v_mfma_f32_16x16x32_bf16 v[188:191], v[192:195], v[52:55], v[188:191]
  v_rcp_f32 v231, v231
  v_mfma_f32_16x16x32_bf16 v[176:179], v[196:199], v[56:59], v[176:179]
  ds_read_b128 v[192:195], v3 offset:18432
  v_mul_f32 v230, v162, v230
  v_mfma_f32_16x16x32_bf16 v[184:187], v[196:199], v[60:63], v[184:187]
  v_exp_f32 v234, v166
  v_mfma_f32_16x16x32_bf16 v[180:183], v[200:203], v[56:59], v[180:183]
  ds_read_b128 v[196:199], v3 offset:19456
  v_add_f32 v233, 1.0, v233
  v_mfma_f32_16x16x32_bf16 v[188:191], v[200:203], v[60:63], v[188:191]
  v_rcp_f32 v232, v232
  v_mul_f32 v231, v163, v231
  s_waitcnt lgkmcnt(2)
  v_mfma_f32_16x16x32_bf16 v[176:179], v[204:207], v[64:67], v[176:179]
  ds_read_b128 v[200:203], v3 offset:20480
  v_cvt_pk_bf16_f32 v245, v230, v231
  v_mfma_f32_16x16x32_bf16 v[184:187], v[204:207], v[68:71], v[184:187]
  v_exp_f32 v235, v167
  v_mfma_f32_16x16x32_bf16 v[180:183], v[208:211], v[64:67], v[180:183]
  ds_read_b128 v[204:207], v3 offset:21504
  v_add_f32 v234, 1.0, v234
  v_mfma_f32_16x16x32_bf16 v[188:191], v[208:211], v[68:71], v[188:191]
  v_rcp_f32 v233, v233
  v_mul_f32 v232, v164, v232
  v_mfma_f32_16x16x32_bf16 v[176:179], v[212:215], v[72:75], v[176:179]
  ds_read_b128 v[208:211], v3 offset:22528
  v_exp_f32 v236, v168
  v_mfma_f32_16x16x32_bf16 v[184:187], v[212:215], v[76:79], v[184:187]
  v_add_f32 v235, 1.0, v235
  v_mfma_f32_16x16x32_bf16 v[180:183], v[216:219], v[72:75], v[180:183]
  ds_read_b128 v[212:215], v3 offset:23552
  v_rcp_f32 v234, v234
  v_mfma_f32_16x16x32_bf16 v[188:191], v[216:219], v[76:79], v[188:191]
  v_mul_f32 v233, v165, v233
  v_cvt_pk_bf16_f32 v246, v232, v233
  v_mfma_f32_16x16x32_bf16 v[176:179], v[220:223], v[80:83], v[176:179]
  ds_read_b128 v[216:219], v3 offset:24576
  v_exp_f32 v237, v169
  v_mfma_f32_16x16x32_bf16 v[184:187], v[220:223], v[84:87], v[184:187]
  v_add_f32 v236, 1.0, v236
  v_mfma_f32_16x16x32_bf16 v[180:183], v[224:227], v[80:83], v[180:183]
  ds_read_b128 v[220:223], v3 offset:25600
  v_rcp_f32 v235, v235
  v_mfma_f32_16x16x32_bf16 v[188:191], v[224:227], v[84:87], v[188:191]
  v_mul_f32 v234, v166, v234
  s_waitcnt lgkmcnt(2)
  v_mfma_f32_16x16x32_bf16 v[176:179], v[192:195], v[88:91], v[176:179]
  ds_read_b128 v[224:227], v3 offset:26624
  v_exp_f32 v238, v170
  v_mfma_f32_16x16x32_bf16 v[184:187], v[192:195], v[92:95], v[184:187]
  v_add_f32 v237, 1.0, v237
  v_mfma_f32_16x16x32_bf16 v[180:183], v[196:199], v[88:91], v[180:183]
  ds_read_b128 v[192:195], v3 offset:27648
  v_rcp_f32 v236, v236
  v_mul_f32 v235, v167, v235
  v_mfma_f32_16x16x32_bf16 v[188:191], v[196:199], v[92:95], v[188:191]
  v_cvt_pk_bf16_f32 v247, v234, v235
  v_mfma_f32_16x16x32_bf16 v[176:179], v[200:203], v[96:99], v[176:179]
  ds_read_b128 v[196:199], v3 offset:28672
  v_exp_f32 v239, v171
  v_mfma_f32_16x16x32_bf16 v[184:187], v[200:203], v[100:103], v[184:187]
  s_add_u32 s40, s40, 36864
  s_cmp_ge_u32 s40, 147456
  s_cselect_b32 s40, 0, s40
  v_add_f32 v238, 1.0, v238
  v_mfma_f32_16x16x32_bf16 v[180:183], v[204:207], v[96:99], v[180:183]
  ds_read_b128 v[200:203], v3 offset:29696
  v_rcp_f32 v237, v237
  v_mul_f32 v236, v168, v236
  v_mfma_f32_16x16x32_bf16 v[188:191], v[204:207], v[100:103], v[188:191]
  v_exp_f32 v240, v172
  v_mfma_f32_16x16x32_bf16 v[176:179], v[208:211], v[104:107], v[176:179]
  ds_read_b128 v[204:207], v3 offset:30720
  v_add_f32 v239, 1.0, v239
  v_mfma_f32_16x16x32_bf16 v[184:187], v[208:211], v[108:111], v[184:187]
  v_rcp_f32 v238, v238
  v_mfma_f32_16x16x32_bf16 v[180:183], v[212:215], v[104:107], v[180:183]
  ds_read_b128 v[208:211], v3 offset:31744
  v_mul_f32 v237, v169, v237
  v_cvt_pk_bf16_f32 v248, v236, v237
  v_mfma_f32_16x16x32_bf16 v[188:191], v[212:215], v[108:111], v[188:191]
  v_exp_f32 v241, v173
  s_waitcnt lgkmcnt(2)
  v_mfma_f32_16x16x32_bf16 v[176:179], v[216:219], v[112:115], v[176:179]
  ds_read_b128 v[212:215], v3 offset:32768
  v_add_f32 v240, 1.0, v240
  v_mfma_f32_16x16x32_bf16 v[184:187], v[216:219], v[116:119], v[184:187]
  v_rcp_f32 v239, v239
  v_mfma_f32_16x16x32_bf16 v[180:183], v[220:223], v[112:115], v[180:183]
  ds_read_b128 v[216:219], v3 offset:33792
  v_mul_f32 v238, v170, v238
  v_mfma_f32_16x16x32_bf16 v[188:191], v[220:223], v[116:119], v[188:191]
  v_exp_f32 v242, v174
  v_mfma_f32_16x16x32_bf16 v[176:179], v[224:227], v[120:123], v[176:179]
  ds_read_b128 v[220:223], v3 offset:34816
  v_add_f32 v241, 1.0, v241
  v_mfma_f32_16x16x32_bf16 v[184:187], v[224:227], v[124:127], v[184:187]
  v_rcp_f32 v240, v240
  v_mul_f32 v239, v171, v239
  v_mfma_f32_16x16x32_bf16 v[180:183], v[192:195], v[120:123], v[180:183]
  ds_read_b128 v[224:227], v3 offset:35840
  v_cvt_pk_bf16_f32 v249, v238, v239
  v_mfma_f32_16x16x32_bf16 v[188:191], v[192:195], v[124:127], v[188:191]
  v_exp_f32 v243, v175
  s_barrier
  v_add_u32 v3, s40, v2
  v_mfma_f32_16x16x32_bf16 v[176:179], v[196:199], v[128:131], v[176:179]
  ds_read_b128 v[192:195], v3 offset:0
  v_add_f32 v242, 1.0, v242
  v_mfma_f32_16x16x32_bf16 v[184:187], v[196:199], v[132:135], v[184:187]
  v_rcp_f32 v241, v241
  v_mul_f32 v240, v172, v240
  v_mfma_f32_16x16x32_bf16 v[180:183], v[200:203], v[128:131], v[180:183]
  ds_read_b128 v[196:199], v3 offset:1024
  v_add_f32 v243, 1.0, v243
  v_mfma_f32_16x16x32_bf16 v[188:191], v[200:203], v[132:135], v[188:191]
  v_rcp_f32 v242, v242
  s_waitcnt lgkmcnt(2)
  v_mfma_f32_16x16x32_bf16 v[176:179], v[204:207], v[136:139], v[176:179]
  ds_read_b128 v[200:203], v3 offset:2048
  v_mul_f32 v241, v173, v241
  v_cvt_pk_bf16_f32 v250, v240, v241
  v_mfma_f32_16x16x32_bf16 v[184:187], v[204:207], v[140:143], v[184:187]
  v_rcp_f32 v243, v243
  v_mfma_f32_16x16x32_bf16 v[180:183], v[208:211], v[136:139], v[180:183]
  ds_read_b128 v[204:207], v3 offset:3072
  v_mul_f32 v242, v174, v242
  v_mfma_f32_16x16x32_bf16 v[188:191], v[208:211], v[140:143], v[188:191]
  v_mul_f32 v243, v175, v243
  v_cvt_pk_bf16_f32 v251, v242, v243
  v_mfma_f32_16x16x32_bf16 v[176:179], v[212:215], v[144:147], v[176:179]
  ds_read_b128 v[208:211], v3 offset:4096
  v_mfma_f32_16x16x32_bf16 v[184:187], v[212:215], v[148:151], v[184:187]
  v_mfma_f32_16x16x32_bf16 v[180:183], v[216:219], v[144:147], v[180:183]
  ds_read_b128 v[212:215], v3 offset:5120
  v_mfma_f32_16x16x32_bf16 v[188:191], v[216:219], v[148:151], v[188:191]
  buffer_store_dwordx4 v[244:247], v9, s[8:11], s38 offen sc1
  v_mfma_f32_16x16x32_bf16 v[176:179], v[220:223], v[152:155], v[176:179]
  ds_read_b128 v[216:219], v3 offset:6144
  v_mfma_f32_16x16x32_bf16 v[184:187], v[220:223], v[156:159], v[184:187]
  v_mfma_f32_16x16x32_bf16 v[180:183], v[224:227], v[152:155], v[180:183]
  ds_read_b128 v[220:223], v3 offset:7168
  v_mfma_f32_16x16x32_bf16 v[188:191], v[224:227], v[156:159], v[188:191]
  buffer_store_dwordx4 v[248:251], v9, s[8:11], s38 offen offset:256 sc1
  s_add_u32 s38, s38, 2048
  s_waitcnt lgkmcnt(2)
  v_mfma_f32_16x16x32_bf16 v[160:163], v[192:195], v[16:19], 0
  ds_read_b128 v[224:227], v3 offset:8192
  v_mfma_f32_16x16x32_bf16 v[168:171], v[192:195], v[20:23], 0
  v_mfma_f32_16x16x32_bf16 v[164:167], v[196:199], v[16:19], 0
  ds_read_b128 v[192:195], v3 offset:9216
  v_mfma_f32_16x16x32_bf16 v[172:175], v[196:199], v[20:23], 0
  v_mfma_f32_16x16x32_bf16 v[160:163], v[200:203], v[24:27], v[160:163]
  ds_read_b128 v[196:199], v3 offset:10240
  v_exp_f32 v228, v176
  v_mfma_f32_16x16x32_bf16 v[168:171], v[200:203], v[28:31], v[168:171]
  v_exp_f32 v229, v177
  v_mfma_f32_16x16x32_bf16 v[164:167], v[204:207], v[24:27], v[164:167]
  ds_read_b128 v[200:203], v3 offset:11264
  v_add_f32 v228, 1.0, v228
  v_mfma_f32_16x16x32_bf16 v[172:175], v[204:207], v[28:31], v[172:175]
  v_exp_f32 v230, v178
  v_mfma_f32_16x16x32_bf16 v[160:163], v[208:211], v[32:35], v[160:163]
  ds_read_b128 v[204:207], v3 offset:12288
  v_add_f32 v229, 1.0, v229
  v_mfma_f32_16x16x32_bf16 v[168:171], v[208:211], v[36:39], v[168:171]
  v_rcp_f32 v228, v228
  v_mfma_f32_16x16x32_bf16 v[164:167], v[212:215], v[32:35], v[164:167]
  ds_read_b128 v[208:211], v3 offset:13312
  v_exp_f32 v231, v179
  v_mfma_f32_16x16x32_bf16 v[172:175], v[212:215], v[36:39], v[172:175]
  v_add_f32 v230, 1.0, v230
  s_waitcnt lgkmcnt(2)
  v_mfma_f32_16x16x32_bf16 v[160:163], v[216:219], v[40:43], v[160:163]
  ds_read_b128 v[212:215], v3 offset:14336
  v_rcp_f32 v229, v229
  v_mul_f32 v228, v176, v228
  v_mfma_f32_16x16x32_bf16 v[168:171], v[216:219], v[44:47], v[168:171]
  v_exp_f32 v232, v180
  v_mfma_f32_16x16x32_bf16 v[164:167], v[220:223], v[40:43], v[164:167]
  ds_read_b128 v[216:219], v3 offset:15360
  v_add_f32 v231, 1.0, v231
  v_mfma_f32_16x16x32_bf16 v[172:175], v[220:223], v[44:47], v[172:175]
  v_rcp_f32 v230, v230
  v_mfma_f32_16x16x32_bf16 v[160:163], v[224:227], v[48:51], v[160:163]
  ds_read_b128 v[220:223], v3 offset:16384
  v_mul_f32 v229, v177, v229
  v_cvt_pk_bf16_f32 v244, v228, v229
  v_mfma_f32_16x16x32_bf16 v[168:171], v[224:227], v[52:55], v[168:171]
  v_exp_f32 v233, v181
  v_mfma_f32_16x16x32_bf16 v[164:167], v[192:195], v[48:51], v[164:167]
  ds_read_b128 v[224:227], v3 offset:17408
  v_add_f32 v232, 1.0, v232
  v_mfma_f32_16x16x32_bf16 v[172:175], v[192:195], v[52:55], v[172:175]
  v_rcp_f32 v231, v231
  v_mfma_f32_16x16x32_bf16 v[160:163], v[196:199], v[56:59], v[160:163]
  ds_read_b128 v[192:195], v3 offset:18432
  v_mul_f32 v230, v178, v230
  v_mfma_f32_16x16x32_bf16 v[168:171], v[196:199], v[60:63], v[168:171]
  v_exp_f32 v234, v182
  v_mfma_f32_16x16x32_bf16 v[164:167], v[200:203], v[56:59], v[164:167]
  ds_read_b128 v[196:199], v3 offset:19456
  v_add_f32 v233, 1.0, v233
  v_mfma_f32_16x16x32_bf16 v[172:175], v[200:203], v[60:63], v[172:175]
  v_rcp_f32 v232, v232
  v_mul_f32 v231, v179, v231
  s_waitcnt lgkmcnt(2)
  v_mfma_f32_16x16x32_bf16 v[160:163], v[204:207], v[64:67], v[160:163]
  ds_read_b128 v[200:203], v3 offset:20480
  v_cvt_pk_bf16_f32 v245, v230, v231
  v_mfma_f32_16x16x32_bf16 v[168:171], v[204:207], v[68:71], v[168:171]
  v_exp_f32 v235, v183
  v_mfma_f32_16x16x32_bf16 v[164:167], v[208:211], v[64:67], v[164:167]
  ds_read_b128 v[204:207], v3 offset:21504
  v_add_f32 v234, 1.0, v234
  v_mfma_f32_16x16x32_bf16 v[172:175], v[208:211], v[68:71], v[172:175]
  v_rcp_f32 v233, v233
  v_mul_f32 v232, v180, v232
  v_mfma_f32_16x16x32_bf16 v[160:163], v[212:215], v[72:75], v[160:163]
  ds_read_b128 v[208:211], v3 offset:22528
  v_exp_f32 v236, v184
  v_mfma_f32_16x16x32_bf16 v[168:171], v[212:215], v[76:79], v[168:171]
  v_add_f32 v235, 1.0, v235
  v_mfma_f32_16x16x32_bf16 v[164:167], v[216:219], v[72:75], v[164:167]
  ds_read_b128 v[212:215], v3 offset:23552
  v_rcp_f32 v234, v234
  v_mfma_f32_16x16x32_bf16 v[172:175], v[216:219], v[76:79], v[172:175]
  v_mul_f32 v233, v181, v233
  v_cvt_pk_bf16_f32 v246, v232, v233
  v_mfma_f32_16x16x32_bf16 v[160:163], v[220:223], v[80:83], v[160:163]
  ds_read_b128 v[216:219], v3 offset:24576
  v_exp_f32 v237, v185
  v_mfma_f32_16x16x32_bf16 v[168:171], v[220:223], v[84:87], v[168:171]
  v_add_f32 v236, 1.0, v236
  v_mfma_f32_16x16x32_bf16 v[164:167], v[224:227], v[80:83], v[164:167]
  ds_read_b128 v[220:223], v3 offset:25600
  v_rcp_f32 v235, v235
  v_mfma_f32_16x16x32_bf16 v[172:175], v[224:227], v[84:87], v[172:175]
  v_mul_f32 v234, v182, v234
  s_waitcnt lgkmcnt(2)
  v_mfma_f32_16x16x32_bf16 v[160:163], v[192:195], v[88:91], v[160:163]
  ds_read_b128 v[224:227], v3 offset:26624
  v_exp_f32 v238, v186
  v_mfma_f32_16x16x32_bf16 v[168:171], v[192:195], v[92:95], v[168:171]
  v_add_f32 v237, 1.0, v237
  v_mfma_f32_16x16x32_bf16 v[164:167], v[196:199], v[88:91], v[164:167]
  ds_read_b128 v[192:195], v3 offset:27648
  v_rcp_f32 v236, v236
  v_mul_f32 v235, v183, v235
  v_mfma_f32_16x16x32_bf16 v[172:175], v[196:199], v[92:95], v[172:175]
  v_cvt_pk_bf16_f32 v247, v234, v235
  v_mfma_f32_16x16x32_bf16 v[160:163], v[200:203], v[96:99], v[160:163]
  ds_read_b128 v[196:199], v3 offset:28672
  v_exp_f32 v239, v187
  v_mfma_f32_16x16x32_bf16 v[168:171], v[200:203], v[100:103], v[168:171]
  s_add_u32 s40, s40, 36864
  s_cmp_ge_u32 s40, 147456
  s_cselect_b32 s40, 0, s40
  v_add_f32 v238, 1.0, v238
  v_mfma_f32_16x16x32_bf16 v[164:167], v[204:207], v[96:99], v[164:167]
  ds_read_b128 v[200:203], v3 offset:29696
  v_rcp_f32 v237, v237
  v_mul_f32 v236, v184, v236
  v_mfma_f32_16x16x32_bf16 v[172:175], v[204:207], v[100:103], v[172:175]
  v_exp_f32 v240, v188
  v_mfma_f32_16x16x32_bf16 v[160:163], v[208:211], v[104:107], v[160:163]
  ds_read_b128 v[204:207], v3 offset:30720
  v_add_f32 v239, 1.0, v239
  v_mfma_f32_16x16x32_bf16 v[168:171], v[208:211], v[108:111], v[168:171]
  v_rcp_f32 v238, v238
  v_mfma_f32_16x16x32_bf16 v[164:167], v[212:215], v[104:107], v[164:167]
  ds_read_b128 v[208:211], v3 offset:31744
  v_mul_f32 v237, v185, v237
  v_cvt_pk_bf16_f32 v248, v236, v237
  v_mfma_f32_16x16x32_bf16 v[172:175], v[212:215], v[108:111], v[172:175]
  v_exp_f32 v241, v189
  s_waitcnt lgkmcnt(2)
  v_mfma_f32_16x16x32_bf16 v[160:163], v[216:219], v[112:115], v[160:163]
  ds_read_b128 v[212:215], v3 offset:32768
  v_add_f32 v240, 1.0, v240
  v_mfma_f32_16x16x32_bf16 v[168:171], v[216:219], v[116:119], v[168:171]
  v_rcp_f32 v239, v239
  v_mfma_f32_16x16x32_bf16 v[164:167], v[220:223], v[112:115], v[164:167]
  ds_read_b128 v[216:219], v3 offset:33792
  v_mul_f32 v238, v186, v238
  v_mfma_f32_16x16x32_bf16 v[172:175], v[220:223], v[116:119], v[172:175]
  v_exp_f32 v242, v190
  v_mfma_f32_16x16x32_bf16 v[160:163], v[224:227], v[120:123], v[160:163]
  ds_read_b128 v[220:223], v3 offset:34816
  v_add_f32 v241, 1.0, v241
  v_mfma_f32_16x16x32_bf16 v[168:171], v[224:227], v[124:127], v[168:171]
  v_rcp_f32 v240, v240
  v_mul_f32 v239, v187, v239
  v_mfma_f32_16x16x32_bf16 v[164:167], v[192:195], v[120:123], v[164:167]
  ds_read_b128 v[224:227], v3 offset:35840
  v_cvt_pk_bf16_f32 v249, v238, v239
  v_mfma_f32_16x16x32_bf16 v[172:175], v[192:195], v[124:127], v[172:175]
  v_exp_f32 v243, v191
  s_barrier
  v_add_u32 v3, s40, v2
  v_mfma_f32_16x16x32_bf16 v[160:163], v[196:199], v[128:131], v[160:163]
  ds_read_b128 v[192:195], v3 offset:0
  v_add_f32 v242, 1.0, v242
  v_mfma_f32_16x16x32_bf16 v[168:171], v[196:199], v[132:135], v[168:171]
  v_rcp_f32 v241, v241
  v_mul_f32 v240, v188, v240
  v_mfma_f32_16x16x32_bf16 v[164:167], v[200:203], v[128:131], v[164:167]
  ds_read_b128 v[196:199], v3 offset:1024
  v_add_f32 v243, 1.0, v243
  v_mfma_f32_16x16x32_bf16 v[172:175], v[200:203], v[132:135], v[172:175]
  v_rcp_f32 v242, v242
  s_waitcnt lgkmcnt(2)
  v_mfma_f32_16x16x32_bf16 v[160:163], v[204:207], v[136:139], v[160:163]
  ds_read_b128 v[200:203], v3 offset:2048
  v_mul_f32 v241, v189, v241
  v_cvt_pk_bf16_f32 v250, v240, v241
  v_mfma_f32_16x16x32_bf16 v[168:171], v[204:207], v[140:143], v[168:171]
  v_rcp_f32 v243, v243
  v_mfma_f32_16x16x32_bf16 v[164:167], v[208:211], v[136:139], v[164:167]
  ds_read_b128 v[204:207], v3 offset:3072
  v_mul_f32 v242, v190, v242
  v_mfma_f32_16x16x32_bf16 v[172:175], v[208:211], v[140:143], v[172:175]
  v_mul_f32 v243, v191, v243
  v_cvt_pk_bf16_f32 v251, v242, v243
  v_mfma_f32_16x16x32_bf16 v[160:163], v[212:215], v[144:147], v[160:163]
  ds_read_b128 v[208:211], v3 offset:4096
  v_mfma_f32_16x16x32_bf16 v[168:171], v[212:215], v[148:151], v[168:171]
  v_mfma_f32_16x16x32_bf16 v[164:167], v[216:219], v[144:147], v[164:167]
  ds_read_b128 v[212:215], v3 offset:5120
  v_mfma_f32_16x16x32_bf16 v[172:175], v[216:219], v[148:151], v[172:175]
  buffer_store_dwordx4 v[244:247], v9, s[8:11], s38 offen sc1
  v_mfma_f32_16x16x32_bf16 v[160:163], v[220:223], v[152:155], v[160:163]
  ds_read_b128 v[216:219], v3 offset:6144
  v_mfma_f32_16x16x32_bf16 v[168:171], v[220:223], v[156:159], v[168:171]
  v_mfma_f32_16x16x32_bf16 v[164:167], v[224:227], v[152:155], v[164:167]
  ds_read_b128 v[220:223], v3 offset:7168
  v_mfma_f32_16x16x32_bf16 v[172:175], v[224:227], v[156:159], v[172:175]
  buffer_store_dwordx4 v[248:251], v9, s[8:11], s38 offen offset:256 sc1
  s_add_u32 s38, s38, 2048
  s_sub_u32 s41, s41, 1
  s_cmp_lg_u32 s41, 0
  s_cbranch_scc1 LP_chain1_k_87
  v_exp_f32 v228, v160
  v_exp_f32 v229, v161
  v_add_f32 v228, 1.0, v228
  v_exp_f32 v230, v162
  v_add_f32 v229, 1.0, v229
  v_rcp_f32 v228, v228
  v_exp_f32 v231, v163
  v_add_f32 v230, 1.0, v230
  v_rcp_f32 v229, v229
  v_mul_f32 v228, v160, v228
  v_exp_f32 v232, v164
  v_add_f32 v231, 1.0, v231
  v_rcp_f32 v230, v230
  v_mul_f32 v229, v161, v229
  v_cvt_pk_bf16_f32 v244, v228, v229
  v_exp_f32 v233, v165
  v_add_f32 v232, 1.0, v232
  v_rcp_f32 v231, v231
  v_mul_f32 v230, v162, v230
  v_exp_f32 v234, v166
  v_add_f32 v233, 1.0, v233
  v_rcp_f32 v232, v232
  v_mul_f32 v231, v163, v231
  v_cvt_pk_bf16_f32 v245, v230, v231
  v_exp_f32 v235, v167
  v_add_f32 v234, 1.0, v234
  v_rcp_f32 v233, v233
  v_mul_f32 v232, v164, v232
  v_exp_f32 v236, v168
  v_add_f32 v235, 1.0, v235
  v_rcp_f32 v234, v234
  v_mul_f32 v233, v165, v233
  v_cvt_pk_bf16_f32 v246, v232, v233
  v_exp_f32 v237, v169
  v_add_f32 v236, 1.0, v236
  v_rcp_f32 v235, v235
  v_mul_f32 v234, v166, v234
  v_exp_f32 v238, v170
  v_add_f32 v237, 1.0, v237
  v_rcp_f32 v236, v236
  v_mul_f32 v235, v167, v235
  v_cvt_pk_bf16_f32 v247, v234, v235
  v_exp_f32 v239, v171
  v_add_f32 v238, 1.0, v238
  v_rcp_f32 v237, v237
  v_mul_f32 v236, v168, v236
  v_exp_f32 v240, v172
  v_add_f32 v239, 1.0, v239
  v_rcp_f32 v238, v238
  v_mul_f32 v237, v169, v237
  v_cvt_pk_bf16_f32 v248, v236, v237
  v_exp_f32 v241, v173
  v_add_f32 v240, 1.0, v240
  v_rcp_f32 v239, v239
  v_mul_f32 v238, v170, v238
  v_exp_f32 v242, v174
  v_add_f32 v241, 1.0, v241
  v_rcp_f32 v240, v240
  v_mul_f32 v239, v171, v239
  v_cvt_pk_bf16_f32 v249, v238, v239
  v_exp_f32 v243, v175
  v_add_f32 v242, 1.0, v242
  v_rcp_f32 v241, v241
  v_mul_f32 v240, v172, v240
  v_add_f32 v243, 1.0, v243
  v_rcp_f32 v242, v242
  v_mul_f32 v241, v173, v241
  v_cvt_pk_bf16_f32 v250, v240, v241
  v_rcp_f32 v243, v243
  v_mul_f32 v242, v174, v242
  v_mul_f32 v243, v175, v243
  v_cvt_pk_bf16_f32 v251, v242, v243
  buffer_store_dwordx4 v[244:247], v9, s[8:11], s38 offen sc1
  buffer_store_dwordx4 v[248:251], v9, s[8:11], s38 offen offset:256 sc1
  s_add_u32 s38, s38, 2048
  s_branch EN_chain1_k_89
EL_chain1_k_88:
  s_mul_i32 s30, s24, 331776
  s_mul_i32 s31, s20, 9216
  s_add_u32 s30, s30, s31
  s_add_u32 s30, s30, 2727936
  s_mov_b32 s32, s31
  s_mov_b32 s33, 0
  s_add_u32 s34, s32, 0
  s_mov_b32 m0, s34
  s_add_u32 s35, s30, 0
  buffer_load_dwordx4 v2, s[12:15], s35 offen lds
  buffer_load_dwordx4 v2, s[12:15], s35 offen offset:1024 lds
  buffer_load_dwordx4 v2, s[12:15], s35 offen offset:2048 lds
  s_add_u32 s34, s32, 3072
  s_mov_b32 m0, s34
  s_add_u32 s35, s30, 3072
  buffer_load_dwordx4 v2, s[12:15], s35 offen lds
  buffer_load_dwordx4 v2, s[12:15], s35 offen offset:1024 lds
  buffer_load_dwordx4 v2, s[12:15], s35 offen offset:2048 lds
  s_add_u32 s34, s32, 6144
  s_mov_b32 m0, s34
  s_add_u32 s35, s30, 6144
  buffer_load_dwordx4 v2, s[12:15], s35 offen lds
  buffer_load_dwordx4 v2, s[12:15], s35 offen offset:1024 lds
  buffer_load_dwordx4 v2, s[12:15], s35 offen offset:2048 lds
  s_add_u32 s30, s30, 36864
  s_add_u32 s32, s32, 36864
  s_sub_u32 s34, s32, 147456
  s_cmp_ge_u32 s32, 147456
  s_cselect_b32 s32, s34, s32
  s_add_u32 s33, s33, 1
  s_cmp_ge_u32 s33, 9
  s_cselect_b32 s14, 0, s14
  s_add_u32 s34, s32, 0
  s_mov_b32 m0, s34
  s_add_u32 s35, s30, 0
  buffer_load_dwordx4 v2, s[12:15], s35 offen lds
  buffer_load_dwordx4 v2, s[12:15], s35 offen offset:1024 lds
  buffer_load_dwordx4 v2, s[12:15], s35 offen offset:2048 lds
  s_add_u32 s34, s32, 3072
  s_mov_b32 m0, s34
  s_add_u32 s35, s30, 3072
  buffer_load_dwordx4 v2, s[12:15], s35 offen lds
  buffer_load_dwordx4 v2, s[12:15], s35 offen offset:1024 lds
  buffer_load_dwordx4 v2, s[12:15], s35 offen offset:2048 lds
  s_add_u32 s34, s32, 6144
  s_mov_b32 m0, s34
  s_add_u32 s35, s30, 6144
  buffer_load_dwordx4 v2, s[12:15], s35 offen lds
  buffer_load_dwordx4 v2, s[12:15], s35 offen offset:1024 lds
  buffer_load_dwordx4 v2, s[12:15], s35 offen offset:2048 lds
  s_add_u32 s30, s30, 36864
  s_add_u32 s32, s32, 36864
  s_sub_u32 s34, s32, 147456
  s_cmp_ge_u32 s32, 147456
  s_cselect_b32 s32, s34, s32
  s_add_u32 s33, s33, 1
  s_cmp_ge_u32 s33, 9
  s_cselect_b32 s14, 0, s14
  s_add_u32 s34, s32, 0
  s_mov_b32 m0, s34
  s_add_u32 s35, s30, 0
  buffer_load_dwordx4 v2, s[12:15], s35 offen lds
  buffer_load_dwordx4 v2, s[12:15], s35 offen offset:1024 lds
  buffer_load_dwordx4 v2, s[12:15], s35 offen offset:2048 lds
  s_add_u32 s34, s32, 3072
  s_mov_b32 m0, s34
  s_add_u32 s35, s30, 3072
  buffer_load_dwordx4 v2, s[12:15], s35 offen lds
  buffer_load_dwordx4 v2, s[12:15], s35 offen offset:1024 lds
  buffer_load_dwordx4 v2, s[12:15], s35 offen offset:2048 lds
  s_add_u32 s34, s32, 6144
  s_mov_b32 m0, s34
  s_add_u32 s35, s30, 6144
  buffer_load_dwordx4 v2, s[12:15], s35 offen lds
  buffer_load_dwordx4 v2, s[12:15], s35 offen offset:1024 lds
  buffer_load_dwordx4 v2, s[12:15], s35 offen offset:2048 lds
  s_add_u32 s30, s30, 36864
  s_add_u32 s32, s32, 36864
  s_sub_u32 s34, s32, 147456
  s_cmp_ge_u32 s32, 147456
  s_cselect_b32 s32, s34, s32
  s_add_u32 s33, s33, 1
  s_cmp_ge_u32 s33, 9
  s_cselect_b32 s14, 0, s14
  s_barrier
  s_waitcnt vmcnt(18)
  s_barrier
  s_mov_b32 s41, 9
LP_chain1_k_90:
  s_waitcnt vmcnt(9)
  s_barrier
  s_add_u32 s34, s32, 0
  s_mov_b32 m0, s34
  s_add_u32 s35, s30, 0
  buffer_load_dwordx4 v2, s[12:15], s35 offen lds
  buffer_load_dwordx4 v2, s[12:15], s35 offen offset:1024 lds
  buffer_load_dwordx4 v2, s[12:15], s35 offen offset:2048 lds
  s_add_u32 s34, s32, 3072
  s_mov_b32 m0, s34
  s_add_u32 s35, s30, 3072
  buffer_load_dwordx4 v2, s[12:15], s35 offen lds
  buffer_load_dwordx4 v2, s[12:15], s35 offen offset:1024 lds
  buffer_load_dwordx4 v2, s[12:15], s35 offen offset:2048 lds
  s_add_u32 s34, s32, 6144
  s_mov_b32 m0, s34
  s_add_u32 s35, s30, 6144
  buffer_load_dwordx4 v2, s[12:15], s35 offen lds
  buffer_load_dwordx4 v2, s[12:15], s35 offen offset:1024 lds
  buffer_load_dwordx4 v2, s[12:15], s35 offen offset:2048 lds
  s_add_u32 s30, s30, 36864
  s_add_u32 s32, s32, 36864
  s_sub_u32 s34, s32, 147456
  s_cmp_ge_u32 s32, 147456
  s_cselect_b32 s32, s34, s32
  s_add_u32 s33, s33, 1
  s_cmp_ge_u32 s33, 9
  s_cselect_b32 s14, 0, s14
  s_sub_u32 s41, s41, 1
  s_cmp_lg_u32 s41, 0
  s_cbranch_scc1 LP_chain1_k_90
EN_chain1_k_89:
  s_waitcnt vmcnt(0) lgkmcnt(0)
  s_barrier
  s_cmp_lg_u32 s19, 1
  s_cbranch_scc1 SD_chain1_k_91
  s_cmp_lg_u32 s20, 0
  s_cbranch_scc1 SD_chain1_k_91
  v_mul_u32_u24 v14, 43, v1
  v_lshrrev_b32 v14, 7, v14
  v_mul_u32_u24 v15, 3, v14
  v_sub_u32 v15, v1, v15
  v_lshlrev_b32 v14, 4, v14
  v_add_u32 v14, s23, v14
  v_mul_u32_u24 v13, 205, v14
  v_lshrrev_b32 v13, 11, v13
  v_mul_u32_u24 v12, 10, v13
  v_sub_u32 v12, v14, v12
  v_mul_u32_u24 v12, 3, v12
  v_add_u32 v12, v12, v15
  v_lshl_add_u32 v14, v12, 3, v13
  v_lshlrev_b32 v14, 8, v14
  s_mul_i32 s46, s18, 48267264
  s_add_u32 s46, s46, 61550592
  v_mov_b32 v15, 1
  s_mov_b64 exec, 32767
  buffer_atomic_add v15, v14, s[8:11], s46 offen sc1
  s_mov_b64 exec, -1
SD_chain1_k_91:
  s_waitcnt vmcnt(0) lgkmcnt(0)
  s_nop 15
PHS_f2:
  s_getpc_b64 s[84:85]
PHP_f2:
  s_mov_b32 s88, s84
  s_and_b32 s89, s85, 0xffff
  s_mov_b32 s90, PHS_red-PHP_f2
  s_mov_b32 s91, 0x20000
  v_lshlrev_b32 v251, 4, v0
  buffer_load_dwordx4 v[252:255], v251, s[88:91], 0 offen
  s_cmp_ge_u32 s2, 240
  s_cbranch_scc1 F2E_chain1_k_92
  v_lshrrev_b32 v1, 6, v0
  s_nop 0
  v_readfirstlane_b32 s20, v1
  v_and_b32 v1, 63, v0
  v_lshlrev_b32 v2, 4, v1
  s_nop 1
  s_lshr_b32 s19, s20, 2
  s_and_b32 s20, s20, 3
  s_and_b32 s21, s2, 7
  s_lshr_b32 s22, s2, 3
  s_mul_i32 s23, s22, 21846
  s_lshr_b32 s23, s23, 16
  s_mul_i32 s24, s23, 3
  s_sub_u32 s24, s22, s24
  s_mul_i32 s21, s21, 10
  s_add_u32 s23, s23, s21
  s_lshr_b32 s26, s23, 4
  s_and_b32 s23, s23, 15
  s_lshl_b32 s25, s23, 2
  s_add_u32 s25, s25, s20
  s_mul_i32 s27, s26, 58
  s_cmp_eq_u32 s26, 4
  s_cselect_b32 s28, 28, 29
  s_mov_b32 s12, s4
  s_and_b32 s13, s5, 65535
  s_mov_b32 s14, 0x10000000
  s_mov_b32 s15, 0x20000
  s_mul_i32 s30, s24, 1769472
  s_mul_i32 s31, s27, 6144
  s_add_u32 s30, s30, s31
  s_add_u32 s30, s30, 8036352
  s_mul_i32 s32, s25, 288
  s_add_u32 s32, s32, s27
  s_lshl_b32 s32, s32, 10
  s_add_u32 s32, s32, 28454912
  s_cmp_lg_u32 s19, 0
  s_cbranch_scc1 PD_chain1_k_94
  s_cmp_lg_u32 s20, 0
  s_cbranch_scc1 PD_chain1_k_94
  s_mul_i32 s46, s18, 48267264
  s_add_u32 s46, s46, 61550592
  s_lshl_b32 s47, s2, 8
  s_add_u32 s46, s46, s47
  s_mov_b32 s47, 300000
  v_mov_b32 v14, 0
PW_chain1_k_93:
  buffer_load_dword v252, v14, s[8:11], s46 offen sc1
  s_waitcnt vmcnt(0)
  v_readfirstlane_b32 s48, v252
  s_nop 3
  s_cmp_ge_u32 s48, 16
  s_cbranch_scc1 PW_chain1_k_93_x
  s_sub_u32 s47, s47, 1
  s_cmp_lg_u32 s47, 0
  s_cbranch_scc1 PW_chain1_k_93
PW_chain1_k_93_x:
PD_chain1_k_94:
  s_cmp_eq_u32 s19, 0
  s_cbranch_scc0 EL_chain1_k_95
  s_barrier
  s_setprio 1
  v_lshrrev_b32 v11, 4, v1
  v_lshlrev_b32 v11, 9, v11
  v_and_b32 v10, 15, v1
  v_lshl_add_u32 v11, v10, 4, v11
  s_mul_i32 s43, s26, 2359296
  s_lshl_b32 s44, s23, 2
  s_lshr_b32 s46, s20, 1
  s_lshl_b32 s46, s46, 1
  s_add_u32 s44, s44, s46
  s_mul_i32 s44, s44, 36864
  s_add_u32 s43, s43, s44
  s_mul_i32 s44, s24, 6
  s_and_b32 s46, s20, 1
  s_mul_i32 s46, s46, 3
  s_add_u32 s44, s44, s46
  s_lshl_b32 s44, s44, 11
  s_add_u32 s43, s43, s44
  s_add_u32 s43, s43, 47329280
  s_and_b32 s35, s20, 1
  s_mul_i32 s35, s35, 6144
  s_lshr_b32 s37, s20, 1
  s_lshl_b32 s37, s37, 12
  s_add_u32 s37, s37, 12288
  s_mov_b32 s40, 0
  v_mov_b32 v16, 0
  v_mov_b32 v17, 0
  v_mov_b32 v18, 0
  v_mov_b32 v19, 0
  v_mov_b32 v20, 0
  v_mov_b32 v21, 0
  v_mov_b32 v22, 0
  v_mov_b32 v23, 0
  v_mov_b32 v24, 0
  v_mov_b32 v25, 0
  v_mov_b32 v26, 0
  v_mov_b32 v27, 0
  v_mov_b32 v28, 0
  v_mov_b32 v29, 0
  v_mov_b32 v30, 0
  v_mov_b32 v31, 0
  v_mov_b32 v32, 0
  v_mov_b32 v33, 0
  v_mov_b32 v34, 0
  v_mov_b32 v35, 0
  v_mov_b32 v36, 0
  v_mov_b32 v37, 0
  v_mov_b32 v38, 0
  v_mov_b32 v39, 0
  v_mov_b32 v40, 0
  v_mov_b32 v41, 0
  v_mov_b32 v42, 0
  v_mov_b32 v43, 0
  v_mov_b32 v44, 0
  v_mov_b32 v45, 0
  v_mov_b32 v46, 0
  v_mov_b32 v47, 0
  v_mov_b32 v48, 0
  v_mov_b32 v49, 0
  v_mov_b32 v50, 0
  v_mov_b32 v51, 0
  v_mov_b32 v52, 0
  v_mov_b32 v53, 0
  v_mov_b32 v54, 0
  v_mov_b32 v55, 0
  v_mov_b32 v56, 0
  v_mov_b32 v57, 0
  v_mov_b32 v58, 0
  v_mov_b32 v59, 0
  v_mov_b32 v60, 0
  v_mov_b32 v61, 0
  v_mov_b32 v62, 0
  v_mov_b32 v63, 0
  v_mov_b32 v64, 0
  v_mov_b32 v65, 0
  v_mov_b32 v66, 0
  v_mov_b32 v67, 0
  v_mov_b32 v68, 0
  v_mov_b32 v69, 0
  v_mov_b32 v70, 0
  v_mov_b32 v71, 0
  v_mov_b32 v72, 0
  v_mov_b32 v73, 0
  v_mov_b32 v74, 0
  v_mov_b32 v75, 0
  v_mov_b32 v76, 0
  v_mov_b32 v77, 0
  v_mov_b32 v78, 0
  v_mov_b32 v79, 0
  v_mov_b32 v80, 0
  v_mov_b32 v81, 0
  v_mov_b32 v82, 0
  v_mov_b32 v83, 0
  v_mov_b32 v84, 0
  v_mov_b32 v85, 0
  v_mov_b32 v86, 0
  v_mov_b32 v87, 0
  v_mov_b32 v88, 0
  v_mov_b32 v89, 0
  v_mov_b32 v90, 0
  v_mov_b32 v91, 0
  v_mov_b32 v92, 0
  v_mov_b32 v93, 0
  v_mov_b32 v94, 0
  v_mov_b32 v95, 0
  v_mov_b32 v96, 0
  v_mov_b32 v97, 0
  v_mov_b32 v98, 0
  v_mov_b32 v99, 0
  v_mov_b32 v100, 0
  v_mov_b32 v101, 0
  v_mov_b32 v102, 0
  v_mov_b32 v103, 0
  v_mov_b32 v104, 0
  v_mov_b32 v105, 0
  v_mov_b32 v106, 0
  v_mov_b32 v107, 0
  v_mov_b32 v108, 0
  v_mov_b32 v109, 0
  v_mov_b32 v110, 0
  v_mov_b32 v111, 0
  s_add_u32 s42, s40, s35
  v_add_u32 v3, s42, v2
  s_add_u32 s42, s40, s37
  v_add_u32 v4, s42, v2
  s_barrier
  ds_read_b128 v[112:115], v3 offset:0
  ds_read_b128 v[136:139], v4 offset:0
  ds_read_b128 v[140:143], v4 offset:1024
  ds_read_b128 v[144:147], v4 offset:2048
  ds_read_b128 v[148:151], v4 offset:3072
  ds_read_b128 v[116:119], v3 offset:1024
  ds_read_b128 v[120:123], v3 offset:2048
  ds_read_b128 v[124:127], v3 offset:3072
  ds_read_b128 v[128:131], v3 offset:4096
  ds_read_b128 v[132:135], v3 offset:5120
  s_mov_b32 s41, 13
LC_chain1_k_97:
  s_waitcnt lgkmcnt(2)
  v_mfma_f32_16x16x32_bf16 v[16:19], v[112:115], v[136:139], v[16:19]
  s_add_u32 s40, s40, 20480
  s_cmp_ge_u32 s40, 143360
  s_cselect_b32 s40, 0, s40
  v_mfma_f32_16x16x32_bf16 v[40:43], v[112:115], v[140:143], v[40:43]
  s_barrier
  s_add_u32 s42, s40, s35
  v_add_u32 v3, s42, v2
  s_add_u32 s42, s40, s37
  v_add_u32 v4, s42, v2
  v_mfma_f32_16x16x32_bf16 v[64:67], v[112:115], v[144:147], v[64:67]
  ds_read_b128 v[152:155], v3 offset:0
  v_mfma_f32_16x16x32_bf16 v[88:91], v[112:115], v[148:151], v[88:91]
  v_mfma_f32_16x16x32_bf16 v[20:23], v[116:119], v[136:139], v[20:23]
  ds_read_b128 v[176:179], v4 offset:0
  v_mfma_f32_16x16x32_bf16 v[44:47], v[116:119], v[140:143], v[44:47]
  v_mfma_f32_16x16x32_bf16 v[68:71], v[116:119], v[144:147], v[68:71]
  ds_read_b128 v[180:183], v4 offset:1024
  v_mfma_f32_16x16x32_bf16 v[92:95], v[116:119], v[148:151], v[92:95]
  v_mfma_f32_16x16x32_bf16 v[24:27], v[120:123], v[136:139], v[24:27]
  ds_read_b128 v[184:187], v4 offset:2048
  v_mfma_f32_16x16x32_bf16 v[48:51], v[120:123], v[140:143], v[48:51]
  v_mfma_f32_16x16x32_bf16 v[72:75], v[120:123], v[144:147], v[72:75]
  ds_read_b128 v[188:191], v4 offset:3072
  v_mfma_f32_16x16x32_bf16 v[96:99], v[120:123], v[148:151], v[96:99]
  v_mfma_f32_16x16x32_bf16 v[28:31], v[124:127], v[136:139], v[28:31]
  ds_read_b128 v[156:159], v3 offset:1024
  v_mfma_f32_16x16x32_bf16 v[52:55], v[124:127], v[140:143], v[52:55]
  v_mfma_f32_16x16x32_bf16 v[76:79], v[124:127], v[144:147], v[76:79]
  ds_read_b128 v[160:163], v3 offset:2048
  v_mfma_f32_16x16x32_bf16 v[100:103], v[124:127], v[148:151], v[100:103]
  s_waitcnt lgkmcnt(8)
  v_mfma_f32_16x16x32_bf16 v[32:35], v[128:131], v[136:139], v[32:35]
  ds_read_b128 v[164:167], v3 offset:3072
  v_mfma_f32_16x16x32_bf16 v[56:59], v[128:131], v[140:143], v[56:59]
  v_mfma_f32_16x16x32_bf16 v[80:83], v[128:131], v[144:147], v[80:83]
  ds_read_b128 v[168:171], v3 offset:4096
  v_mfma_f32_16x16x32_bf16 v[104:107], v[128:131], v[148:151], v[104:107]
  s_waitcnt lgkmcnt(9)
  v_mfma_f32_16x16x32_bf16 v[36:39], v[132:135], v[136:139], v[36:39]
  ds_read_b128 v[172:175], v3 offset:5120
  v_mfma_f32_16x16x32_bf16 v[60:63], v[132:135], v[140:143], v[60:63]
  v_mfma_f32_16x16x32_bf16 v[84:87], v[132:135], v[144:147], v[84:87]
  v_mfma_f32_16x16x32_bf16 v[108:111], v[132:135], v[148:151], v[108:111]
  s_waitcnt lgkmcnt(2)
  v_mfma_f32_16x16x32_bf16 v[16:19], v[152:155], v[176:179], v[16:19]
  s_add_u32 s40, s40, 20480
  s_cmp_ge_u32 s40, 143360
  s_cselect_b32 s40, 0, s40
  v_mfma_f32_16x16x32_bf16 v[40:43], v[152:155], v[180:183], v[40:43]
  s_barrier
  s_add_u32 s42, s40, s35
  v_add_u32 v3, s42, v2
  s_add_u32 s42, s40, s37
  v_add_u32 v4, s42, v2
  v_mfma_f32_16x16x32_bf16 v[64:67], v[152:155], v[184:187], v[64:67]
  ds_read_b128 v[112:115], v3 offset:0
  v_mfma_f32_16x16x32_bf16 v[88:91], v[152:155], v[188:191], v[88:91]
  v_mfma_f32_16x16x32_bf16 v[20:23], v[156:159], v[176:179], v[20:23]
  ds_read_b128 v[136:139], v4 offset:0
  v_mfma_f32_16x16x32_bf16 v[44:47], v[156:159], v[180:183], v[44:47]
  v_mfma_f32_16x16x32_bf16 v[68:71], v[156:159], v[184:187], v[68:71]
  ds_read_b128 v[140:143], v4 offset:1024
  v_mfma_f32_16x16x32_bf16 v[92:95], v[156:159], v[188:191], v[92:95]
  v_mfma_f32_16x16x32_bf16 v[24:27], v[160:163], v[176:179], v[24:27]
  ds_read_b128 v[144:147], v4 offset:2048
  v_mfma_f32_16x16x32_bf16 v[48:51], v[160:163], v[180:183], v[48:51]
  v_mfma_f32_16x16x32_bf16 v[72:75], v[160:163], v[184:187], v[72:75]
  ds_read_b128 v[148:151], v4 offset:3072
  v_mfma_f32_16x16x32_bf16 v[96:99], v[160:163], v[188:191], v[96:99]
  v_mfma_f32_16x16x32_bf16 v[28:31], v[164:167], v[176:179], v[28:31]
  ds_read_b128 v[116:119], v3 offset:1024
  v_mfma_f32_16x16x32_bf16 v[52:55], v[164:167], v[180:183], v[52:55]
  v_mfma_f32_16x16x32_bf16 v[76:79], v[164:167], v[184:187], v[76:79]
  ds_read_b128 v[120:123], v3 offset:2048
  v_mfma_f32_16x16x32_bf16 v[100:103], v[164:167], v[188:191], v[100:103]
  s_waitcnt lgkmcnt(8)
  v_mfma_f32_16x16x32_bf16 v[32:35], v[168:171], v[176:179], v[32:35]
  ds_read_b128 v[124:127], v3 offset:3072
  v_mfma_f32_16x16x32_bf16 v[56:59], v[168:171], v[180:183], v[56:59]
  v_mfma_f32_16x16x32_bf16 v[80:83], v[168:171], v[184:187], v[80:83]
  ds_read_b128 v[128:131], v3 offset:4096
  v_mfma_f32_16x16x32_bf16 v[104:107], v[168:171], v[188:191], v[104:107]
  s_waitcnt lgkmcnt(9)
  v_mfma_f32_16x16x32_bf16 v[36:39], v[172:175], v[176:179], v[36:39]
  ds_read_b128 v[132:135], v3 offset:5120
  v_mfma_f32_16x16x32_bf16 v[60:63], v[172:175], v[180:183], v[60:63]
  v_mfma_f32_16x16x32_bf16 v[84:87], v[172:175], v[184:187], v[84:87]
  s_sub_u32 s41, s41, 1
  s_cmp_lg_u32 s41, 0
  v_mfma_f32_16x16x32_bf16 v[108:111], v[172:175], v[188:191], v[108:111]
  s_cbranch_scc1 LC_chain1_k_97
  s_and_b32 s45, s28, 1
  s_barrier
  s_add_u32 s40, s40, 20480
  s_cmp_ge_u32 s40, 143360
  s_cselect_b32 s40, 0, s40
  s_add_u32 s42, s40, s35
  v_add_u32 v3, s42, v2
  s_add_u32 s42, s40, s37
  v_add_u32 v4, s42, v2
  ds_read_b128 v[152:155], v3 offset:0
  ds_read_b128 v[176:179], v4 offset:0
  ds_read_b128 v[180:183], v4 offset:1024
  ds_read_b128 v[184:187], v4 offset:2048
  ds_read_b128 v[188:191], v4 offset:3072
  ds_read_b128 v[156:159], v3 offset:1024
  ds_read_b128 v[160:163], v3 offset:2048
  ds_read_b128 v[164:167], v3 offset:3072
  ds_read_b128 v[168:171], v3 offset:4096
  ds_read_b128 v[172:175], v3 offset:5120
  s_barrier
  s_cmp_eq_u32 s45, 0
  s_cbranch_scc1 SK_chain1_k_98
  s_barrier
  s_add_u32 s40, s40, 20480
  s_cmp_ge_u32 s40, 143360
  s_cselect_b32 s40, 0, s40
  s_add_u32 s42, s40, s35
  v_add_u32 v3, s42, v2
  s_add_u32 s42, s40, s37
  v_add_u32 v4, s42, v2
  ds_read_b128 v[208:211], v4 offset:0
  ds_read_b128 v[212:215], v4 offset:1024
  ds_read_b128 v[216:219], v4 offset:2048
  ds_read_b128 v[220:223], v4 offset:3072
  ds_read_b128 v[224:227], v3 offset:0
  ds_read_b128 v[228:231], v3 offset:1024
  ds_read_b128 v[232:235], v3 offset:2048
  ds_read_b128 v[236:239], v3 offset:3072
  ds_read_b128 v[240:243], v3 offset:4096
  ds_read_b128 v[244:247], v3 offset:5120
SK_chain1_k_98:
  v_mfma_f32_16x16x32_bf16 v[16:19], v[112:115], v[136:139], v[16:19]
  v_mfma_f32_16x16x32_bf16 v[40:43], v[112:115], v[140:143], v[40:43]
  v_mfma_f32_16x16x32_bf16 v[64:67], v[112:115], v[144:147], v[64:67]
  v_mfma_f32_16x16x32_bf16 v[88:91], v[112:115], v[148:151], v[88:91]
  s_waitcnt lgkmcnt(14)
  v_mfma_f32_16x16x32_bf16 v[20:23], v[116:119], v[136:139], v[20:23]
  v_mfma_f32_16x16x32_bf16 v[44:47], v[116:119], v[140:143], v[44:47]
  v_mfma_f32_16x16x32_bf16 v[68:71], v[116:119], v[144:147], v[68:71]
  v_mfma_f32_16x16x32_bf16 v[92:95], v[116:119], v[148:151], v[92:95]
  s_waitcnt lgkmcnt(8)
  v_mfma_f32_16x16x32_bf16 v[16:19], v[152:155], v[176:179], v[16:19]
  s_waitcnt lgkmcnt(7)
  v_mfma_f32_16x16x32_bf16 v[40:43], v[152:155], v[180:183], v[40:43]
  s_waitcnt lgkmcnt(6)
  v_mfma_f32_16x16x32_bf16 v[64:67], v[152:155], v[184:187], v[64:67]
  s_waitcnt lgkmcnt(5)
  v_mfma_f32_16x16x32_bf16 v[88:91], v[152:155], v[188:191], v[88:91]
  s_waitcnt lgkmcnt(4)
  v_mfma_f32_16x16x32_bf16 v[20:23], v[156:159], v[176:179], v[20:23]
  v_mfma_f32_16x16x32_bf16 v[44:47], v[156:159], v[180:183], v[44:47]
  v_mfma_f32_16x16x32_bf16 v[68:71], v[156:159], v[184:187], v[68:71]
  v_mfma_f32_16x16x32_bf16 v[92:95], v[156:159], v[188:191], v[92:95]
  s_cmp_eq_u32 s45, 0
  s_cbranch_scc1 SK_chain1_k_99
  s_waitcnt lgkmcnt(5)
  v_mfma_f32_16x16x32_bf16 v[16:19], v[224:227], v[208:211], v[16:19]
  v_mfma_f32_16x16x32_bf16 v[40:43], v[224:227], v[212:215], v[40:43]
  v_mfma_f32_16x16x32_bf16 v[64:67], v[224:227], v[216:219], v[64:67]
  v_mfma_f32_16x16x32_bf16 v[88:91], v[224:227], v[220:223], v[88:91]
  s_waitcnt lgkmcnt(4)
  v_mfma_f32_16x16x32_bf16 v[20:23], v[228:231], v[208:211], v[20:23]
  v_mfma_f32_16x16x32_bf16 v[44:47], v[228:231], v[212:215], v[44:47]
  v_mfma_f32_16x16x32_bf16 v[68:71], v[228:231], v[216:219], v[68:71]
  v_mfma_f32_16x16x32_bf16 v[92:95], v[228:231], v[220:223], v[92:95]
SK_chain1_k_99:
  v_mfma_f32_16x16x32_bf16 v[24:27], v[120:123], v[136:139], v[24:27]
  v_mfma_f32_16x16x32_bf16 v[48:51], v[120:123], v[140:143], v[48:51]
  v_mfma_f32_16x16x32_bf16 v[72:75], v[120:123], v[144:147], v[72:75]
  v_mfma_f32_16x16x32_bf16 v[96:99], v[120:123], v[148:151], v[96:99]
  v_cvt_pk_bf16_f32 v192, v16, v17
  v_cvt_pk_bf16_f32 v193, v18, v19
  v_cvt_pk_bf16_f32 v194, v20, v21
  v_cvt_pk_bf16_f32 v195, v22, v23
  s_add_u32 s44, s43, 0
  buffer_store_dwordx4 v[192:195], v11, s[8:11], s44 offen sc1
  v_mfma_f32_16x16x32_bf16 v[28:31], v[124:127], v[136:139], v[28:31]
  v_mfma_f32_16x16x32_bf16 v[52:55], v[124:127], v[140:143], v[52:55]
  v_mfma_f32_16x16x32_bf16 v[76:79], v[124:127], v[144:147], v[76:79]
  v_cvt_pk_bf16_f32 v196, v40, v41
  v_cvt_pk_bf16_f32 v197, v42, v43
  v_cvt_pk_bf16_f32 v198, v44, v45
  v_cvt_pk_bf16_f32 v199, v46, v47
  s_add_u32 s44, s43, 256
  buffer_store_dwordx4 v[196:199], v11, s[8:11], s44 offen sc1
  v_mfma_f32_16x16x32_bf16 v[100:103], v[124:127], v[148:151], v[100:103]
  s_waitcnt lgkmcnt(3)
  v_mfma_f32_16x16x32_bf16 v[24:27], v[160:163], v[176:179], v[24:27]
  v_mfma_f32_16x16x32_bf16 v[48:51], v[160:163], v[180:183], v[48:51]
  v_cvt_pk_bf16_f32 v200, v64, v65
  v_cvt_pk_bf16_f32 v201, v66, v67
  v_cvt_pk_bf16_f32 v202, v68, v69
  v_cvt_pk_bf16_f32 v203, v70, v71
  s_add_u32 s44, s43, 36864
  buffer_store_dwordx4 v[200:203], v11, s[8:11], s44 offen sc1
  v_mfma_f32_16x16x32_bf16 v[72:75], v[160:163], v[184:187], v[72:75]
  v_mfma_f32_16x16x32_bf16 v[96:99], v[160:163], v[188:191], v[96:99]
  s_waitcnt lgkmcnt(2)
  v_mfma_f32_16x16x32_bf16 v[28:31], v[164:167], v[176:179], v[28:31]
  v_cvt_pk_bf16_f32 v204, v88, v89
  v_cvt_pk_bf16_f32 v205, v90, v91
  v_cvt_pk_bf16_f32 v206, v92, v93
  v_cvt_pk_bf16_f32 v207, v94, v95
  s_add_u32 s44, s43, 37120
  buffer_store_dwordx4 v[204:207], v11, s[8:11], s44 offen sc1
  v_mfma_f32_16x16x32_bf16 v[52:55], v[164:167], v[180:183], v[52:55]
  v_mfma_f32_16x16x32_bf16 v[76:79], v[164:167], v[184:187], v[76:79]
  v_mfma_f32_16x16x32_bf16 v[100:103], v[164:167], v[188:191], v[100:103]
  s_cmp_eq_u32 s45, 0
  s_cbranch_scc1 SK_chain1_k_100
  s_waitcnt lgkmcnt(3)
  v_mfma_f32_16x16x32_bf16 v[24:27], v[232:235], v[208:211], v[24:27]
  v_mfma_f32_16x16x32_bf16 v[48:51], v[232:235], v[212:215], v[48:51]
  v_mfma_f32_16x16x32_bf16 v[72:75], v[232:235], v[216:219], v[72:75]
  v_mfma_f32_16x16x32_bf16 v[96:99], v[232:235], v[220:223], v[96:99]
  s_waitcnt lgkmcnt(2)
  v_mfma_f32_16x16x32_bf16 v[28:31], v[236:239], v[208:211], v[28:31]
  v_mfma_f32_16x16x32_bf16 v[52:55], v[236:239], v[212:215], v[52:55]
  v_mfma_f32_16x16x32_bf16 v[76:79], v[236:239], v[216:219], v[76:79]
  v_mfma_f32_16x16x32_bf16 v[100:103], v[236:239], v[220:223], v[100:103]
SK_chain1_k_100:
  v_mfma_f32_16x16x32_bf16 v[32:35], v[128:131], v[136:139], v[32:35]
  v_mfma_f32_16x16x32_bf16 v[56:59], v[128:131], v[140:143], v[56:59]
  v_mfma_f32_16x16x32_bf16 v[80:83], v[128:131], v[144:147], v[80:83]
  v_mfma_f32_16x16x32_bf16 v[104:107], v[128:131], v[148:151], v[104:107]
  v_cvt_pk_bf16_f32 v192, v24, v25
  v_cvt_pk_bf16_f32 v193, v26, v27
  v_cvt_pk_bf16_f32 v194, v28, v29
  v_cvt_pk_bf16_f32 v195, v30, v31
  s_add_u32 s44, s43, 2048
  buffer_store_dwordx4 v[192:195], v11, s[8:11], s44 offen sc1
  v_mfma_f32_16x16x32_bf16 v[36:39], v[132:135], v[136:139], v[36:39]
  v_mfma_f32_16x16x32_bf16 v[60:63], v[132:135], v[140:143], v[60:63]
  v_mfma_f32_16x16x32_bf16 v[84:87], v[132:135], v[144:147], v[84:87]
  v_cvt_pk_bf16_f32 v196, v48, v49
  v_cvt_pk_bf16_f32 v197, v50, v51
  v_cvt_pk_bf16_f32 v198, v52, v53
  v_cvt_pk_bf16_f32 v199, v54, v55
  s_add_u32 s44, s43, 2304
  buffer_store_dwordx4 v[196:199], v11, s[8:11], s44 offen sc1
  v_mfma_f32_16x16x32_bf16 v[108:111], v[132:135], v[148:151], v[108:111]
  s_waitcnt lgkmcnt(1)
  v_mfma_f32_16x16x32_bf16 v[32:35], v[168:171], v[176:179], v[32:35]
  v_mfma_f32_16x16x32_bf16 v[56:59], v[168:171], v[180:183], v[56:59]
  v_cvt_pk_bf16_f32 v200, v72, v73
  v_cvt_pk_bf16_f32 v201, v74, v75
  v_cvt_pk_bf16_f32 v202, v76, v77
  v_cvt_pk_bf16_f32 v203, v78, v79
  s_add_u32 s44, s43, 38912
  buffer_store_dwordx4 v[200:203], v11, s[8:11], s44 offen sc1
  v_mfma_f32_16x16x32_bf16 v[80:83], v[168:171], v[184:187], v[80:83]
  v_mfma_f32_16x16x32_bf16 v[104:107], v[168:171], v[188:191], v[104:107]
  s_waitcnt lgkmcnt(0)
  v_mfma_f32_16x16x32_bf16 v[36:39], v[172:175], v[176:179], v[36:39]
  v_cvt_pk_bf16_f32 v204, v96, v97
  v_cvt_pk_bf16_f32 v205, v98, v99
  v_cvt_pk_bf16_f32 v206, v100, v101
  v_cvt_pk_bf16_f32 v207, v102, v103
  s_add_u32 s44, s43, 39168
  buffer_store_dwordx4 v[204:207], v11, s[8:11], s44 offen sc1
  v_mfma_f32_16x16x32_bf16 v[60:63], v[172:175], v[180:183], v[60:63]
  v_mfma_f32_16x16x32_bf16 v[84:87], v[172:175], v[184:187], v[84:87]
  v_mfma_f32_16x16x32_bf16 v[108:111], v[172:175], v[188:191], v[108:111]
  s_cmp_eq_u32 s45, 0
  s_cbranch_scc1 SK_chain1_k_101
  s_waitcnt lgkmcnt(1)
  v_mfma_f32_16x16x32_bf16 v[32:35], v[240:243], v[208:211], v[32:35]
  v_mfma_f32_16x16x32_bf16 v[56:59], v[240:243], v[212:215], v[56:59]
  v_mfma_f32_16x16x32_bf16 v[80:83], v[240:243], v[216:219], v[80:83]
  v_mfma_f32_16x16x32_bf16 v[104:107], v[240:243], v[220:223], v[104:107]
  s_waitcnt lgkmcnt(0)
  v_mfma_f32_16x16x32_bf16 v[36:39], v[244:247], v[208:211], v[36:39]
  v_mfma_f32_16x16x32_bf16 v[60:63], v[244:247], v[212:215], v[60:63]
  v_mfma_f32_16x16x32_bf16 v[84:87], v[244:247], v[216:219], v[84:87]
  v_mfma_f32_16x16x32_bf16 v[108:111], v[244:247], v[220:223], v[108:111]
SK_chain1_k_101:
  s_nop 0
  v_cvt_pk_bf16_f32 v192, v32, v33
  v_cvt_pk_bf16_f32 v193, v34, v35
  s_nop 1
  v_cvt_pk_bf16_f32 v194, v36, v37
  v_cvt_pk_bf16_f32 v195, v38, v39
  s_add_u32 s44, s43, 4096
  buffer_store_dwordx4 v[192:195], v11, s[8:11], s44 offen sc1
  v_cvt_pk_bf16_f32 v196, v56, v57
  v_cvt_pk_bf16_f32 v197, v58, v59
  v_cvt_pk_bf16_f32 v198, v60, v61
  v_cvt_pk_bf16_f32 v199, v62, v63
  s_add_u32 s44, s43, 4352
  buffer_store_dwordx4 v[196:199], v11, s[8:11], s44 offen sc1
  v_cvt_pk_bf16_f32 v200, v80, v81
  v_cvt_pk_bf16_f32 v201, v82, v83
  v_cvt_pk_bf16_f32 v202, v84, v85
  v_cvt_pk_bf16_f32 v203, v86, v87
  s_add_u32 s44, s43, 40960
  buffer_store_dwordx4 v[200:203], v11, s[8:11], s44 offen sc1
  v_cvt_pk_bf16_f32 v204, v104, v105
  v_cvt_pk_bf16_f32 v205, v106, v107
  v_cvt_pk_bf16_f32 v206, v108, v109
  v_cvt_pk_bf16_f32 v207, v110, v111
  s_add_u32 s44, s43, 41216
  buffer_store_dwordx4 v[204:207], v11, s[8:11], s44 offen sc1
  s_branch EN_chain1_k_96
EL_chain1_k_95:
  s_mul_i32 s31, s20, 3072
  s_add_u32 s30, s30, s31
  s_mov_b32 s33, 0
  s_mul_i32 s35, s20, 2048
  s_add_u32 s35, s35, 12288
  s_mov_b32 s36, s28
  v_lshrrev_b32 v11, 4, v1
  v_lshlrev_b32 v11, 9, v11
  v_and_b32 v10, 15, v1
  v_lshl_add_u32 v11, v10, 4, v11
  s_mov_b32 s37, 0
  s_add_u32 s34, s37, s31
  s_mov_b32 m0, s34
  s_nop 0
  buffer_load_dwordx4 v2, s[12:15], s30 offen lds
  buffer_load_dwordx4 v2, s[12:15], s30 offen offset:1024 lds
  buffer_load_dwordx4 v2, s[12:15], s30 offen offset:2048 lds
  s_add_u32 s30, s30, 12288
  s_add_u32 s37, s37, 20480
  s_add_u32 s34, s37, s31
  s_mov_b32 m0, s34
  s_nop 0
  buffer_load_dwordx4 v2, s[12:15], s30 offen lds
  buffer_load_dwordx4 v2, s[12:15], s30 offen offset:1024 lds
  buffer_load_dwordx4 v2, s[12:15], s30 offen offset:2048 lds
  s_add_u32 s30, s30, 12288
  s_add_u32 s37, s37, 20480
  s_add_u32 s34, s37, s31
  s_mov_b32 m0, s34
  s_nop 0
  buffer_load_dwordx4 v2, s[12:15], s30 offen lds
  buffer_load_dwordx4 v2, s[12:15], s30 offen offset:1024 lds
  buffer_load_dwordx4 v2, s[12:15], s30 offen offset:2048 lds
  s_add_u32 s30, s30, 12288
  s_add_u32 s37, s37, 20480
  s_add_u32 s34, s37, s31
  s_mov_b32 m0, s34
  s_nop 0
  buffer_load_dwordx4 v2, s[12:15], s30 offen lds
  buffer_load_dwordx4 v2, s[12:15], s30 offen offset:1024 lds
  buffer_load_dwordx4 v2, s[12:15], s30 offen offset:2048 lds
  s_add_u32 s30, s30, 12288
  s_add_u32 s37, s37, 20480
  s_add_u32 s34, s37, s31
  s_mov_b32 m0, s34
  s_nop 0
  buffer_load_dwordx4 v2, s[12:15], s30 offen lds
  buffer_load_dwordx4 v2, s[12:15], s30 offen offset:1024 lds
  buffer_load_dwordx4 v2, s[12:15], s30 offen offset:2048 lds
  s_add_u32 s30, s30, 12288
  s_add_u32 s37, s37, 20480
  s_add_u32 s34, s37, s31
  s_mov_b32 m0, s34
  s_nop 0
  buffer_load_dwordx4 v2, s[12:15], s30 offen lds
  buffer_load_dwordx4 v2, s[12:15], s30 offen offset:1024 lds
  buffer_load_dwordx4 v2, s[12:15], s30 offen offset:2048 lds
  s_add_u32 s30, s30, 12288
  s_add_u32 s37, s37, 20480
  s_barrier
  s_add_u32 s34, s33, s35
  s_mov_b32 m0, s34
  s_nop 0
  buffer_load_dwordx4 v11, s[12:15], s32 offen sc1 lds
  s_add_u32 s34, s34, 1024
  s_mov_b32 m0, s34
  s_add_u32 s38, s32, 256
  buffer_load_dwordx4 v11, s[12:15], s38 offen sc1 lds
  s_add_u32 s32, s32, 2048
  s_add_u32 s33, s33, 20480
  s_cmp_ge_u32 s33, 143360
  s_cselect_b32 s33, 0, s33
  s_sub_u32 s36, s36, 1
  s_cmp_eq_u32 s36, 0
  s_cselect_b32 s14, 0, s14
  s_add_u32 s34, s33, s35
  s_mov_b32 m0, s34
  s_nop 0
  buffer_load_dwordx4 v11, s[12:15], s32 offen sc1 lds
  s_add_u32 s34, s34, 1024
  s_mov_b32 m0, s34
  s_add_u32 s38, s32, 256
  buffer_load_dwordx4 v11, s[12:15], s38 offen sc1 lds
  s_add_u32 s32, s32, 2048
  s_add_u32 s33, s33, 20480
  s_cmp_ge_u32 s33, 143360
  s_cselect_b32 s33, 0, s33
  s_sub_u32 s36, s36, 1
  s_cmp_eq_u32 s36, 0
  s_cselect_b32 s14, 0, s14
  s_add_u32 s34, s33, s35
  s_mov_b32 m0, s34
  s_nop 0
  buffer_load_dwordx4 v11, s[12:15], s32 offen sc1 lds
  s_add_u32 s34, s34, 1024
  s_mov_b32 m0, s34
  s_add_u32 s38, s32, 256
  buffer_load_dwordx4 v11, s[12:15], s38 offen sc1 lds
  s_add_u32 s32, s32, 2048
  s_add_u32 s33, s33, 20480
  s_cmp_ge_u32 s33, 143360
  s_cselect_b32 s33, 0, s33
  s_sub_u32 s36, s36, 1
  s_cmp_eq_u32 s36, 0
  s_cselect_b32 s14, 0, s14
  s_add_u32 s34, s33, s35
  s_mov_b32 m0, s34
  s_nop 0
  buffer_load_dwordx4 v11, s[12:15], s32 offen sc1 lds
  s_add_u32 s34, s34, 1024
  s_mov_b32 m0, s34
  s_add_u32 s38, s32, 256
  buffer_load_dwordx4 v11, s[12:15], s38 offen sc1 lds
  s_add_u32 s32, s32, 2048
  s_add_u32 s33, s33, 20480
  s_cmp_ge_u32 s33, 143360
  s_cselect_b32 s33, 0, s33
  s_sub_u32 s36, s36, 1
  s_cmp_eq_u32 s36, 0
  s_cselect_b32 s14, 0, s14
  s_add_u32 s34, s33, s35
  s_mov_b32 m0, s34
  s_nop 0
  buffer_load_dwordx4 v11, s[12:15], s32 offen sc1 lds
  s_add_u32 s34, s34, 1024
  s_mov_b32 m0, s34
  s_add_u32 s38, s32, 256
  buffer_load_dwordx4 v11, s[12:15], s38 offen sc1 lds
  s_add_u32 s32, s32, 2048
  s_add_u32 s33, s33, 20480
  s_cmp_ge_u32 s33, 143360
  s_cselect_b32 s33, 0, s33
  s_sub_u32 s36, s36, 1
  s_cmp_eq_u32 s36, 0
  s_cselect_b32 s14, 0, s14
  s_add_u32 s34, s33, s35
  s_mov_b32 m0, s34
  s_nop 0
  buffer_load_dwordx4 v11, s[12:15], s32 offen sc1 lds
  s_add_u32 s34, s34, 1024
  s_mov_b32 m0, s34
  s_add_u32 s38, s32, 256
  buffer_load_dwordx4 v11, s[12:15], s38 offen sc1 lds
  s_add_u32 s32, s32, 2048
  s_add_u32 s33, s33, 20480
  s_cmp_ge_u32 s33, 143360
  s_cselect_b32 s33, 0, s33
  s_sub_u32 s36, s36, 1
  s_cmp_eq_u32 s36, 0
  s_cselect_b32 s14, 0, s14
  s_waitcnt vmcnt(10)
  s_barrier
  s_waitcnt vmcnt(8)
  s_barrier
  s_add_u32 s34, s33, s31
  s_mov_b32 m0, s34
  s_nop 0
  buffer_load_dwordx4 v2, s[12:15], s30 offen lds
  buffer_load_dwordx4 v2, s[12:15], s30 offen offset:1024 lds
  buffer_load_dwordx4 v2, s[12:15], s30 offen offset:2048 lds
  s_add_u32 s30, s30, 12288
  s_add_u32 s34, s33, s35
  s_mov_b32 m0, s34
  s_nop 0
  buffer_load_dwordx4 v11, s[12:15], s32 offen sc1 lds
  s_add_u32 s34, s34, 1024
  s_mov_b32 m0, s34
  s_add_u32 s38, s32, 256
  buffer_load_dwordx4 v11, s[12:15], s38 offen sc1 lds
  s_add_u32 s32, s32, 2048
  s_add_u32 s33, s33, 20480
  s_cmp_ge_u32 s33, 143360
  s_cselect_b32 s33, 0, s33
  s_sub_u32 s36, s36, 1
  s_cmp_eq_u32 s36, 0
  s_cselect_b32 s14, 0, s14
  s_waitcnt vmcnt(11)
  s_barrier
  s_add_u32 s34, s33, s31
  s_mov_b32 m0, s34
  s_nop 0
  buffer_load_dwordx4 v2, s[12:15], s30 offen lds
  buffer_load_dwordx4 v2, s[12:15], s30 offen offset:1024 lds
  buffer_load_dwordx4 v2, s[12:15], s30 offen offset:2048 lds
  s_add_u32 s30, s30, 12288
  s_add_u32 s34, s33, s35
  s_mov_b32 m0, s34
  s_nop 0
  buffer_load_dwordx4 v11, s[12:15], s32 offen sc1 lds
  s_add_u32 s34, s34, 1024
  s_mov_b32 m0, s34
  s_add_u32 s38, s32, 256
  buffer_load_dwordx4 v11, s[12:15], s38 offen sc1 lds
  s_add_u32 s32, s32, 2048
  s_add_u32 s33, s33, 20480
  s_cmp_ge_u32 s33, 143360
  s_cselect_b32 s33, 0, s33
  s_sub_u32 s36, s36, 1
  s_cmp_eq_u32 s36, 0
  s_cselect_b32 s14, 0, s14
  s_waitcnt vmcnt(14)
  s_barrier
  s_add_u32 s34, s33, s31
  s_mov_b32 m0, s34
  s_nop 0
  buffer_load_dwordx4 v2, s[12:15], s30 offen lds
  buffer_load_dwordx4 v2, s[12:15], s30 offen offset:1024 lds
  buffer_load_dwordx4 v2, s[12:15], s30 offen offset:2048 lds
  s_add_u32 s30, s30, 12288
  s_add_u32 s34, s33, s35
  s_mov_b32 m0, s34
  s_nop 0
  buffer_load_dwordx4 v11, s[12:15], s32 offen sc1 lds
  s_add_u32 s34, s34, 1024
  s_mov_b32 m0, s34
  s_add_u32 s38, s32, 256
  buffer_load_dwordx4 v11, s[12:15], s38 offen sc1 lds
  s_add_u32 s32, s32, 2048
  s_add_u32 s33, s33, 20480
  s_cmp_ge_u32 s33, 143360
  s_cselect_b32 s33, 0, s33
  s_sub_u32 s36, s36, 1
  s_cmp_eq_u32 s36, 0
  s_cselect_b32 s14, 0, s14
  s_waitcnt vmcnt(17)
  s_barrier
  s_add_u32 s34, s33, s31
  s_mov_b32 m0, s34
  s_nop 0
  buffer_load_dwordx4 v2, s[12:15], s30 offen lds
  buffer_load_dwordx4 v2, s[12:15], s30 offen offset:1024 lds
  buffer_load_dwordx4 v2, s[12:15], s30 offen offset:2048 lds
  s_add_u32 s30, s30, 12288
  s_add_u32 s34, s33, s35
  s_mov_b32 m0, s34
  s_nop 0
  buffer_load_dwordx4 v11, s[12:15], s32 offen sc1 lds
  s_add_u32 s34, s34, 1024
  s_mov_b32 m0, s34
  s_add_u32 s38, s32, 256
  buffer_load_dwordx4 v11, s[12:15], s38 offen sc1 lds
  s_add_u32 s32, s32, 2048
  s_add_u32 s33, s33, 20480
  s_cmp_ge_u32 s33, 143360
  s_cselect_b32 s33, 0, s33
  s_sub_u32 s36, s36, 1
  s_cmp_eq_u32 s36, 0
  s_cselect_b32 s14, 0, s14
  s_waitcnt vmcnt(20)
  s_barrier
  s_add_u32 s34, s33, s31
  s_mov_b32 m0, s34
  s_nop 0
  buffer_load_dwordx4 v2, s[12:15], s30 offen lds
  buffer_load_dwordx4 v2, s[12:15], s30 offen offset:1024 lds
  buffer_load_dwordx4 v2, s[12:15], s30 offen offset:2048 lds
  s_add_u32 s30, s30, 12288
  s_add_u32 s34, s33, s35
  s_mov_b32 m0, s34
  s_nop 0
  buffer_load_dwordx4 v11, s[12:15], s32 offen sc1 lds
  s_add_u32 s34, s34, 1024
  s_mov_b32 m0, s34
  s_add_u32 s38, s32, 256
  buffer_load_dwordx4 v11, s[12:15], s38 offen sc1 lds
  s_add_u32 s32, s32, 2048
  s_add_u32 s33, s33, 20480
  s_cmp_ge_u32 s33, 143360
  s_cselect_b32 s33, 0, s33
  s_sub_u32 s36, s36, 1
  s_cmp_eq_u32 s36, 0
  s_cselect_b32 s14, 0, s14
  s_sub_u32 s28, s28, 5
  s_sub_u32 s28, s28, 6
LL_chain1_k_102:
  s_waitcnt vmcnt(20)
  s_barrier
  s_add_u32 s34, s33, s31
  s_mov_b32 m0, s34
  s_nop 0
  buffer_load_dwordx4 v2, s[12:15], s30 offen lds
  buffer_load_dwordx4 v2, s[12:15], s30 offen offset:1024 lds
  buffer_load_dwordx4 v2, s[12:15], s30 offen offset:2048 lds
  s_add_u32 s30, s30, 12288
  s_add_u32 s34, s33, s35
  s_mov_b32 m0, s34
  s_nop 0
  buffer_load_dwordx4 v11, s[12:15], s32 offen sc1 lds
  s_add_u32 s34, s34, 1024
  s_mov_b32 m0, s34
  s_add_u32 s38, s32, 256
  buffer_load_dwordx4 v11, s[12:15], s38 offen sc1 lds
  s_add_u32 s32, s32, 2048
  s_add_u32 s33, s33, 20480
  s_cmp_ge_u32 s33, 143360
  s_cselect_b32 s33, 0, s33
  s_sub_u32 s36, s36, 1
  s_cmp_eq_u32 s36, 0
  s_cselect_b32 s14, 0, s14
  s_sub_u32 s28, s28, 1
  s_cmp_lg_u32 s28, 0
  s_cbranch_scc1 LL_chain1_k_102
  s_waitcnt vmcnt(20)
  s_barrier
  s_waitcnt vmcnt(15)
  s_barrier
  s_waitcnt vmcnt(10)
  s_barrier
  s_waitcnt vmcnt(5)
  s_barrier
  s_waitcnt vmcnt(0)
  s_barrier
  s_waitcnt vmcnt(0)
  s_barrier
EN_chain1_k_96:
  s_waitcnt vmcnt(0) lgkmcnt(0)
  s_barrier
  s_cmp_lg_u32 s19, 1
  s_cbranch_scc1 SD_chain1_k_103
  s_cmp_lg_u32 s20, 0
  s_cbranch_scc1 SD_chain1_k_103
  s_lshl_b32 s46, s23, 4
  v_add_u32 v14, s46, v1
  v_lshlrev_b32 v14, 8, v14
  s_mul_i32 s46, s18, 48267264
  s_add_u32 s46, s46, 61616128
  v_mov_b32 v15, 1
  s_mov_b64 exec, 65535
  buffer_atomic_add v15, v14, s[8:11], s46 offen sc1
  s_mov_b64 exec, -1
SD_chain1_k_103:
F2E_chain1_k_92:
  s_waitcnt vmcnt(0) lgkmcnt(0)
  s_nop 15
PHS_red:
  s_getpc_b64 s[84:85]
PHP_red:
  s_mov_b32 s88, s84
  s_and_b32 s89, s85, 0xffff
  s_mov_b32 s90, PHS_qkv-PHP_red
  s_mov_b32 s91, 0x20000
  v_lshlrev_b32 v251, 4, v0
  buffer_load_dwordx4 v[252:255], v251, s[88:91], 0 offen
  v_lshrrev_b32 v1, 6, v0
  s_nop 0
  v_readfirstlane_b32 s20, v1
  v_and_b32 v1, 63, v0
  v_lshlrev_b32 v2, 4, v1
  s_nop 1
  s_lshr_b32 s19, s20, 2
  s_and_b32 s20, s20, 3
  s_mov_b32 s43, s19
  s_mov_b32 s44, s20
  s_cmp_eq_u32 s18, 0
  s_cbranch_scc0 EL_chain1_k_104
  v_readfirstlane_b32 s45, v0
  s_nop 3
  s_cmp_lt_u32 s45, 64
  s_cbranch_scc0 EL_chain1_k_106
  v_and_b32 v1, 7, v0
  v_lshrrev_b32 v2, 3, v0
  s_lshr_b32 s20, s2, 2
  s_and_b32 s21, s2, 3
  s_lshl_b32 s21, s21, 3
  s_mul_i32 s22, s20, 36864
  s_lshl_b32 s23, s21, 4
  s_add_u32 s22, s22, s23
  v_lshlrev_b32 v3, 9, v2
  v_lshl_add_u32 v3, v1, 4, v3
  v_add_u32 v7, 32768, v3
  v_cmp_gt_u32 vcc, 8, v2
  v_mov_b32 v12, 0x7ffffff0
  s_nop 0
  v_cndmask_b32 v7, v12, v7, vcc
  s_mov_b32 s19, s43
  s_mov_b32 s20, s44
  s_cmp_lg_u32 s19, 0
  s_cbranch_scc1 PD_chain1_k_109
  s_cmp_lg_u32 s20, 0
  s_cbranch_scc1 PD_chain1_k_109
  s_mul_i32 s46, s18, 48267264
  s_add_u32 s46, s46, 61616128
  s_lshl_b32 s47, s2, 8
  s_add_u32 s46, s46, s47
  s_mov_b32 s47, 300000
  v_mov_b32 v14, 0
PW_chain1_k_108:
  buffer_load_dword v252, v14, s[8:11], s46 offen sc1
  s_waitcnt vmcnt(0)
  v_readfirstlane_b32 s48, v252
  s_nop 3
  s_cmp_ge_u32 s48, 15
  s_cbranch_scc1 PW_chain1_k_108_x
  s_sub_u32 s47, s47, 1
  s_cmp_lg_u32 s47, 0
  s_cbranch_scc1 PW_chain1_k_108
PW_chain1_k_108_x:
PD_chain1_k_109:
  s_barrier
  s_add_u32 s25, s22, 47329280
  buffer_load_dwordx4 v[24:27], v3, s[8:11], s25 offen sc1
  buffer_load_dwordx4 v[28:31], v7, s[8:11], s25 offen sc1
  s_add_u32 s25, s22, 49688576
  buffer_load_dwordx4 v[32:35], v3, s[8:11], s25 offen sc1
  buffer_load_dwordx4 v[36:39], v7, s[8:11], s25 offen sc1
  s_add_u32 s25, s22, 52047872
  buffer_load_dwordx4 v[40:43], v3, s[8:11], s25 offen sc1
  buffer_load_dwordx4 v[44:47], v7, s[8:11], s25 offen sc1
  s_add_u32 s25, s22, 54407168
  buffer_load_dwordx4 v[48:51], v3, s[8:11], s25 offen sc1
  buffer_load_dwordx4 v[52:55], v7, s[8:11], s25 offen sc1
  s_add_u32 s25, s22, 56766464
  buffer_load_dwordx4 v[56:59], v3, s[8:11], s25 offen sc1
  buffer_load_dwordx4 v[60:63], v7, s[8:11], s25 offen sc1
  s_add_u32 s25, s22, 59125760
  buffer_load_dwordx4 v[16:19], v3, s[8:11], s25 offen sc1
  buffer_load_dwordx4 v[20:23], v7, s[8:11], s25 offen sc1
  s_waitcnt vmcnt(11)
  v_lshlrev_b32 v64, 16, v24
  v_and_b32 v65, 0xffff0000, v24
  v_lshlrev_b32 v66, 16, v25
  v_and_b32 v67, 0xffff0000, v25
  v_lshlrev_b32 v68, 16, v26
  v_and_b32 v69, 0xffff0000, v26
  v_lshlrev_b32 v70, 16, v27
  v_and_b32 v71, 0xffff0000, v27
  s_waitcnt vmcnt(10)
  v_lshlrev_b32 v72, 16, v28
  v_and_b32 v73, 0xffff0000, v28
  v_lshlrev_b32 v74, 16, v29
  v_and_b32 v75, 0xffff0000, v29
  v_lshlrev_b32 v76, 16, v30
  v_and_b32 v77, 0xffff0000, v30
  v_lshlrev_b32 v78, 16, v31
  v_and_b32 v79, 0xffff0000, v31
  s_waitcnt vmcnt(9)
  v_lshlrev_b32 v80, 16, v32
  v_and_b32 v81, 0xffff0000, v32
  v_lshlrev_b32 v82, 16, v33
  v_and_b32 v83, 0xffff0000, v33
  v_lshlrev_b32 v84, 16, v34
  v_and_b32 v85, 0xffff0000, v34
  v_lshlrev_b32 v86, 16, v35
  v_and_b32 v87, 0xffff0000, v35
  s_waitcnt vmcnt(8)
  v_lshlrev_b32 v88, 16, v36
  v_and_b32 v89, 0xffff0000, v36
  v_lshlrev_b32 v90, 16, v37
  v_and_b32 v91, 0xffff0000, v37
  v_lshlrev_b32 v92, 16, v38
  v_and_b32 v93, 0xffff0000, v38
  v_lshlrev_b32 v94, 16, v39
  v_and_b32 v95, 0xffff0000, v39
  v_pk_add_f32 v[64:65], v[64:65], v[80:81]
  v_pk_add_f32 v[66:67], v[66:67], v[82:83]
  v_pk_add_f32 v[68:69], v[68:69], v[84:85]
  v_pk_add_f32 v[70:71], v[70:71], v[86:87]
  v_pk_add_f32 v[72:73], v[72:73], v[88:89]
  v_pk_add_f32 v[74:75], v[74:75], v[90:91]
  v_pk_add_f32 v[76:77], v[76:77], v[92:93]
  v_pk_add_f32 v[78:79], v[78:79], v[94:95]
  s_waitcnt vmcnt(7)
  v_lshlrev_b32 v80, 16, v40
  v_and_b32 v81, 0xffff0000, v40
  v_lshlrev_b32 v82, 16, v41
  v_and_b32 v83, 0xffff0000, v41
  v_lshlrev_b32 v84, 16, v42
  v_and_b32 v85, 0xffff0000, v42
  v_lshlrev_b32 v86, 16, v43
  v_and_b32 v87, 0xffff0000, v43
  s_waitcnt vmcnt(6)
  v_lshlrev_b32 v88, 16, v44
  v_and_b32 v89, 0xffff0000, v44
  v_lshlrev_b32 v90, 16, v45
  v_and_b32 v91, 0xffff0000, v45
  v_lshlrev_b32 v92, 16, v46
  v_and_b32 v93, 0xffff0000, v46
  v_lshlrev_b32 v94, 16, v47
  v_and_b32 v95, 0xffff0000, v47
  v_pk_add_f32 v[64:65], v[64:65], v[80:81]
  v_pk_add_f32 v[66:67], v[66:67], v[82:83]
  v_pk_add_f32 v[68:69], v[68:69], v[84:85]
  v_pk_add_f32 v[70:71], v[70:71], v[86:87]
  v_pk_add_f32 v[72:73], v[72:73], v[88:89]
  v_pk_add_f32 v[74:75], v[74:75], v[90:91]
  v_pk_add_f32 v[76:77], v[76:77], v[92:93]
  v_pk_add_f32 v[78:79], v[78:79], v[94:95]
  s_waitcnt vmcnt(5)
  v_lshlrev_b32 v80, 16, v48
  v_and_b32 v81, 0xffff0000, v48
  v_lshlrev_b32 v82, 16, v49
  v_and_b32 v83, 0xffff0000, v49
  v_lshlrev_b32 v84, 16, v50
  v_and_b32 v85, 0xffff0000, v50
  v_lshlrev_b32 v86, 16, v51
  v_and_b32 v87, 0xffff0000, v51
  s_waitcnt vmcnt(4)
  v_lshlrev_b32 v88, 16, v52
  v_and_b32 v89, 0xffff0000, v52
  v_lshlrev_b32 v90, 16, v53
  v_and_b32 v91, 0xffff0000, v53
  v_lshlrev_b32 v92, 16, v54
  v_and_b32 v93, 0xffff0000, v54
  v_lshlrev_b32 v94, 16, v55
  v_and_b32 v95, 0xffff0000, v55
  v_pk_add_f32 v[64:65], v[64:65], v[80:81]
  v_pk_add_f32 v[66:67], v[66:67], v[82:83]
  v_pk_add_f32 v[68:69], v[68:69], v[84:85]
  v_pk_add_f32 v[70:71], v[70:71], v[86:87]
  v_pk_add_f32 v[72:73], v[72:73], v[88:89]
  v_pk_add_f32 v[74:75], v[74:75], v[90:91]
  v_pk_add_f32 v[76:77], v[76:77], v[92:93]
  v_pk_add_f32 v[78:79], v[78:79], v[94:95]
  s_waitcnt vmcnt(3)
  v_lshlrev_b32 v80, 16, v56
  v_and_b32 v81, 0xffff0000, v56
  v_lshlrev_b32 v82, 16, v57
  v_and_b32 v83, 0xffff0000, v57
  v_lshlrev_b32 v84, 16, v58
  v_and_b32 v85, 0xffff0000, v58
  v_lshlrev_b32 v86, 16, v59
  v_and_b32 v87, 0xffff0000, v59
  s_waitcnt vmcnt(2)
  v_lshlrev_b32 v88, 16, v60
  v_and_b32 v89, 0xffff0000, v60
  v_lshlrev_b32 v90, 16, v61
  v_and_b32 v91, 0xffff0000, v61
  v_lshlrev_b32 v92, 16, v62
  v_and_b32 v93, 0xffff0000, v62
  v_lshlrev_b32 v94, 16, v63
  v_and_b32 v95, 0xffff0000, v63
  v_pk_add_f32 v[64:65], v[64:65], v[80:81]
  v_pk_add_f32 v[66:67], v[66:67], v[82:83]
  v_pk_add_f32 v[68:69], v[68:69], v[84:85]
  v_pk_add_f32 v[70:71], v[70:71], v[86:87]
  v_pk_add_f32 v[72:73], v[72:73], v[88:89]
  v_pk_add_f32 v[74:75], v[74:75], v[90:91]
  v_pk_add_f32 v[76:77], v[76:77], v[92:93]
  v_pk_add_f32 v[78:79], v[78:79], v[94:95]
  s_mov_b32 s26, 0xbf317218
  s_waitcnt vmcnt(1)
  v_lshlrev_b32 v80, 16, v16
  v_and_b32 v81, 0xffff0000, v16
  v_lshlrev_b32 v82, 16, v17
  v_and_b32 v83, 0xffff0000, v17
  v_lshlrev_b32 v84, 16, v18
  v_and_b32 v85, 0xffff0000, v18
  v_lshlrev_b32 v86, 16, v19
  v_and_b32 v87, 0xffff0000, v19
  s_waitcnt vmcnt(0)
  v_lshlrev_b32 v88, 16, v20
  v_and_b32 v89, 0xffff0000, v20
  v_lshlrev_b32 v90, 16, v21
  v_and_b32 v91, 0xffff0000, v21
  v_lshlrev_b32 v92, 16, v22
  v_and_b32 v93, 0xffff0000, v22
  v_lshlrev_b32 v94, 16, v23
  v_and_b32 v95, 0xffff0000, v23
  v_fma_f32 v64, v64, s26, v80
  v_fma_f32 v65, v65, s26, v81
  v_fma_f32 v66, v66, s26, v82
  v_fma_f32 v67, v67, s26, v83
  v_fma_f32 v68, v68, s26, v84
  v_fma_f32 v69, v69, s26, v85
  v_fma_f32 v70, v70, s26, v86
  v_fma_f32 v71, v71, s26, v87
  v_fma_f32 v72, v72, s26, v88
  v_fma_f32 v73, v73, s26, v89
  v_fma_f32 v74, v74, s26, v90
  v_fma_f32 v75, v75, s26, v91
  v_fma_f32 v76, v76, s26, v92
  v_fma_f32 v77, v77, s26, v93
  v_fma_f32 v78, v78, s26, v94
  v_fma_f32 v79, v79, s26, v95
  v_cvt_pk_bf16_f32 v16, v64, v65
  v_cvt_pk_bf16_f32 v17, v66, v67
  v_cvt_pk_bf16_f32 v18, v68, v69
  v_cvt_pk_bf16_f32 v19, v70, v71
  v_cvt_pk_bf16_f32 v20, v72, v73
  v_cvt_pk_bf16_f32 v21, v74, v75
  v_cvt_pk_bf16_f32 v22, v76, v77
  v_cvt_pk_bf16_f32 v23, v78, v79
  v_lshlrev_b32 v64, 16, v16
  v_and_b32 v65, 0xffff0000, v16
  v_lshlrev_b32 v66, 16, v17
  v_and_b32 v67, 0xffff0000, v17
  v_lshlrev_b32 v68, 16, v18
  v_and_b32 v69, 0xffff0000, v18
  v_lshlrev_b32 v70, 16, v19
  v_and_b32 v71, 0xffff0000, v19
  v_lshlrev_b32 v72, 16, v20
  v_and_b32 v73, 0xffff0000, v20
  v_lshlrev_b32 v74, 16, v21
  v_and_b32 v75, 0xffff0000, v21
  v_lshlrev_b32 v76, 16, v22
  v_and_b32 v77, 0xffff0000, v22
  v_lshlrev_b32 v78, 16, v23
  v_and_b32 v79, 0xffff0000, v23
  s_add_u32 s25, s22, 13676544
  buffer_store_dwordx4 v[16:19], v3, s[8:11], s25 offen sc1
  buffer_store_dwordx4 v[20:23], v7, s[8:11], s25 offen sc1
  v_add_f32 v96, v64, v65
  v_mul_f32 v97, v64, v64
  v_fmac_f32 v97, v65, v65
  v_add_f32 v96, v96, v66
  v_fmac_f32 v97, v66, v66
  v_add_f32 v96, v96, v67
  v_fmac_f32 v97, v67, v67
  v_add_f32 v96, v96, v68
  v_fmac_f32 v97, v68, v68
  v_add_f32 v96, v96, v69
  v_fmac_f32 v97, v69, v69
  v_add_f32 v96, v96, v70
  v_fmac_f32 v97, v70, v70
  v_add_f32 v96, v96, v71
  v_fmac_f32 v97, v71, v71
  v_add_f32 v96, v96, v72
  v_fmac_f32 v97, v72, v72
  v_add_f32 v96, v96, v73
  v_fmac_f32 v97, v73, v73
  v_add_f32 v96, v96, v74
  v_fmac_f32 v97, v74, v74
  v_add_f32 v96, v96, v75
  v_fmac_f32 v97, v75, v75
  v_add_f32 v96, v96, v76
  v_fmac_f32 v97, v76, v76
  v_add_f32 v96, v96, v77
  v_fmac_f32 v97, v77, v77
  v_add_f32 v96, v96, v78
  v_fmac_f32 v97, v78, v78
  v_add_f32 v96, v96, v79
  v_fmac_f32 v97, v79, v79
  s_nop 0
  v_add_f32_dpp v96, v96, v96 row_ror:8 row_mask:0xf bank_mask:0xf
  v_add_f32_dpp v97, v97, v97 row_ror:8 row_mask:0xf bank_mask:0xf
  v_mov_b32 v98, v96
  s_nop 1
  v_permlane16_swap_b32 v98, v96
  v_add_f32 v96, v96, v98
  v_mov_b32 v98, v97
  s_nop 1
  v_permlane16_swap_b32 v98, v97
  v_add_f32 v97, v97, v98
  v_mov_b32 v98, v96
  s_nop 1
  v_permlane32_swap_b32 v98, v96
  v_add_f32 v96, v96, v98
  v_mov_b32 v98, v97
  s_nop 1
  v_permlane32_swap_b32 v98, v97
  v_add_f32 v97, v97, v98
  v_lshrrev_b32 v98, 6, v0
  v_lshlrev_b32 v98, 3, v98
  v_mul_u32_u24 v99, 80, v1
  v_add_u32 v98, v98, v99
  ds_write_b64 v98, v[96:97]
  s_waitcnt lgkmcnt(0)
  s_barrier
  ds_read_b64 v[100:101], v99 offset:0
  ds_read_b64 v[102:103], v99 offset:8
  ds_read_b64 v[104:105], v99 offset:16
  ds_read_b64 v[106:107], v99 offset:24
  ds_read_b64 v[108:109], v99 offset:32
  ds_read_b64 v[110:111], v99 offset:40
  ds_read_b64 v[112:113], v99 offset:48
  ds_read_b64 v[114:115], v99 offset:56
  s_waitcnt lgkmcnt(6)
  v_add_f32 v96, v100, v102
  v_add_f32 v97, v101, v103
  s_waitcnt lgkmcnt(5)
  v_add_f32 v96, v96, v104
  v_add_f32 v97, v97, v105
  s_waitcnt lgkmcnt(4)
  v_add_f32 v96, v96, v106
  v_add_f32 v97, v97, v107
  s_waitcnt lgkmcnt(3)
  v_add_f32 v96, v96, v108
  v_add_f32 v97, v97, v109
  s_waitcnt lgkmcnt(2)
  v_add_f32 v96, v96, v110
  v_add_f32 v97, v97, v111
  s_waitcnt lgkmcnt(1)
  v_add_f32 v96, v96, v112
  v_add_f32 v97, v97, v113
  s_waitcnt lgkmcnt(0)
  v_add_f32 v96, v96, v114
  v_add_f32 v97, v97, v115
  v_mul_f32 v96, 0x3ae38e39, v96
  v_mul_f32 v97, 0x3ae38e39, v97
  v_fma_f32 v97, -v96, v96, v97
  v_max_f32 v97, 0, v97
  v_cvt_pk_bf16_f32 v97, v97, v97
  v_and_b32 v97, 0xffff0000, v97
  v_add_f32 v97, 0x3727c5ac, v97
  v_cvt_pk_bf16_f32 v97, v97, v97
  v_and_b32 v97, 0xffff0000, v97
  v_sqrt_f32 v97, v97
  s_nop 0
  v_cvt_pk_bf16_f32 v97, v97, v97
  v_and_b32 v97, 0xffff0000, v97
  v_rcp_f32 v97, v97
  v_cvt_pk_bf16_f32 v96, v96, v96
  v_and_b32 v96, 0xffff0000, v96
  v_sub_f32 v64, v64, v96
  v_sub_f32 v65, v65, v96
  v_sub_f32 v66, v66, v96
  v_sub_f32 v67, v67, v96
  v_sub_f32 v68, v68, v96
  v_sub_f32 v69, v69, v96
  v_sub_f32 v70, v70, v96
  v_sub_f32 v71, v71, v96
  v_sub_f32 v72, v72, v96
  v_sub_f32 v73, v73, v96
  v_sub_f32 v74, v74, v96
  v_sub_f32 v75, v75, v96
  v_sub_f32 v76, v76, v96
  v_sub_f32 v77, v77, v96
  v_sub_f32 v78, v78, v96
  v_sub_f32 v79, v79, v96
  v_cvt_pk_bf16_f32 v16, v64, v65
  v_cvt_pk_bf16_f32 v17, v66, v67
  v_cvt_pk_bf16_f32 v18, v68, v69
  v_cvt_pk_bf16_f32 v19, v70, v71
  v_cvt_pk_bf16_f32 v20, v72, v73
  v_cvt_pk_bf16_f32 v21, v74, v75
  v_cvt_pk_bf16_f32 v22, v76, v77
  v_cvt_pk_bf16_f32 v23, v78, v79
  v_lshlrev_b32 v64, 16, v16
  v_and_b32 v65, 0xffff0000, v16
  v_lshlrev_b32 v66, 16, v17
  v_and_b32 v67, 0xffff0000, v17
  v_lshlrev_b32 v68, 16, v18
  v_and_b32 v69, 0xffff0000, v18
  v_lshlrev_b32 v70, 16, v19
  v_and_b32 v71, 0xffff0000, v19
  v_lshlrev_b32 v72, 16, v20
  v_and_b32 v73, 0xffff0000, v20
  v_lshlrev_b32 v74, 16, v21
  v_and_b32 v75, 0xffff0000, v21
  v_lshlrev_b32 v76, 16, v22
  v_and_b32 v77, 0xffff0000, v22
  v_lshlrev_b32 v78, 16, v23
  v_and_b32 v79, 0xffff0000, v23
  v_mul_f32 v64, v64, v97
  v_mul_f32 v65, v65, v97
  v_mul_f32 v66, v66, v97
  v_mul_f32 v67, v67, v97
  v_mul_f32 v68, v68, v97
  v_mul_f32 v69, v69, v97
  v_mul_f32 v70, v70, v97
  v_mul_f32 v71, v71, v97
  v_mul_f32 v72, v72, v97
  v_mul_f32 v73, v73, v97
  v_mul_f32 v74, v74, v97
  v_mul_f32 v75, v75, v97
  v_mul_f32 v76, v76, v97
  v_mul_f32 v77, v77, v97
  v_mul_f32 v78, v78, v97
  v_mul_f32 v79, v79, v97
  v_cvt_pk_bf16_f32 v16, v64, v65
  v_cvt_pk_bf16_f32 v17, v66, v67
  v_cvt_pk_bf16_f32 v18, v68, v69
  v_cvt_pk_bf16_f32 v19, v70, v71
  v_cvt_pk_bf16_f32 v20, v72, v73
  v_cvt_pk_bf16_f32 v21, v74, v75
  v_cvt_pk_bf16_f32 v22, v76, v77
  v_cvt_pk_bf16_f32 v23, v78, v79
  s_add_u32 s25, s22, 16035840
  buffer_store_dwordx4 v[16:19], v3, s[8:11], s25 offen sc1
  buffer_store_dwordx4 v[20:23], v7, s[8:11], s25 offen sc1
  s_branch EN_chain1_k_107
EL_chain1_k_106:
  v_and_b32 v1, 7, v0
  v_lshrrev_b32 v2, 3, v0
  s_lshr_b32 s20, s2, 2
  s_and_b32 s21, s2, 3
  s_lshl_b32 s21, s21, 3
  s_mul_i32 s22, s20, 36864
  s_lshl_b32 s23, s21, 4
  s_add_u32 s22, s22, s23
  v_lshlrev_b32 v3, 9, v2
  v_lshl_add_u32 v3, v1, 4, v3
  s_mov_b32 s19, s43
  s_mov_b32 s20, s44
  s_cmp_lg_u32 s19, 0
  s_cbranch_scc1 PD_chain1_k_111
  s_cmp_lg_u32 s20, 0
  s_cbranch_scc1 PD_chain1_k_111
  s_mul_i32 s46, s18, 48267264
  s_add_u32 s46, s46, 61616128
  s_lshl_b32 s47, s2, 8
  s_add_u32 s46, s46, s47
  s_mov_b32 s47, 300000
  v_mov_b32 v14, 0
PW_chain1_k_110:
  buffer_load_dword v252, v14, s[8:11], s46 offen sc1
  s_waitcnt vmcnt(0)
  v_readfirstlane_b32 s48, v252
  s_nop 3
  s_cmp_ge_u32 s48, 15
  s_cbranch_scc1 PW_chain1_k_110_x
  s_sub_u32 s47, s47, 1
  s_cmp_lg_u32 s47, 0
  s_cbranch_scc1 PW_chain1_k_110
PW_chain1_k_110_x:
PD_chain1_k_111:
  s_barrier
  s_add_u32 s25, s22, 47329280
  buffer_load_dwordx4 v[20:23], v3, s[8:11], s25 offen sc1
  s_add_u32 s25, s22, 49688576
  buffer_load_dwordx4 v[24:27], v3, s[8:11], s25 offen sc1
  s_add_u32 s25, s22, 52047872
  buffer_load_dwordx4 v[28:31], v3, s[8:11], s25 offen sc1
  s_add_u32 s25, s22, 54407168
  buffer_load_dwordx4 v[32:35], v3, s[8:11], s25 offen sc1
  s_add_u32 s25, s22, 56766464
  buffer_load_dwordx4 v[36:39], v3, s[8:11], s25 offen sc1
  s_add_u32 s25, s22, 59125760
  buffer_load_dwordx4 v[16:19], v3, s[8:11], s25 offen sc1
  s_waitcnt vmcnt(5)
  v_lshlrev_b32 v40, 16, v20
  v_and_b32 v41, 0xffff0000, v20
  v_lshlrev_b32 v42, 16, v21
  v_and_b32 v43, 0xffff0000, v21
  v_lshlrev_b32 v44, 16, v22
  v_and_b32 v45, 0xffff0000, v22
  v_lshlrev_b32 v46, 16, v23
  v_and_b32 v47, 0xffff0000, v23
  s_waitcnt vmcnt(4)
  v_lshlrev_b32 v48, 16, v24
  v_and_b32 v49, 0xffff0000, v24
  v_lshlrev_b32 v50, 16, v25
  v_and_b32 v51, 0xffff0000, v25
  v_lshlrev_b32 v52, 16, v26
  v_and_b32 v53, 0xffff0000, v26
  v_lshlrev_b32 v54, 16, v27
  v_and_b32 v55, 0xffff0000, v27
  v_pk_add_f32 v[40:41], v[40:41], v[48:49]
  v_pk_add_f32 v[42:43], v[42:43], v[50:51]
  v_pk_add_f32 v[44:45], v[44:45], v[52:53]
  v_pk_add_f32 v[46:47], v[46:47], v[54:55]
  s_waitcnt vmcnt(3)
  v_lshlrev_b32 v48, 16, v28
  v_and_b32 v49, 0xffff0000, v28
  v_lshlrev_b32 v50, 16, v29
  v_and_b32 v51, 0xffff0000, v29
  v_lshlrev_b32 v52, 16, v30
  v_and_b32 v53, 0xffff0000, v30
  v_lshlrev_b32 v54, 16, v31
  v_and_b32 v55, 0xffff0000, v31
  v_pk_add_f32 v[40:41], v[40:41], v[48:49]
  v_pk_add_f32 v[42:43], v[42:43], v[50:51]
  v_pk_add_f32 v[44:45], v[44:45], v[52:53]
  v_pk_add_f32 v[46:47], v[46:47], v[54:55]
  s_waitcnt vmcnt(2)
  v_lshlrev_b32 v48, 16, v32
  v_and_b32 v49, 0xffff0000, v32
  v_lshlrev_b32 v50, 16, v33
  v_and_b32 v51, 0xffff0000, v33
  v_lshlrev_b32 v52, 16, v34
  v_and_b32 v53, 0xffff0000, v34
  v_lshlrev_b32 v54, 16, v35
  v_and_b32 v55, 0xffff0000, v35
  v_pk_add_f32 v[40:41], v[40:41], v[48:49]
  v_pk_add_f32 v[42:43], v[42:43], v[50:51]
  v_pk_add_f32 v[44:45], v[44:45], v[52:53]
  v_pk_add_f32 v[46:47], v[46:47], v[54:55]
  s_waitcnt vmcnt(1)
  v_lshlrev_b32 v48, 16, v36
  v_and_b32 v49, 0xffff0000, v36
  v_lshlrev_b32 v50, 16, v37
  v_and_b32 v51, 0xffff0000, v37
  v_lshlrev_b32 v52, 16, v38
  v_and_b32 v53, 0xffff0000, v38
  v_lshlrev_b32 v54, 16, v39
  v_and_b32 v55, 0xffff0000, v39
  v_pk_add_f32 v[40:41], v[40:41], v[48:49]
  v_pk_add_f32 v[42:43], v[42:43], v[50:51]
  v_pk_add_f32 v[44:45], v[44:45], v[52:53]
  v_pk_add_f32 v[46:47], v[46:47], v[54:55]
  s_mov_b32 s26, 0xbf317218
  s_waitcnt vmcnt(0)
  v_lshlrev_b32 v48, 16, v16
  v_and_b32 v49, 0xffff0000, v16
  v_lshlrev_b32 v50, 16, v17
  v_and_b32 v51, 0xffff0000, v17
  v_lshlrev_b32 v52, 16, v18
  v_and_b32 v53, 0xffff0000, v18
  v_lshlrev_b32 v54, 16, v19
  v_and_b32 v55, 0xffff0000, v19
  v_fma_f32 v40, v40, s26, v48
  v_fma_f32 v41, v41, s26, v49
  v_fma_f32 v42, v42, s26, v50
  v_fma_f32 v43, v43, s26, v51
  v_fma_f32 v44, v44, s26, v52
  v_fma_f32 v45, v45, s26, v53
  v_fma_f32 v46, v46, s26, v54
  v_fma_f32 v47, v47, s26, v55
  v_cvt_pk_bf16_f32 v16, v40, v41
  v_cvt_pk_bf16_f32 v17, v42, v43
  v_cvt_pk_bf16_f32 v18, v44, v45
  v_cvt_pk_bf16_f32 v19, v46, v47
  v_lshlrev_b32 v40, 16, v16
  v_and_b32 v41, 0xffff0000, v16
  v_lshlrev_b32 v42, 16, v17
  v_and_b32 v43, 0xffff0000, v17
  v_lshlrev_b32 v44, 16, v18
  v_and_b32 v45, 0xffff0000, v18
  v_lshlrev_b32 v46, 16, v19
  v_and_b32 v47, 0xffff0000, v19
  s_add_u32 s25, s22, 13676544
  buffer_store_dwordx4 v[16:19], v3, s[8:11], s25 offen sc1
  v_add_f32 v56, v40, v41
  v_mul_f32 v57, v40, v40
  v_fmac_f32 v57, v41, v41
  v_add_f32 v56, v56, v42
  v_fmac_f32 v57, v42, v42
  v_add_f32 v56, v56, v43
  v_fmac_f32 v57, v43, v43
  v_add_f32 v56, v56, v44
  v_fmac_f32 v57, v44, v44
  v_add_f32 v56, v56, v45
  v_fmac_f32 v57, v45, v45
  v_add_f32 v56, v56, v46
  v_fmac_f32 v57, v46, v46
  v_add_f32 v56, v56, v47
  v_fmac_f32 v57, v47, v47
  s_nop 0
  v_add_f32_dpp v56, v56, v56 row_ror:8 row_mask:0xf bank_mask:0xf
  v_add_f32_dpp v57, v57, v57 row_ror:8 row_mask:0xf bank_mask:0xf
  v_mov_b32 v58, v56
  s_nop 1
  v_permlane16_swap_b32 v58, v56
  v_add_f32 v56, v56, v58
  v_mov_b32 v58, v57
  s_nop 1
  v_permlane16_swap_b32 v58, v57
  v_add_f32 v57, v57, v58
  v_mov_b32 v58, v56
  s_nop 1
  v_permlane32_swap_b32 v58, v56
  v_add_f32 v56, v56, v58
  v_mov_b32 v58, v57
  s_nop 1
  v_permlane32_swap_b32 v58, v57
  v_add_f32 v57, v57, v58
  v_lshrrev_b32 v58, 6, v0
  v_lshlrev_b32 v58, 3, v58
  v_mul_u32_u24 v59, 80, v1
  v_add_u32 v58, v58, v59
  ds_write_b64 v58, v[56:57]
  s_waitcnt lgkmcnt(0)
  s_barrier
  ds_read_b64 v[60:61], v59 offset:0
  ds_read_b64 v[62:63], v59 offset:8
  ds_read_b64 v[64:65], v59 offset:16
  ds_read_b64 v[66:67], v59 offset:24
  ds_read_b64 v[68:69], v59 offset:32
  ds_read_b64 v[70:71], v59 offset:40
  ds_read_b64 v[72:73], v59 offset:48
  ds_read_b64 v[74:75], v59 offset:56
  s_waitcnt lgkmcnt(6)
  v_add_f32 v56, v60, v62
  v_add_f32 v57, v61, v63
  s_waitcnt lgkmcnt(5)
  v_add_f32 v56, v56, v64
  v_add_f32 v57, v57, v65
  s_waitcnt lgkmcnt(4)
  v_add_f32 v56, v56, v66
  v_add_f32 v57, v57, v67
  s_waitcnt lgkmcnt(3)
  v_add_f32 v56, v56, v68
  v_add_f32 v57, v57, v69
  s_waitcnt lgkmcnt(2)
  v_add_f32 v56, v56, v70
  v_add_f32 v57, v57, v71
  s_waitcnt lgkmcnt(1)
  v_add_f32 v56, v56, v72
  v_add_f32 v57, v57, v73
  s_waitcnt lgkmcnt(0)
  v_add_f32 v56, v56, v74
  v_add_f32 v57, v57, v75
  v_mul_f32 v56, 0x3ae38e39, v56
  v_mul_f32 v57, 0x3ae38e39, v57
  v_fma_f32 v57, -v56, v56, v57
  v_max_f32 v57, 0, v57
  v_cvt_pk_bf16_f32 v57, v57, v57
  v_and_b32 v57, 0xffff0000, v57
  v_add_f32 v57, 0x3727c5ac, v57
  v_cvt_pk_bf16_f32 v57, v57, v57
  v_and_b32 v57, 0xffff0000, v57
  v_sqrt_f32 v57, v57
  s_nop 0
  v_cvt_pk_bf16_f32 v57, v57, v57
  v_and_b32 v57, 0xffff0000, v57
  v_rcp_f32 v57, v57
  v_cvt_pk_bf16_f32 v56, v56, v56
  v_and_b32 v56, 0xffff0000, v56
  v_sub_f32 v40, v40, v56
  v_sub_f32 v41, v41, v56
  v_sub_f32 v42, v42, v56
  v_sub_f32 v43, v43, v56
  v_sub_f32 v44, v44, v56
  v_sub_f32 v45, v45, v56
  v_sub_f32 v46, v46, v56
  v_sub_f32 v47, v47, v56
  v_cvt_pk_bf16_f32 v16, v40, v41
  v_cvt_pk_bf16_f32 v17, v42, v43
  v_cvt_pk_bf16_f32 v18, v44, v45
  v_cvt_pk_bf16_f32 v19, v46, v47
  v_lshlrev_b32 v40, 16, v16
  v_and_b32 v41, 0xffff0000, v16
  v_lshlrev_b32 v42, 16, v17
  v_and_b32 v43, 0xffff0000, v17
  v_lshlrev_b32 v44, 16, v18
  v_and_b32 v45, 0xffff0000, v18
  v_lshlrev_b32 v46, 16, v19
  v_and_b32 v47, 0xffff0000, v19
  v_mul_f32 v40, v40, v57
  v_mul_f32 v41, v41, v57
  v_mul_f32 v42, v42, v57
  v_mul_f32 v43, v43, v57
  v_mul_f32 v44, v44, v57
  v_mul_f32 v45, v45, v57
  v_mul_f32 v46, v46, v57
  v_mul_f32 v47, v47, v57
  v_cvt_pk_bf16_f32 v16, v40, v41
  v_cvt_pk_bf16_f32 v17, v42, v43
  v_cvt_pk_bf16_f32 v18, v44, v45
  v_cvt_pk_bf16_f32 v19, v46, v47
  s_add_u32 s25, s22, 16035840
  buffer_store_dwordx4 v[16:19], v3, s[8:11], s25 offen sc1
EN_chain1_k_107:
  s_branch EN_chain1_k_105
EL_chain1_k_104:
  s_mov_b32 s12, s6
  s_and_b32 s13, s7, 65535
  s_mov_b32 s14, 0x240000
  s_mov_b32 s15, 0x20000
  v_readfirstlane_b32 s45, v0
  s_nop 3
  s_cmp_lt_u32 s45, 64
  s_cbranch_scc0 EL_chain1_k_112
  v_and_b32 v1, 7, v0
  v_lshrrev_b32 v2, 3, v0
  s_lshr_b32 s20, s2, 2
  s_and_b32 s21, s2, 3
  s_lshl_b32 s21, s21, 3
  s_mul_i32 s22, s20, 36864
  s_lshl_b32 s23, s21, 4
  s_add_u32 s22, s22, s23
  v_lshlrev_b32 v3, 9, v2
  v_lshl_add_u32 v3, v1, 4, v3
  s_lshl_b32 s24, s2, 3
  v_add_u32 v4, s24, v1
  v_mul_u32_u24 v4, 1152, v4
  v_lshl_add_u32 v4, v2, 4, v4
  v_add_u32 v7, 32768, v3
  v_add_u32 v6, 1024, v4
  v_cmp_gt_u32 vcc, 8, v2
  v_mov_b32 v12, 0x7ffffff0
  s_nop 0
  v_cndmask_b32 v7, v12, v7, vcc
  v_cndmask_b32 v6, v12, v6, vcc
  s_mov_b32 s19, s43
  s_mov_b32 s20, s44
  s_cmp_lg_u32 s19, 0
  s_cbranch_scc1 PD_chain1_k_115
  s_cmp_lg_u32 s20, 0
  s_cbranch_scc1 PD_chain1_k_115
  s_mul_i32 s46, s18, 48267264
  s_add_u32 s46, s46, 61616128
  s_lshl_b32 s47, s2, 8
  s_add_u32 s46, s46, s47
  s_mov_b32 s47, 300000
  v_mov_b32 v14, 0
PW_chain1_k_114:
  buffer_load_dword v252, v14, s[8:11], s46 offen sc1
  s_waitcnt vmcnt(0)
  v_readfirstlane_b32 s48, v252
  s_nop 3
  s_cmp_ge_u32 s48, 15
  s_cbranch_scc1 PW_chain1_k_114_x
  s_sub_u32 s47, s47, 1
  s_cmp_lg_u32 s47, 0
  s_cbranch_scc1 PW_chain1_k_114
PW_chain1_k_114_x:
PD_chain1_k_115:
  s_barrier
  s_add_u32 s25, s22, 47329280
  buffer_load_dwordx4 v[24:27], v3, s[8:11], s25 offen sc1
  buffer_load_dwordx4 v[28:31], v7, s[8:11], s25 offen sc1
  s_add_u32 s25, s22, 49688576
  buffer_load_dwordx4 v[32:35], v3, s[8:11], s25 offen sc1
  buffer_load_dwordx4 v[36:39], v7, s[8:11], s25 offen sc1
  s_add_u32 s25, s22, 52047872
  buffer_load_dwordx4 v[40:43], v3, s[8:11], s25 offen sc1
  buffer_load_dwordx4 v[44:47], v7, s[8:11], s25 offen sc1
  s_add_u32 s25, s22, 54407168
  buffer_load_dwordx4 v[48:51], v3, s[8:11], s25 offen sc1
  buffer_load_dwordx4 v[52:55], v7, s[8:11], s25 offen sc1
  s_add_u32 s25, s22, 56766464
  buffer_load_dwordx4 v[56:59], v3, s[8:11], s25 offen sc1
  buffer_load_dwordx4 v[60:63], v7, s[8:11], s25 offen sc1
  s_add_u32 s25, s22, 59125760
  buffer_load_dwordx4 v[16:19], v3, s[8:11], s25 offen sc1
  buffer_load_dwordx4 v[20:23], v7, s[8:11], s25 offen sc1
  s_waitcnt vmcnt(11)
  v_lshlrev_b32 v64, 16, v24
  v_and_b32 v65, 0xffff0000, v24
  v_lshlrev_b32 v66, 16, v25
  v_and_b32 v67, 0xffff0000, v25
  v_lshlrev_b32 v68, 16, v26
  v_and_b32 v69, 0xffff0000, v26
  v_lshlrev_b32 v70, 16, v27
  v_and_b32 v71, 0xffff0000, v27
  s_waitcnt vmcnt(10)
  v_lshlrev_b32 v72, 16, v28
  v_and_b32 v73, 0xffff0000, v28
  v_lshlrev_b32 v74, 16, v29
  v_and_b32 v75, 0xffff0000, v29
  v_lshlrev_b32 v76, 16, v30
  v_and_b32 v77, 0xffff0000, v30
  v_lshlrev_b32 v78, 16, v31
  v_and_b32 v79, 0xffff0000, v31
  s_waitcnt vmcnt(9)
  v_lshlrev_b32 v80, 16, v32
  v_and_b32 v81, 0xffff0000, v32
  v_lshlrev_b32 v82, 16, v33
  v_and_b32 v83, 0xffff0000, v33
  v_lshlrev_b32 v84, 16, v34
  v_and_b32 v85, 0xffff0000, v34
  v_lshlrev_b32 v86, 16, v35
  v_and_b32 v87, 0xffff0000, v35
  s_waitcnt vmcnt(8)
  v_lshlrev_b32 v88, 16, v36
  v_and_b32 v89, 0xffff0000, v36
  v_lshlrev_b32 v90, 16, v37
  v_and_b32 v91, 0xffff0000, v37
  v_lshlrev_b32 v92, 16, v38
  v_and_b32 v93, 0xffff0000, v38
  v_lshlrev_b32 v94, 16, v39
  v_and_b32 v95, 0xffff0000, v39
  v_pk_add_f32 v[64:65], v[64:65], v[80:81]
  v_pk_add_f32 v[66:67], v[66:67], v[82:83]
  v_pk_add_f32 v[68:69], v[68:69], v[84:85]
  v_pk_add_f32 v[70:71], v[70:71], v[86:87]
  v_pk_add_f32 v[72:73], v[72:73], v[88:89]
  v_pk_add_f32 v[74:75], v[74:75], v[90:91]
  v_pk_add_f32 v[76:77], v[76:77], v[92:93]
  v_pk_add_f32 v[78:79], v[78:79], v[94:95]
  s_waitcnt vmcnt(7)
  v_lshlrev_b32 v80, 16, v40
  v_and_b32 v81, 0xffff0000, v40
  v_lshlrev_b32 v82, 16, v41
  v_and_b32 v83, 0xffff0000, v41
  v_lshlrev_b32 v84, 16, v42
  v_and_b32 v85, 0xffff0000, v42
  v_lshlrev_b32 v86, 16, v43
  v_and_b32 v87, 0xffff0000, v43
  s_waitcnt vmcnt(6)
  v_lshlrev_b32 v88, 16, v44
  v_and_b32 v89, 0xffff0000, v44
  v_lshlrev_b32 v90, 16, v45
  v_and_b32 v91, 0xffff0000, v45
  v_lshlrev_b32 v92, 16, v46
  v_and_b32 v93, 0xffff0000, v46
  v_lshlrev_b32 v94, 16, v47
  v_and_b32 v95, 0xffff0000, v47
  v_pk_add_f32 v[64:65], v[64:65], v[80:81]
  v_pk_add_f32 v[66:67], v[66:67], v[82:83]
  v_pk_add_f32 v[68:69], v[68:69], v[84:85]
  v_pk_add_f32 v[70:71], v[70:71], v[86:87]
  v_pk_add_f32 v[72:73], v[72:73], v[88:89]
  v_pk_add_f32 v[74:75], v[74:75], v[90:91]
  v_pk_add_f32 v[76:77], v[76:77], v[92:93]
  v_pk_add_f32 v[78:79], v[78:79], v[94:95]
  s_waitcnt vmcnt(5)
  v_lshlrev_b32 v80, 16, v48
  v_and_b32 v81, 0xffff0000, v48
  v_lshlrev_b32 v82, 16, v49
  v_and_b32 v83, 0xffff0000, v49
  v_lshlrev_b32 v84, 16, v50
  v_and_b32 v85, 0xffff0000, v50
  v_lshlrev_b32 v86, 16, v51
  v_and_b32 v87, 0xffff0000, v51
  s_waitcnt vmcnt(4)
  v_lshlrev_b32 v88, 16, v52
  v_and_b32 v89, 0xffff0000, v52
  v_lshlrev_b32 v90, 16, v53
  v_and_b32 v91, 0xffff0000, v53
  v_lshlrev_b32 v92, 16, v54
  v_and_b32 v93, 0xffff0000, v54
  v_lshlrev_b32 v94, 16, v55
  v_and_b32 v95, 0xffff0000, v55
  v_pk_add_f32 v[64:65], v[64:65], v[80:81]
  v_pk_add_f32 v[66:67], v[66:67], v[82:83]
  v_pk_add_f32 v[68:69], v[68:69], v[84:85]
  v_pk_add_f32 v[70:71], v[70:71], v[86:87]
  v_pk_add_f32 v[72:73], v[72:73], v[88:89]
  v_pk_add_f32 v[74:75], v[74:75], v[90:91]
  v_pk_add_f32 v[76:77], v[76:77], v[92:93]
  v_pk_add_f32 v[78:79], v[78:79], v[94:95]
  s_waitcnt vmcnt(3)
  v_lshlrev_b32 v80, 16, v56
  v_and_b32 v81, 0xffff0000, v56
  v_lshlrev_b32 v82, 16, v57
  v_and_b32 v83, 0xffff0000, v57
  v_lshlrev_b32 v84, 16, v58
  v_and_b32 v85, 0xffff0000, v58
  v_lshlrev_b32 v86, 16, v59
  v_and_b32 v87, 0xffff0000, v59
  s_waitcnt vmcnt(2)
  v_lshlrev_b32 v88, 16, v60
  v_and_b32 v89, 0xffff0000, v60
  v_lshlrev_b32 v90, 16, v61
  v_and_b32 v91, 0xffff0000, v61
  v_lshlrev_b32 v92, 16, v62
  v_and_b32 v93, 0xffff0000, v62
  v_lshlrev_b32 v94, 16, v63
  v_and_b32 v95, 0xffff0000, v63
  v_pk_add_f32 v[64:65], v[64:65], v[80:81]
  v_pk_add_f32 v[66:67], v[66:67], v[82:83]
  v_pk_add_f32 v[68:69], v[68:69], v[84:85]
  v_pk_add_f32 v[70:71], v[70:71], v[86:87]
  v_pk_add_f32 v[72:73], v[72:73], v[88:89]
  v_pk_add_f32 v[74:75], v[74:75], v[90:91]
  v_pk_add_f32 v[76:77], v[76:77], v[92:93]
  v_pk_add_f32 v[78:79], v[78:79], v[94:95]
  s_mov_b32 s26, 0xbf317218
  s_waitcnt vmcnt(1)
  v_lshlrev_b32 v80, 16, v16
  v_and_b32 v81, 0xffff0000, v16
  v_lshlrev_b32 v82, 16, v17
  v_and_b32 v83, 0xffff0000, v17
  v_lshlrev_b32 v84, 16, v18
  v_and_b32 v85, 0xffff0000, v18
  v_lshlrev_b32 v86, 16, v19
  v_and_b32 v87, 0xffff0000, v19
  s_waitcnt vmcnt(0)
  v_lshlrev_b32 v88, 16, v20
  v_and_b32 v89, 0xffff0000, v20
  v_lshlrev_b32 v90, 16, v21
  v_and_b32 v91, 0xffff0000, v21
  v_lshlrev_b32 v92, 16, v22
  v_and_b32 v93, 0xffff0000, v22
  v_lshlrev_b32 v94, 16, v23
  v_and_b32 v95, 0xffff0000, v23
  v_fma_f32 v64, v64, s26, v80
  v_fma_f32 v65, v65, s26, v81
  v_fma_f32 v66, v66, s26, v82
  v_fma_f32 v67, v67, s26, v83
  v_fma_f32 v68, v68, s26, v84
  v_fma_f32 v69, v69, s26, v85
  v_fma_f32 v70, v70, s26, v86
  v_fma_f32 v71, v71, s26, v87
  v_fma_f32 v72, v72, s26, v88
  v_fma_f32 v73, v73, s26, v89
  v_fma_f32 v74, v74, s26, v90
  v_fma_f32 v75, v75, s26, v91
  v_fma_f32 v76, v76, s26, v92
  v_fma_f32 v77, v77, s26, v93
  v_fma_f32 v78, v78, s26, v94
  v_fma_f32 v79, v79, s26, v95
  v_cvt_pk_bf16_f32 v16, v64, v65
  v_cvt_pk_bf16_f32 v17, v66, v67
  v_cvt_pk_bf16_f32 v18, v68, v69
  v_cvt_pk_bf16_f32 v19, v70, v71
  v_cvt_pk_bf16_f32 v20, v72, v73
  v_cvt_pk_bf16_f32 v21, v74, v75
  v_cvt_pk_bf16_f32 v22, v76, v77
  v_cvt_pk_bf16_f32 v23, v78, v79
  buffer_store_dwordx4 v[16:19], v4, s[12:15], 0 offen
  buffer_store_dwordx4 v[20:23], v6, s[12:15], 0 offen
  s_branch EN_chain1_k_113
EL_chain1_k_112:
  v_and_b32 v1, 7, v0
  v_lshrrev_b32 v2, 3, v0
  s_lshr_b32 s20, s2, 2
  s_and_b32 s21, s2, 3
  s_lshl_b32 s21, s21, 3
  s_mul_i32 s22, s20, 36864
  s_lshl_b32 s23, s21, 4
  s_add_u32 s22, s22, s23
  v_lshlrev_b32 v3, 9, v2
  v_lshl_add_u32 v3, v1, 4, v3
  s_lshl_b32 s24, s2, 3
  v_add_u32 v4, s24, v1
  v_mul_u32_u24 v4, 1152, v4
  v_lshl_add_u32 v4, v2, 4, v4
  s_mov_b32 s19, s43
  s_mov_b32 s20, s44
  s_cmp_lg_u32 s19, 0
  s_cbranch_scc1 PD_chain1_k_117
  s_cmp_lg_u32 s20, 0
  s_cbranch_scc1 PD_chain1_k_117
  s_mul_i32 s46, s18, 48267264
  s_add_u32 s46, s46, 61616128
  s_lshl_b32 s47, s2, 8
  s_add_u32 s46, s46, s47
  s_mov_b32 s47, 300000
  v_mov_b32 v14, 0
PW_chain1_k_116:
  buffer_load_dword v252, v14, s[8:11], s46 offen sc1
  s_waitcnt vmcnt(0)
  v_readfirstlane_b32 s48, v252
  s_nop 3
  s_cmp_ge_u32 s48, 15
  s_cbranch_scc1 PW_chain1_k_116_x
  s_sub_u32 s47, s47, 1
  s_cmp_lg_u32 s47, 0
  s_cbranch_scc1 PW_chain1_k_116
PW_chain1_k_116_x:
PD_chain1_k_117:
  s_barrier
  s_add_u32 s25, s22, 47329280
  buffer_load_dwordx4 v[20:23], v3, s[8:11], s25 offen sc1
  s_add_u32 s25, s22, 49688576
  buffer_load_dwordx4 v[24:27], v3, s[8:11], s25 offen sc1
  s_add_u32 s25, s22, 52047872
  buffer_load_dwordx4 v[28:31], v3, s[8:11], s25 offen sc1
  s_add_u32 s25, s22, 54407168
  buffer_load_dwordx4 v[32:35], v3, s[8:11], s25 offen sc1
  s_add_u32 s25, s22, 56766464
  buffer_load_dwordx4 v[36:39], v3, s[8:11], s25 offen sc1
  s_add_u32 s25, s22, 59125760
  buffer_load_dwordx4 v[16:19], v3, s[8:11], s25 offen sc1
  s_waitcnt vmcnt(5)
  v_lshlrev_b32 v40, 16, v20
  v_and_b32 v41, 0xffff0000, v20
  v_lshlrev_b32 v42, 16, v21
  v_and_b32 v43, 0xffff0000, v21
  v_lshlrev_b32 v44, 16, v22
  v_and_b32 v45, 0xffff0000, v22
  v_lshlrev_b32 v46, 16, v23
  v_and_b32 v47, 0xffff0000, v23
  s_waitcnt vmcnt(4)
  v_lshlrev_b32 v48, 16, v24
  v_and_b32 v49, 0xffff0000, v24
  v_lshlrev_b32 v50, 16, v25
  v_and_b32 v51, 0xffff0000, v25
  v_lshlrev_b32 v52, 16, v26
  v_and_b32 v53, 0xffff0000, v26
  v_lshlrev_b32 v54, 16, v27
  v_and_b32 v55, 0xffff0000, v27
  v_pk_add_f32 v[40:41], v[40:41], v[48:49]
  v_pk_add_f32 v[42:43], v[42:43], v[50:51]
  v_pk_add_f32 v[44:45], v[44:45], v[52:53]
  v_pk_add_f32 v[46:47], v[46:47], v[54:55]
  s_waitcnt vmcnt(3)
  v_lshlrev_b32 v48, 16, v28
  v_and_b32 v49, 0xffff0000, v28
  v_lshlrev_b32 v50, 16, v29
  v_and_b32 v51, 0xffff0000, v29
  v_lshlrev_b32 v52, 16, v30
  v_and_b32 v53, 0xffff0000, v30
  v_lshlrev_b32 v54, 16, v31
  v_and_b32 v55, 0xffff0000, v31
  v_pk_add_f32 v[40:41], v[40:41], v[48:49]
  v_pk_add_f32 v[42:43], v[42:43], v[50:51]
  v_pk_add_f32 v[44:45], v[44:45], v[52:53]
  v_pk_add_f32 v[46:47], v[46:47], v[54:55]
  s_waitcnt vmcnt(2)
  v_lshlrev_b32 v48, 16, v32
  v_and_b32 v49, 0xffff0000, v32
  v_lshlrev_b32 v50, 16, v33
  v_and_b32 v51, 0xffff0000, v33
  v_lshlrev_b32 v52, 16, v34
  v_and_b32 v53, 0xffff0000, v34
  v_lshlrev_b32 v54, 16, v35
  v_and_b32 v55, 0xffff0000, v35
  v_pk_add_f32 v[40:41], v[40:41], v[48:49]
  v_pk_add_f32 v[42:43], v[42:43], v[50:51]
  v_pk_add_f32 v[44:45], v[44:45], v[52:53]
  v_pk_add_f32 v[46:47], v[46:47], v[54:55]
  s_waitcnt vmcnt(1)
  v_lshlrev_b32 v48, 16, v36
  v_and_b32 v49, 0xffff0000, v36
  v_lshlrev_b32 v50, 16, v37
  v_and_b32 v51, 0xffff0000, v37
  v_lshlrev_b32 v52, 16, v38
  v_and_b32 v53, 0xffff0000, v38
  v_lshlrev_b32 v54, 16, v39
  v_and_b32 v55, 0xffff0000, v39
  v_pk_add_f32 v[40:41], v[40:41], v[48:49]
  v_pk_add_f32 v[42:43], v[42:43], v[50:51]
  v_pk_add_f32 v[44:45], v[44:45], v[52:53]
  v_pk_add_f32 v[46:47], v[46:47], v[54:55]
  s_mov_b32 s26, 0xbf317218
  s_waitcnt vmcnt(0)
  v_lshlrev_b32 v48, 16, v16
  v_and_b32 v49, 0xffff0000, v16
  v_lshlrev_b32 v50, 16, v17
  v_and_b32 v51, 0xffff0000, v17
  v_lshlrev_b32 v52, 16, v18
  v_and_b32 v53, 0xffff0000, v18
  v_lshlrev_b32 v54, 16, v19
  v_and_b32 v55, 0xffff0000, v19
  v_fma_f32 v40, v40, s26, v48
  v_fma_f32 v41, v41, s26, v49
  v_fma_f32 v42, v42, s26, v50
  v_fma_f32 v43, v43, s26, v51
  v_fma_f32 v44, v44, s26, v52
  v_fma_f32 v45, v45, s26, v53
  v_fma_f32 v46, v46, s26, v54
  v_fma_f32 v47, v47, s26, v55
  v_cvt_pk_bf16_f32 v16, v40, v41
  v_cvt_pk_bf16_f32 v17, v42, v43
  v_cvt_pk_bf16_f32 v18, v44, v45
  v_cvt_pk_bf16_f32 v19, v46, v47
  buffer_store_dwordx4 v[16:19], v4, s[12:15], 0 offen
EN_chain1_k_113:
  s_endpgm
EN_chain1_k_105:
  v_lshrrev_b32 v1, 6, v0
  s_nop 0
  v_readfirstlane_b32 s20, v1
  v_and_b32 v1, 63, v0
  v_lshlrev_b32 v2, 4, v1
  s_nop 1
  s_lshr_b32 s19, s20, 2
  s_and_b32 s20, s20, 3
  s_lshr_b32 s27, s2, 4
  s_waitcnt vmcnt(0) lgkmcnt(0)
  s_barrier
  s_cmp_lg_u32 s19, 1
  s_cbranch_scc1 SD_chain1_k_118
  s_cmp_lg_u32 s20, 0
  s_cbranch_scc1 SD_chain1_k_118
  v_cmp_lt_u32 vcc, 6, v1
  v_mov_b32 v14, 0
  v_mov_b32 v15, 4
  v_cndmask_b32 v14, v14, v15, vcc
  v_mov_b32 v13, 0
  v_mov_b32 v15, 7
  v_cndmask_b32 v13, v13, v15, vcc
  v_sub_u32 v13, v1, v13
  v_lshlrev_b32 v13, 5, v13
  v_add_u32 v14, v14, v13
  s_lshr_b32 s46, s27, 2
  s_and_b32 s47, s27, 3
  s_lshl_b32 s47, s47, 3
  s_add_u32 s46, s46, s47
  v_add_u32 v14, s46, v14
  v_lshlrev_b32 v14, 8, v14
  s_mul_i32 s46, s18, 48267264
  s_add_u32 s46, s46, 61681664
  v_mov_b32 v15, 1
  s_mov_b64 exec, 16383
  buffer_atomic_add v15, v14, s[8:11], s46 offen sc1
  s_mov_b64 exec, -1
SD_chain1_k_118:
  s_waitcnt vmcnt(0) lgkmcnt(0)
  s_nop 15
PHS_qkv:
  s_getpc_b64 s[84:85]
PHP_qkv:
  s_mov_b32 s88, s84
  s_and_b32 s89, s85, 0xffff
  s_mov_b32 s90, PHS_end-PHP_qkv
  s_mov_b32 s91, 0x20000
  v_lshlrev_b32 v251, 4, v0
  buffer_load_dwordx4 v[252:255], v251, s[88:91], 0 offen
  s_cmp_ge_u32 s2, 224
  s_cbranch_scc1 QE_chain1_k_119
  v_lshrrev_b32 v1, 6, v0
  s_nop 0
  v_readfirstlane_b32 s20, v1
  v_and_b32 v1, 63, v0
  v_lshlrev_b32 v2, 4, v1
  s_nop 1
  s_lshr_b32 s19, s20, 2
  s_and_b32 s20, s20, 3
  v_lshrrev_b32 v5, 5, v1
  v_and_b32 v6, 31, v1
  s_and_b32 s21, s2, 7
  s_lshr_b32 s22, s2, 3
  s_and_b32 s23, s21, 3
  s_lshl_b32 s23, s23, 2
  s_and_b32 s24, s22, 3
  s_add_u32 s23, s23, s24
  s_lshr_b32 s24, s21, 2
  s_mul_i32 s24, s24, 7
  s_lshr_b32 s25, s22, 2
  s_add_u32 s24, s24, s25
  s_lshl_b32 s25, s23, 2
  s_add_u32 s25, s25, s20
  s_mov_b32 s12, s4
  s_and_b32 s13, s5, 65535
  s_mov_b32 s14, 0x10000000
  s_mov_b32 s15, 0x20000
  s_mul_i32 s32, s25, 36864
  s_add_u32 s32, s32, 16035840
  s_mul_i32 s30, s24, 147456
  s_add_u32 s30, s30, 0
  s_mov_b32 s28, 18
  s_cmp_lg_u32 s19, 0
  s_cbranch_scc1 PD_chain1_k_121
  s_cmp_lg_u32 s20, 0
  s_cbranch_scc1 PD_chain1_k_121
  s_mul_i32 s46, s18, 48267264
  s_add_u32 s46, s46, 61681664
  s_lshl_b32 s47, s2, 8
  s_add_u32 s46, s46, s47
  s_mov_b32 s47, 300000
  v_mov_b32 v14, 0
PW_chain1_k_120:
  buffer_load_dword v252, v14, s[8:11], s46 offen sc1
  s_waitcnt vmcnt(0)
  v_readfirstlane_b32 s48, v252
  s_nop 3
  s_cmp_ge_u32 s48, 16
  s_cbranch_scc1 PW_chain1_k_120_x
  s_sub_u32 s47, s47, 1
  s_cmp_lg_u32 s47, 0
  s_cbranch_scc1 PW_chain1_k_120
PW_chain1_k_120_x:
PD_chain1_k_121:
  s_cmp_eq_u32 s19, 0
  s_cbranch_scc1 SK_chain1_k_122
  s_mul_i32 s31, s20, 2048
  s_add_u32 s30, s30, s31
  s_mov_b32 s33, 0
  s_mul_i32 s35, s20, 2048
  s_add_u32 s35, s35, 8192
  s_mov_b32 s36, s28
  s_mov_b32 s37, 0
  s_add_u32 s34, s37, s31
  s_mov_b32 m0, s34
  s_nop 0
  buffer_load_dwordx4 v2, s[12:15], s30 offen lds
  buffer_load_dwordx4 v2, s[12:15], s30 offen offset:1024 lds
  s_add_u32 s30, s30, 8192
  s_add_u32 s37, s37, 16384
  s_add_u32 s34, s37, s31
  s_mov_b32 m0, s34
  s_nop 0
  buffer_load_dwordx4 v2, s[12:15], s30 offen lds
  buffer_load_dwordx4 v2, s[12:15], s30 offen offset:1024 lds
  s_add_u32 s30, s30, 8192
  s_add_u32 s37, s37, 16384
  s_add_u32 s34, s37, s31
  s_mov_b32 m0, s34
  s_nop 0
  buffer_load_dwordx4 v2, s[12:15], s30 offen lds
  buffer_load_dwordx4 v2, s[12:15], s30 offen offset:1024 lds
  s_add_u32 s30, s30, 8192
  s_add_u32 s37, s37, 16384
  s_add_u32 s34, s37, s31
  s_mov_b32 m0, s34
  s_nop 0
  buffer_load_dwordx4 v2, s[12:15], s30 offen lds
  buffer_load_dwordx4 v2, s[12:15], s30 offen offset:1024 lds
  s_add_u32 s30, s30, 8192
  s_add_u32 s37, s37, 16384
  s_add_u32 s34, s37, s31
  s_mov_b32 m0, s34
  s_nop 0
  buffer_load_dwordx4 v2, s[12:15], s30 offen lds
  buffer_load_dwordx4 v2, s[12:15], s30 offen offset:1024 lds
  s_add_u32 s30, s30, 8192
  s_add_u32 s37, s37, 16384
  s_add_u32 s34, s37, s31
  s_mov_b32 m0, s34
  s_nop 0
  buffer_load_dwordx4 v2, s[12:15], s30 offen lds
  buffer_load_dwordx4 v2, s[12:15], s30 offen offset:1024 lds
  s_add_u32 s30, s30, 8192
  s_add_u32 s37, s37, 16384
  s_add_u32 s34, s37, s31
  s_mov_b32 m0, s34
  s_nop 0
  buffer_load_dwordx4 v2, s[12:15], s30 offen lds
  buffer_load_dwordx4 v2, s[12:15], s30 offen offset:1024 lds
  s_add_u32 s30, s30, 8192
  s_add_u32 s37, s37, 16384
  s_add_u32 s34, s37, s31
  s_mov_b32 m0, s34
  s_nop 0
  buffer_load_dwordx4 v2, s[12:15], s30 offen lds
  buffer_load_dwordx4 v2, s[12:15], s30 offen offset:1024 lds
  s_add_u32 s30, s30, 8192
  s_add_u32 s37, s37, 16384
  s_barrier
  s_add_u32 s34, s33, s35
  s_mov_b32 m0, s34
  s_nop 0
  buffer_load_dwordx4 v2, s[12:15], s32 offen sc1 lds
  buffer_load_dwordx4 v2, s[12:15], s32 offen offset:1024 sc1 lds
  s_add_u32 s32, s32, 2048
  s_add_u32 s33, s33, 16384
  s_cmp_ge_u32 s33, 147456
  s_cselect_b32 s33, 0, s33
  s_sub_u32 s36, s36, 1
  s_cmp_eq_u32 s36, 0
  s_cselect_b32 s14, 0, s14
  s_add_u32 s34, s33, s35
  s_mov_b32 m0, s34
  s_nop 0
  buffer_load_dwordx4 v2, s[12:15], s32 offen sc1 lds
  buffer_load_dwordx4 v2, s[12:15], s32 offen offset:1024 sc1 lds
  s_add_u32 s32, s32, 2048
  s_add_u32 s33, s33, 16384
  s_cmp_ge_u32 s33, 147456
  s_cselect_b32 s33, 0, s33
  s_sub_u32 s36, s36, 1
  s_cmp_eq_u32 s36, 0
  s_cselect_b32 s14, 0, s14
  s_add_u32 s34, s33, s35
  s_mov_b32 m0, s34
  s_nop 0
  buffer_load_dwordx4 v2, s[12:15], s32 offen sc1 lds
  buffer_load_dwordx4 v2, s[12:15], s32 offen offset:1024 sc1 lds
  s_add_u32 s32, s32, 2048
  s_add_u32 s33, s33, 16384
  s_cmp_ge_u32 s33, 147456
  s_cselect_b32 s33, 0, s33
  s_sub_u32 s36, s36, 1
  s_cmp_eq_u32 s36, 0
  s_cselect_b32 s14, 0, s14
  s_add_u32 s34, s33, s35
  s_mov_b32 m0, s34
  s_nop 0
  buffer_load_dwordx4 v2, s[12:15], s32 offen sc1 lds
  buffer_load_dwordx4 v2, s[12:15], s32 offen offset:1024 sc1 lds
  s_add_u32 s32, s32, 2048
  s_add_u32 s33, s33, 16384
  s_cmp_ge_u32 s33, 147456
  s_cselect_b32 s33, 0, s33
  s_sub_u32 s36, s36, 1
  s_cmp_eq_u32 s36, 0
  s_cselect_b32 s14, 0, s14
  s_add_u32 s34, s33, s35
  s_mov_b32 m0, s34
  s_nop 0
  buffer_load_dwordx4 v2, s[12:15], s32 offen sc1 lds
  buffer_load_dwordx4 v2, s[12:15], s32 offen offset:1024 sc1 lds
  s_add_u32 s32, s32, 2048
  s_add_u32 s33, s33, 16384
  s_cmp_ge_u32 s33, 147456
  s_cselect_b32 s33, 0, s33
  s_sub_u32 s36, s36, 1
  s_cmp_eq_u32 s36, 0
  s_cselect_b32 s14, 0, s14
  s_add_u32 s34, s33, s35
  s_mov_b32 m0, s34
  s_nop 0
  buffer_load_dwordx4 v2, s[12:15], s32 offen sc1 lds
  buffer_load_dwordx4 v2, s[12:15], s32 offen offset:1024 sc1 lds
  s_add_u32 s32, s32, 2048
  s_add_u32 s33, s33, 16384
  s_cmp_ge_u32 s33, 147456
  s_cselect_b32 s33, 0, s33
  s_sub_u32 s36, s36, 1
  s_cmp_eq_u32 s36, 0
  s_cselect_b32 s14, 0, s14
  s_add_u32 s34, s33, s35
  s_mov_b32 m0, s34
  s_nop 0
  buffer_load_dwordx4 v2, s[12:15], s32 offen sc1 lds
  buffer_load_dwordx4 v2, s[12:15], s32 offen offset:1024 sc1 lds
  s_add_u32 s32, s32, 2048
  s_add_u32 s33, s33, 16384
  s_cmp_ge_u32 s33, 147456
  s_cselect_b32 s33, 0, s33
  s_sub_u32 s36, s36, 1
  s_cmp_eq_u32 s36, 0
  s_cselect_b32 s14, 0, s14
  s_add_u32 s34, s33, s35
  s_mov_b32 m0, s34
  s_nop 0
  buffer_load_dwordx4 v2, s[12:15], s32 offen sc1 lds
  buffer_load_dwordx4 v2, s[12:15], s32 offen offset:1024 sc1 lds
  s_add_u32 s32, s32, 2048
  s_add_u32 s33, s33, 16384
  s_cmp_ge_u32 s33, 147456
  s_cselect_b32 s33, 0, s33
  s_sub_u32 s36, s36, 1
  s_cmp_eq_u32 s36, 0
  s_cselect_b32 s14, 0, s14
  s_waitcnt vmcnt(14)
  s_barrier
  s_waitcnt vmcnt(12)
  s_barrier
  s_add_u32 s34, s33, s31
  s_mov_b32 m0, s34
  s_nop 0
  buffer_load_dwordx4 v2, s[12:15], s30 offen lds
  buffer_load_dwordx4 v2, s[12:15], s30 offen offset:1024 lds
  s_add_u32 s30, s30, 8192
  s_add_u32 s34, s33, s35
  s_mov_b32 m0, s34
  s_nop 0
  buffer_load_dwordx4 v2, s[12:15], s32 offen sc1 lds
  buffer_load_dwordx4 v2, s[12:15], s32 offen offset:1024 sc1 lds
  s_add_u32 s32, s32, 2048
  s_add_u32 s33, s33, 16384
  s_cmp_ge_u32 s33, 147456
  s_cselect_b32 s33, 0, s33
  s_sub_u32 s36, s36, 1
  s_cmp_eq_u32 s36, 0
  s_cselect_b32 s14, 0, s14
  s_waitcnt vmcnt(14)
  s_barrier
  s_add_u32 s34, s33, s31
  s_mov_b32 m0, s34
  s_nop 0
  buffer_load_dwordx4 v2, s[12:15], s30 offen lds
  buffer_load_dwordx4 v2, s[12:15], s30 offen offset:1024 lds
  s_add_u32 s30, s30, 8192
  s_add_u32 s34, s33, s35
  s_mov_b32 m0, s34
  s_nop 0
  buffer_load_dwordx4 v2, s[12:15], s32 offen sc1 lds
  buffer_load_dwordx4 v2, s[12:15], s32 offen offset:1024 sc1 lds
  s_add_u32 s32, s32, 2048
  s_add_u32 s33, s33, 16384
  s_cmp_ge_u32 s33, 147456
  s_cselect_b32 s33, 0, s33
  s_sub_u32 s36, s36, 1
  s_cmp_eq_u32 s36, 0
  s_cselect_b32 s14, 0, s14
  s_waitcnt vmcnt(16)
  s_barrier
  s_add_u32 s34, s33, s31
  s_mov_b32 m0, s34
  s_nop 0
  buffer_load_dwordx4 v2, s[12:15], s30 offen lds
  buffer_load_dwordx4 v2, s[12:15], s30 offen offset:1024 lds
  s_add_u32 s30, s30, 8192
  s_add_u32 s34, s33, s35
  s_mov_b32 m0, s34
  s_nop 0
  buffer_load_dwordx4 v2, s[12:15], s32 offen sc1 lds
  buffer_load_dwordx4 v2, s[12:15], s32 offen offset:1024 sc1 lds
  s_add_u32 s32, s32, 2048
  s_add_u32 s33, s33, 16384
  s_cmp_ge_u32 s33, 147456
  s_cselect_b32 s33, 0, s33
  s_sub_u32 s36, s36, 1
  s_cmp_eq_u32 s36, 0
  s_cselect_b32 s14, 0, s14
  s_waitcnt vmcnt(18)
  s_barrier
  s_add_u32 s34, s33, s31
  s_mov_b32 m0, s34
  s_nop 0
  buffer_load_dwordx4 v2, s[12:15], s30 offen lds
  buffer_load_dwordx4 v2, s[12:15], s30 offen offset:1024 lds
  s_add_u32 s30, s30, 8192
  s_add_u32 s34, s33, s35
  s_mov_b32 m0, s34
  s_nop 0
  buffer_load_dwordx4 v2, s[12:15], s32 offen sc1 lds
  buffer_load_dwordx4 v2, s[12:15], s32 offen offset:1024 sc1 lds
  s_add_u32 s32, s32, 2048
  s_add_u32 s33, s33, 16384
  s_cmp_ge_u32 s33, 147456
  s_cselect_b32 s33, 0, s33
  s_sub_u32 s36, s36, 1
  s_cmp_eq_u32 s36, 0
  s_cselect_b32 s14, 0, s14
  s_waitcnt vmcnt(20)
  s_barrier
  s_add_u32 s34, s33, s31
  s_mov_b32 m0, s34
  s_nop 0
  buffer_load_dwordx4 v2, s[12:15], s30 offen lds
  buffer_load_dwordx4 v2, s[12:15], s30 offen offset:1024 lds
  s_add_u32 s30, s30, 8192
  s_add_u32 s34, s33, s35
  s_mov_b32 m0, s34
  s_nop 0
  buffer_load_dwordx4 v2, s[12:15], s32 offen sc1 lds
  buffer_load_dwordx4 v2, s[12:15], s32 offen offset:1024 sc1 lds
  s_add_u32 s32, s32, 2048
  s_add_u32 s33, s33, 16384
  s_cmp_ge_u32 s33, 147456
  s_cselect_b32 s33, 0, s33
  s_sub_u32 s36, s36, 1
  s_cmp_eq_u32 s36, 0
  s_cselect_b32 s14, 0, s14
  s_waitcnt vmcnt(22)
  s_barrier
  s_add_u32 s34, s33, s31
  s_mov_b32 m0, s34
  s_nop 0
  buffer_load_dwordx4 v2, s[12:15], s30 offen lds
  buffer_load_dwordx4 v2, s[12:15], s30 offen offset:1024 lds
  s_add_u32 s30, s30, 8192
  s_add_u32 s34, s33, s35
  s_mov_b32 m0, s34
  s_nop 0
  buffer_load_dwordx4 v2, s[12:15], s32 offen sc1 lds
  buffer_load_dwordx4 v2, s[12:15], s32 offen offset:1024 sc1 lds
  s_add_u32 s32, s32, 2048
  s_add_u32 s33, s33, 16384
  s_cmp_ge_u32 s33, 147456
  s_cselect_b32 s33, 0, s33
  s_sub_u32 s36, s36, 1
  s_cmp_eq_u32 s36, 0
  s_cselect_b32 s14, 0, s14
  s_waitcnt vmcnt(24)
  s_barrier
  s_add_u32 s34, s33, s31
  s_mov_b32 m0, s34
  s_nop 0
  buffer_load_dwordx4 v2, s[12:15], s30 offen lds
  buffer_load_dwordx4 v2, s[12:15], s30 offen offset:1024 lds
  s_add_u32 s30, s30, 8192
  s_add_u32 s34, s33, s35
  s_mov_b32 m0, s34
  s_nop 0
  buffer_load_dwordx4 v2, s[12:15], s32 offen sc1 lds
  buffer_load_dwordx4 v2, s[12:15], s32 offen offset:1024 sc1 lds
  s_add_u32 s32, s32, 2048
  s_add_u32 s33, s33, 16384
  s_cmp_ge_u32 s33, 147456
  s_cselect_b32 s33, 0, s33
  s_sub_u32 s36, s36, 1
  s_cmp_eq_u32 s36, 0
  s_cselect_b32 s14, 0, s14
  s_sub_u32 s28, s28, 7
LL_chain1_k_123:
  s_waitcnt vmcnt(24)
  s_barrier
  s_add_u32 s34, s33, s31
  s_mov_b32 m0, s34
  s_nop 0
  buffer_load_dwordx4 v2, s[12:15], s30 offen lds
  buffer_load_dwordx4 v2, s[12:15], s30 offen offset:1024 lds
  s_add_u32 s30, s30, 8192
  s_add_u32 s34, s33, s35
  s_mov_b32 m0, s34
  s_nop 0
  buffer_load_dwordx4 v2, s[12:15], s32 offen sc1 lds
  buffer_load_dwordx4 v2, s[12:15], s32 offen offset:1024 sc1 lds
  s_add_u32 s32, s32, 2048
  s_add_u32 s33, s33, 16384
  s_cmp_ge_u32 s33, 147456
  s_cselect_b32 s33, 0, s33
  s_sub_u32 s36, s36, 1
  s_cmp_eq_u32 s36, 0
  s_cselect_b32 s14, 0, s14
  s_sub_u32 s28, s28, 1
  s_cmp_lg_u32 s28, 0
  s_cbranch_scc1 LL_chain1_k_123
  s_endpgm
SK_chain1_k_122:
  s_barrier
  s_setprio 1
  s_cmp_ge_u32 s24, 9
  s_cbranch_scc1 EL_chain1_k_124
  s_mul_i32 s35, s20, 2048
  s_add_u32 s35, s35, 8192
  s_mov_b32 s40, 0
  v_mov_b32 v16, 0
  v_mov_b32 v17, 0
  v_mov_b32 v18, 0
  v_mov_b32 v19, 0
  v_mov_b32 v20, 0
  v_mov_b32 v21, 0
  v_mov_b32 v22, 0
  v_mov_b32 v23, 0
  v_mov_b32 v24, 0
  v_mov_b32 v25, 0
  v_mov_b32 v26, 0
  v_mov_b32 v27, 0
  v_mov_b32 v28, 0
  v_mov_b32 v29, 0
  v_mov_b32 v30, 0
  v_mov_b32 v31, 0
  v_mov_b32 v32, 0
  v_mov_b32 v33, 0
  v_mov_b32 v34, 0
  v_mov_b32 v35, 0
  v_mov_b32 v36, 0
  v_mov_b32 v37, 0
  v_mov_b32 v38, 0
  v_mov_b32 v39, 0
  v_mov_b32 v40, 0
  v_mov_b32 v41, 0
  v_mov_b32 v42, 0
  v_mov_b32 v43, 0
  v_mov_b32 v44, 0
  v_mov_b32 v45, 0
  v_mov_b32 v46, 0
  v_mov_b32 v47, 0
  v_mov_b32 v48, 0
  v_mov_b32 v49, 0
  v_mov_b32 v50, 0
  v_mov_b32 v51, 0
  v_mov_b32 v52, 0
  v_mov_b32 v53, 0
  v_mov_b32 v54, 0
  v_mov_b32 v55, 0
  v_mov_b32 v56, 0
  v_mov_b32 v57, 0
  v_mov_b32 v58, 0
  v_mov_b32 v59, 0
  v_mov_b32 v60, 0
  v_mov_b32 v61, 0
  v_mov_b32 v62, 0
  v_mov_b32 v63, 0
  v_mov_b32 v64, 0
  v_mov_b32 v65, 0
  v_mov_b32 v66, 0
  v_mov_b32 v67, 0
  v_mov_b32 v68, 0
  v_mov_b32 v69, 0
  v_mov_b32 v70, 0
  v_mov_b32 v71, 0
  v_mov_b32 v72, 0
  v_mov_b32 v73, 0
  v_mov_b32 v74, 0
  v_mov_b32 v75, 0
  v_mov_b32 v76, 0
  v_mov_b32 v77, 0
  v_mov_b32 v78, 0
  v_mov_b32 v79, 0
  v_mov_b32 v3, v2
  v_add_u32 v4, s35, v2
  s_barrier
  ds_read_b128 v[96:99], v4 offset:0
  ds_read_b128 v[80:83], v3 offset:0
  ds_read_b128 v[84:87], v3 offset:1024
  ds_read_b128 v[88:91], v3 offset:2048
  ds_read_b128 v[92:95], v3 offset:3072
LC_chain1_k_126:
  s_waitcnt lgkmcnt(3)
  v_mfma_f32_32x32x16_bf16 v[16:31], v[80:83], v[96:99], v[16:31]
  ds_read_b128 v[116:119], v4 offset:1024
  ds_read_b128 v[100:103], v3 offset:4096
  s_add_u32 s40, s40, 16384
  s_cmp_ge_u32 s40, 147456
  s_cselect_b32 s40, 0, s40
  s_add_u32 s42, s40, s35
  s_waitcnt lgkmcnt(4)
  v_mfma_f32_32x32x16_bf16 v[32:47], v[84:87], v[96:99], v[32:47]
  ds_read_b128 v[104:107], v3 offset:5120
  v_add_u32 v12, s40, v2
  v_add_u32 v13, s42, v2
  s_waitcnt lgkmcnt(4)
  v_mfma_f32_32x32x16_bf16 v[48:63], v[88:91], v[96:99], v[48:63]
  ds_read_b128 v[108:111], v3 offset:6144
  s_barrier
  s_waitcnt lgkmcnt(4)
  v_mfma_f32_32x32x16_bf16 v[64:79], v[92:95], v[96:99], v[64:79]
  ds_read_b128 v[112:115], v3 offset:7168
  s_waitcnt lgkmcnt(3)
  v_mfma_f32_32x32x16_bf16 v[16:31], v[100:103], v[116:119], v[16:31]
  ds_read_b128 v[96:99], v13 offset:0
  ds_read_b128 v[80:83], v12 offset:0
  s_waitcnt lgkmcnt(4)
  v_mfma_f32_32x32x16_bf16 v[32:47], v[104:107], v[116:119], v[32:47]
  ds_read_b128 v[84:87], v12 offset:1024
  v_mov_b32 v3, v12
  v_mov_b32 v4, v13
  s_waitcnt lgkmcnt(4)
  v_mfma_f32_32x32x16_bf16 v[48:63], v[108:111], v[116:119], v[48:63]
  ds_read_b128 v[88:91], v12 offset:2048
  s_waitcnt lgkmcnt(4)
  v_mfma_f32_32x32x16_bf16 v[64:79], v[112:115], v[116:119], v[64:79]
  ds_read_b128 v[92:95], v12 offset:3072
  s_sub_u32 s28, s28, 1
  s_cmp_lg_u32 s28, 0
  s_cbranch_scc1 LC_chain1_k_126
  s_branch EN_chain1_k_125
EL_chain1_k_124:
  s_mul_i32 s35, s20, 2048
  s_add_u32 s35, s35, 8192
  s_mov_b32 s40, 0
  v_mov_b32 v16, 0
  v_mov_b32 v17, 0
  v_mov_b32 v18, 0
  v_mov_b32 v19, 0
  v_mov_b32 v20, 0
  v_mov_b32 v21, 0
  v_mov_b32 v22, 0
  v_mov_b32 v23, 0
  v_mov_b32 v24, 0
  v_mov_b32 v25, 0
  v_mov_b32 v26, 0
  v_mov_b32 v27, 0
  v_mov_b32 v28, 0
  v_mov_b32 v29, 0
  v_mov_b32 v30, 0
  v_mov_b32 v31, 0
  v_mov_b32 v32, 0
  v_mov_b32 v33, 0
  v_mov_b32 v34, 0
  v_mov_b32 v35, 0
  v_mov_b32 v36, 0
  v_mov_b32 v37, 0
  v_mov_b32 v38, 0
  v_mov_b32 v39, 0
  v_mov_b32 v40, 0
  v_mov_b32 v41, 0
  v_mov_b32 v42, 0
  v_mov_b32 v43, 0
  v_mov_b32 v44, 0
  v_mov_b32 v45, 0
  v_mov_b32 v46, 0
  v_mov_b32 v47, 0
  v_mov_b32 v48, 0
  v_mov_b32 v49, 0
  v_mov_b32 v50, 0
  v_mov_b32 v51, 0
  v_mov_b32 v52, 0
  v_mov_b32 v53, 0
  v_mov_b32 v54, 0
  v_mov_b32 v55, 0
  v_mov_b32 v56, 0
  v_mov_b32 v57, 0
  v_mov_b32 v58, 0
  v_mov_b32 v59, 0
  v_mov_b32 v60, 0
  v_mov_b32 v61, 0
  v_mov_b32 v62, 0
  v_mov_b32 v63, 0
  v_mov_b32 v64, 0
  v_mov_b32 v65, 0
  v_mov_b32 v66, 0
  v_mov_b32 v67, 0
  v_mov_b32 v68, 0
  v_mov_b32 v69, 0
  v_mov_b32 v70, 0
  v_mov_b32 v71, 0
  v_mov_b32 v72, 0
  v_mov_b32 v73, 0
  v_mov_b32 v74, 0
  v_mov_b32 v75, 0
  v_mov_b32 v76, 0
  v_mov_b32 v77, 0
  v_mov_b32 v78, 0
  v_mov_b32 v79, 0
  v_mov_b32 v3, v2
  v_add_u32 v4, s35, v2
  s_barrier
  ds_read_b128 v[96:99], v4 offset:0
  ds_read_b128 v[80:83], v3 offset:0
  ds_read_b128 v[84:87], v3 offset:1024
  ds_read_b128 v[88:91], v3 offset:2048
  ds_read_b128 v[92:95], v3 offset:3072
LC_chain1_k_127:
  s_waitcnt lgkmcnt(3)
  v_mfma_f32_32x32x16_bf16 v[16:31], v[96:99], v[80:83], v[16:31]
  ds_read_b128 v[116:119], v4 offset:1024
  ds_read_b128 v[100:103], v3 offset:4096
  s_add_u32 s40, s40, 16384
  s_cmp_ge_u32 s40, 147456
  s_cselect_b32 s40, 0, s40
  s_add_u32 s42, s40, s35
  s_waitcnt lgkmcnt(4)
  v_mfma_f32_32x32x16_bf16 v[32:47], v[96:99], v[84:87], v[32:47]
  ds_read_b128 v[104:107], v3 offset:5120
  v_add_u32 v12, s40, v2
  v_add_u32 v13, s42, v2
  s_waitcnt lgkmcnt(4)
  v_mfma_f32_32x32x16_bf16 v[48:63], v[96:99], v[88:91], v[48:63]
  ds_read_b128 v[108:111], v3 offset:6144
  s_barrier
  s_waitcnt lgkmcnt(4)
  v_mfma_f32_32x32x16_bf16 v[64:79], v[96:99], v[92:95], v[64:79]
  ds_read_b128 v[112:115], v3 offset:7168
  s_waitcnt lgkmcnt(3)
  v_mfma_f32_32x32x16_bf16 v[16:31], v[116:119], v[100:103], v[16:31]
  ds_read_b128 v[96:99], v13 offset:0
  ds_read_b128 v[80:83], v12 offset:0
  s_waitcnt lgkmcnt(4)
  v_mfma_f32_32x32x16_bf16 v[32:47], v[116:119], v[104:107], v[32:47]
  ds_read_b128 v[84:87], v12 offset:1024
  v_mov_b32 v3, v12
  v_mov_b32 v4, v13
  s_waitcnt lgkmcnt(4)
  v_mfma_f32_32x32x16_bf16 v[48:63], v[116:119], v[108:111], v[48:63]
  ds_read_b128 v[88:91], v12 offset:2048
  s_waitcnt lgkmcnt(4)
  v_mfma_f32_32x32x16_bf16 v[64:79], v[116:119], v[112:115], v[64:79]
  ds_read_b128 v[92:95], v12 offset:3072
  s_sub_u32 s28, s28, 1
  s_cmp_lg_u32 s28, 0
  s_cbranch_scc1 LC_chain1_k_127
EN_chain1_k_125:
  s_lshr_b32 s32, s25, 3
  s_and_b32 s33, s25, 7
  s_mul_i32 s34, s32, 19456
  s_add_u32 s34, s34, 20754432
  s_mov_b32 s35, 0x3eae1a93
  s_cmp_lt_u32 s24, 4
  s_cbranch_scc1 SW_chain1_k_129
  s_cmp_lt_u32 s24, 8
  s_cbranch_scc1 SW_chain1_k_130
  s_cmp_lt_u32 s24, 9
  s_cbranch_scc1 SW_chain1_k_131
  s_branch SW_chain1_k_132
SW_chain1_k_129:
  s_lshl_b32 s36, s24, 3
  s_lshl_b32 s36, s36, 16
  s_lshl_b32 s37, s25, 10
  s_add_u32 s36, s36, s37
  s_add_u32 s36, s36, 18395136
  v_mul_f32 v16, s35, v16
  v_mul_f32 v17, s35, v17
  v_cvt_pk_bf16_f32 v120, v16, v17
  v_mul_f32 v18, s35, v18
  v_mul_f32 v19, s35, v19
  v_cvt_pk_bf16_f32 v121, v18, v19
  v_mul_f32 v20, s35, v20
  v_mul_f32 v21, s35, v21
  v_cvt_pk_bf16_f32 v122, v20, v21
  v_mul_f32 v22, s35, v22
  v_mul_f32 v23, s35, v23
  v_cvt_pk_bf16_f32 v123, v22, v23
  v_mul_f32 v24, s35, v24
  v_mul_f32 v25, s35, v25
  v_cvt_pk_bf16_f32 v124, v24, v25
  v_mul_f32 v26, s35, v26
  v_mul_f32 v27, s35, v27
  v_cvt_pk_bf16_f32 v125, v26, v27
  v_mul_f32 v28, s35, v28
  v_mul_f32 v29, s35, v29
  v_cvt_pk_bf16_f32 v126, v28, v29
  v_mul_f32 v30, s35, v30
  v_mul_f32 v31, s35, v31
  v_cvt_pk_bf16_f32 v127, v30, v31
  buffer_store_dwordx4 v[120:123], v2, s[8:11], s36 offen sc1
  s_add_u32 s36, s36, 65536
  buffer_store_dwordx4 v[124:127], v2, s[8:11], s36 offen sc1
  s_add_u32 s36, s36, 65536
  v_mul_f32 v32, s35, v32
  v_mul_f32 v33, s35, v33
  v_cvt_pk_bf16_f32 v128, v32, v33
  v_mul_f32 v34, s35, v34
  v_mul_f32 v35, s35, v35
  v_cvt_pk_bf16_f32 v129, v34, v35
  v_mul_f32 v36, s35, v36
  v_mul_f32 v37, s35, v37
  v_cvt_pk_bf16_f32 v130, v36, v37
  v_mul_f32 v38, s35, v38
  v_mul_f32 v39, s35, v39
  v_cvt_pk_bf16_f32 v131, v38, v39
  v_mul_f32 v40, s35, v40
  v_mul_f32 v41, s35, v41
  v_cvt_pk_bf16_f32 v132, v40, v41
  v_mul_f32 v42, s35, v42
  v_mul_f32 v43, s35, v43
  v_cvt_pk_bf16_f32 v133, v42, v43
  v_mul_f32 v44, s35, v44
  v_mul_f32 v45, s35, v45
  v_cvt_pk_bf16_f32 v134, v44, v45
  v_mul_f32 v46, s35, v46
  v_mul_f32 v47, s35, v47
  v_cvt_pk_bf16_f32 v135, v46, v47
  buffer_store_dwordx4 v[128:131], v2, s[8:11], s36 offen sc1
  s_add_u32 s36, s36, 65536
  buffer_store_dwordx4 v[132:135], v2, s[8:11], s36 offen sc1
  s_add_u32 s36, s36, 65536
  v_mul_f32 v48, s35, v48
  v_mul_f32 v49, s35, v49
  v_cvt_pk_bf16_f32 v136, v48, v49
  v_mul_f32 v50, s35, v50
  v_mul_f32 v51, s35, v51
  v_cvt_pk_bf16_f32 v137, v50, v51
  v_mul_f32 v52, s35, v52
  v_mul_f32 v53, s35, v53
  v_cvt_pk_bf16_f32 v138, v52, v53
  v_mul_f32 v54, s35, v54
  v_mul_f32 v55, s35, v55
  v_cvt_pk_bf16_f32 v139, v54, v55
  v_mul_f32 v56, s35, v56
  v_mul_f32 v57, s35, v57
  v_cvt_pk_bf16_f32 v140, v56, v57
  v_mul_f32 v58, s35, v58
  v_mul_f32 v59, s35, v59
  v_cvt_pk_bf16_f32 v141, v58, v59
  v_mul_f32 v60, s35, v60
  v_mul_f32 v61, s35, v61
  v_cvt_pk_bf16_f32 v142, v60, v61
  v_mul_f32 v62, s35, v62
  v_mul_f32 v63, s35, v63
  v_cvt_pk_bf16_f32 v143, v62, v63
  buffer_store_dwordx4 v[136:139], v2, s[8:11], s36 offen sc1
  s_add_u32 s36, s36, 65536
  buffer_store_dwordx4 v[140:143], v2, s[8:11], s36 offen sc1
  s_add_u32 s36, s36, 65536
  v_mul_f32 v64, s35, v64
  v_mul_f32 v65, s35, v65
  v_cvt_pk_bf16_f32 v144, v64, v65
  v_mul_f32 v66, s35, v66
  v_mul_f32 v67, s35, v67
  v_cvt_pk_bf16_f32 v145, v66, v67
  v_mul_f32 v68, s35, v68
  v_mul_f32 v69, s35, v69
  v_cvt_pk_bf16_f32 v146, v68, v69
  v_mul_f32 v70, s35, v70
  v_mul_f32 v71, s35, v71
  v_cvt_pk_bf16_f32 v147, v70, v71
  v_mul_f32 v72, s35, v72
  v_mul_f32 v73, s35, v73
  v_cvt_pk_bf16_f32 v148, v72, v73
  v_mul_f32 v74, s35, v74
  v_mul_f32 v75, s35, v75
  v_cvt_pk_bf16_f32 v149, v74, v75
  v_mul_f32 v76, s35, v76
  v_mul_f32 v77, s35, v77
  v_cvt_pk_bf16_f32 v150, v76, v77
  v_mul_f32 v78, s35, v78
  v_mul_f32 v79, s35, v79
  v_cvt_pk_bf16_f32 v151, v78, v79
  buffer_store_dwordx4 v[144:147], v2, s[8:11], s36 offen sc1
  s_add_u32 s36, s36, 65536
  buffer_store_dwordx4 v[148:151], v2, s[8:11], s36 offen sc1
  s_add_u32 s36, s36, 65536
  s_branch SWE_chain1_k_128
SW_chain1_k_130:
  s_sub_u32 s36, s24, 4
  s_mul_i32 s36, s36, 1245184
  s_add_u32 s36, s36, s34
  s_lshl_b32 s37, s33, 10
  s_add_u32 s36, s36, s37
  v_cvt_pk_bf16_f32 v120, v16, v17
  v_cvt_pk_bf16_f32 v121, v18, v19
  v_cvt_pk_bf16_f32 v122, v20, v21
  v_cvt_pk_bf16_f32 v123, v22, v23
  v_cvt_pk_bf16_f32 v124, v24, v25
  v_cvt_pk_bf16_f32 v125, v26, v27
  v_cvt_pk_bf16_f32 v126, v28, v29
  v_cvt_pk_bf16_f32 v127, v30, v31
  buffer_store_dwordx4 v[120:123], v2, s[8:11], s36 offen sc1
  s_add_u32 s36, s36, 155648
  buffer_store_dwordx4 v[124:127], v2, s[8:11], s36 offen sc1
  s_add_u32 s36, s36, 155648
  v_cvt_pk_bf16_f32 v128, v32, v33
  v_cvt_pk_bf16_f32 v129, v34, v35
  v_cvt_pk_bf16_f32 v130, v36, v37
  v_cvt_pk_bf16_f32 v131, v38, v39
  v_cvt_pk_bf16_f32 v132, v40, v41
  v_cvt_pk_bf16_f32 v133, v42, v43
  v_cvt_pk_bf16_f32 v134, v44, v45
  v_cvt_pk_bf16_f32 v135, v46, v47
  buffer_store_dwordx4 v[128:131], v2, s[8:11], s36 offen sc1
  s_add_u32 s36, s36, 155648
  buffer_store_dwordx4 v[132:135], v2, s[8:11], s36 offen sc1
  s_add_u32 s36, s36, 155648
  v_cvt_pk_bf16_f32 v136, v48, v49
  v_cvt_pk_bf16_f32 v137, v50, v51
  v_cvt_pk_bf16_f32 v138, v52, v53
  v_cvt_pk_bf16_f32 v139, v54, v55
  v_cvt_pk_bf16_f32 v140, v56, v57
  v_cvt_pk_bf16_f32 v141, v58, v59
  v_cvt_pk_bf16_f32 v142, v60, v61
  v_cvt_pk_bf16_f32 v143, v62, v63
  buffer_store_dwordx4 v[136:139], v2, s[8:11], s36 offen sc1
  s_add_u32 s36, s36, 155648
  buffer_store_dwordx4 v[140:143], v2, s[8:11], s36 offen sc1
  s_add_u32 s36, s36, 155648
  v_cvt_pk_bf16_f32 v144, v64, v65
  v_cvt_pk_bf16_f32 v145, v66, v67
  v_cvt_pk_bf16_f32 v146, v68, v69
  v_cvt_pk_bf16_f32 v147, v70, v71
  v_cvt_pk_bf16_f32 v148, v72, v73
  v_cvt_pk_bf16_f32 v149, v74, v75
  v_cvt_pk_bf16_f32 v150, v76, v77
  v_cvt_pk_bf16_f32 v151, v78, v79
  buffer_store_dwordx4 v[144:147], v2, s[8:11], s36 offen sc1
  s_add_u32 s36, s36, 155648
  buffer_store_dwordx4 v[148:151], v2, s[8:11], s36 offen sc1
  s_add_u32 s36, s36, 155648
  s_branch SWE_chain1_k_128
SW_chain1_k_131:
  v_lshlrev_b32 v8, 14, v5
  v_lshl_add_u32 v8, v6, 2, v8
  s_lshl_b32 s36, s25, 7
  s_add_u32 s36, s36, 20492288
  v_mul_f32 v16, s35, v16
  v_mul_f32 v17, s35, v17
  v_cvt_pk_bf16_f32 v120, v16, v17
  v_mul_f32 v18, s35, v18
  v_mul_f32 v19, s35, v19
  v_cvt_pk_bf16_f32 v121, v18, v19
  v_mul_f32 v20, s35, v20
  v_mul_f32 v21, s35, v21
  v_cvt_pk_bf16_f32 v122, v20, v21
  v_mul_f32 v22, s35, v22
  v_mul_f32 v23, s35, v23
  v_cvt_pk_bf16_f32 v123, v22, v23
  v_mul_f32 v24, s35, v24
  v_mul_f32 v25, s35, v25
  v_cvt_pk_bf16_f32 v124, v24, v25
  v_mul_f32 v26, s35, v26
  v_mul_f32 v27, s35, v27
  v_cvt_pk_bf16_f32 v125, v26, v27
  v_mul_f32 v28, s35, v28
  v_mul_f32 v29, s35, v29
  v_cvt_pk_bf16_f32 v126, v28, v29
  v_mul_f32 v30, s35, v30
  v_mul_f32 v31, s35, v31
  v_cvt_pk_bf16_f32 v127, v30, v31
  s_add_u32 s37, s36, 0
  buffer_store_dword v120, v8, s[8:11], s37 offen
  s_add_u32 s37, s36, 8192
  buffer_store_dword v121, v8, s[8:11], s37 offen
  s_add_u32 s37, s36, 32768
  buffer_store_dword v122, v8, s[8:11], s37 offen
  s_add_u32 s37, s36, 40960
  buffer_store_dword v123, v8, s[8:11], s37 offen
  s_add_u32 s37, s36, 65536
  buffer_store_dword v124, v8, s[8:11], s37 offen
  s_add_u32 s37, s36, 73728
  buffer_store_dword v125, v8, s[8:11], s37 offen
  s_add_u32 s37, s36, 98304
  buffer_store_dword v126, v8, s[8:11], s37 offen
  s_add_u32 s37, s36, 106496
  buffer_store_dword v127, v8, s[8:11], s37 offen
  v_mul_f32 v32, s35, v32
  v_mul_f32 v33, s35, v33
  v_cvt_pk_bf16_f32 v128, v32, v33
  v_mul_f32 v34, s35, v34
  v_mul_f32 v35, s35, v35
  v_cvt_pk_bf16_f32 v129, v34, v35
  v_mul_f32 v36, s35, v36
  v_mul_f32 v37, s35, v37
  v_cvt_pk_bf16_f32 v130, v36, v37
  v_mul_f32 v38, s35, v38
  v_mul_f32 v39, s35, v39
  v_cvt_pk_bf16_f32 v131, v38, v39
  v_mul_f32 v40, s35, v40
  v_mul_f32 v41, s35, v41
  v_cvt_pk_bf16_f32 v132, v40, v41
  v_mul_f32 v42, s35, v42
  v_mul_f32 v43, s35, v43
  v_cvt_pk_bf16_f32 v133, v42, v43
  v_mul_f32 v44, s35, v44
  v_mul_f32 v45, s35, v45
  v_cvt_pk_bf16_f32 v134, v44, v45
  v_mul_f32 v46, s35, v46
  v_mul_f32 v47, s35, v47
  v_cvt_pk_bf16_f32 v135, v46, v47
  s_add_u32 s37, s36, 131072
  buffer_store_dword v128, v8, s[8:11], s37 offen
  s_add_u32 s37, s36, 139264
  buffer_store_dword v129, v8, s[8:11], s37 offen
  s_add_u32 s37, s36, 163840
  buffer_store_dword v130, v8, s[8:11], s37 offen
  s_add_u32 s37, s36, 172032
  buffer_store_dword v131, v8, s[8:11], s37 offen
  s_add_u32 s37, s36, 196608
  buffer_store_dword v132, v8, s[8:11], s37 offen
  s_add_u32 s37, s36, 204800
  buffer_store_dword v133, v8, s[8:11], s37 offen
  s_add_u32 s37, s36, 229376
  buffer_store_dword v134, v8, s[8:11], s37 offen
  s_add_u32 s37, s36, 237568
  buffer_store_dword v135, v8, s[8:11], s37 offen
  v_mul_u32_u24 v7, 311296, v5
  v_lshl_add_u32 v7, v6, 2, v7
  s_lshl_b32 s36, s33, 7
  s_add_u32 s36, s36, s34
  s_add_u32 s36, s36, 8192
  v_cvt_pk_bf16_f32 v136, v48, v49
  v_cvt_pk_bf16_f32 v137, v50, v51
  v_cvt_pk_bf16_f32 v138, v52, v53
  v_cvt_pk_bf16_f32 v139, v54, v55
  v_cvt_pk_bf16_f32 v140, v56, v57
  v_cvt_pk_bf16_f32 v141, v58, v59
  v_cvt_pk_bf16_f32 v142, v60, v61
  v_cvt_pk_bf16_f32 v143, v62, v63
  s_add_u32 s37, s36, 0
  buffer_store_dword v136, v7, s[8:11], s37 offen
  s_add_u32 s37, s36, 155648
  buffer_store_dword v137, v7, s[8:11], s37 offen
  s_add_u32 s37, s36, 622592
  buffer_store_dword v138, v7, s[8:11], s37 offen
  s_add_u32 s37, s36, 778240
  buffer_store_dword v139, v7, s[8:11], s37 offen
  s_add_u32 s37, s36, 1245184
  buffer_store_dword v140, v7, s[8:11], s37 offen
  s_add_u32 s37, s36, 1400832
  buffer_store_dword v141, v7, s[8:11], s37 offen
  s_add_u32 s37, s36, 1867776
  buffer_store_dword v142, v7, s[8:11], s37 offen
  s_add_u32 s37, s36, 2023424
  buffer_store_dword v143, v7, s[8:11], s37 offen
  v_cvt_pk_bf16_f32 v144, v64, v65
  v_cvt_pk_bf16_f32 v145, v66, v67
  v_cvt_pk_bf16_f32 v146, v68, v69
  v_cvt_pk_bf16_f32 v147, v70, v71
  v_cvt_pk_bf16_f32 v148, v72, v73
  v_cvt_pk_bf16_f32 v149, v74, v75
  v_cvt_pk_bf16_f32 v150, v76, v77
  v_cvt_pk_bf16_f32 v151, v78, v79
  s_add_u32 s37, s36, 2490368
  buffer_store_dword v144, v7, s[8:11], s37 offen
  s_add_u32 s37, s36, 2646016
  buffer_store_dword v145, v7, s[8:11], s37 offen
  s_add_u32 s37, s36, 3112960
  buffer_store_dword v146, v7, s[8:11], s37 offen
  s_add_u32 s37, s36, 3268608
  buffer_store_dword v147, v7, s[8:11], s37 offen
  s_add_u32 s37, s36, 3735552
  buffer_store_dword v148, v7, s[8:11], s37 offen
  s_add_u32 s37, s36, 3891200
  buffer_store_dword v149, v7, s[8:11], s37 offen
  s_add_u32 s37, s36, 4358144
  buffer_store_dword v150, v7, s[8:11], s37 offen
  s_add_u32 s37, s36, 4513792
  buffer_store_dword v151, v7, s[8:11], s37 offen
  s_branch SWE_chain1_k_128
SW_chain1_k_132:
  s_mul_i32 s36, s33, 1280
  s_add_u32 s36, s36, s34
  s_add_u32 s36, s36, 9216
  s_sub_u32 s37, s24, 9
  s_lshl_b32 s37, s37, 7
  v_mul_u32_u24 v9, 320, v5
  v_add_u32 v7, s37, v6
  v_mul_u32_u24 v8, 3641, v7
  v_lshrrev_b32 v8, 16, v8
  v_mul_u32_u24 v10, 18, v8
  v_sub_u32 v7, v7, v10
  v_mul_u32_u24 v8, 155648, v8
  v_lshl_add_u32 v8, v7, 4, v8
  v_add_u32 v8, v8, v9
  v_cvt_pk_bf16_f32 v120, v16, v17
  v_cvt_pk_bf16_f32 v121, v18, v19
  v_cvt_pk_bf16_f32 v122, v20, v21
  v_cvt_pk_bf16_f32 v123, v22, v23
  v_cvt_pk_bf16_f32 v124, v24, v25
  v_cvt_pk_bf16_f32 v125, v26, v27
  v_cvt_pk_bf16_f32 v126, v28, v29
  v_cvt_pk_bf16_f32 v127, v30, v31
  buffer_store_dwordx4 v[120:123], v8, s[8:11], s36 offen sc1
  buffer_store_dwordx4 v[124:127], v8, s[8:11], s36 offen offset:640 sc1
  v_add_u32 v7, s37, v6
  v_add_u32 v7, 32, v7
  v_mul_u32_u24 v8, 3641, v7
  v_lshrrev_b32 v8, 16, v8
  v_mul_u32_u24 v10, 18, v8
  v_sub_u32 v7, v7, v10
  v_mul_u32_u24 v8, 155648, v8
  v_lshl_add_u32 v8, v7, 4, v8
  v_add_u32 v8, v8, v9
  v_cvt_pk_bf16_f32 v128, v32, v33
  v_cvt_pk_bf16_f32 v129, v34, v35
  v_cvt_pk_bf16_f32 v130, v36, v37
  v_cvt_pk_bf16_f32 v131, v38, v39
  v_cvt_pk_bf16_f32 v132, v40, v41
  v_cvt_pk_bf16_f32 v133, v42, v43
  v_cvt_pk_bf16_f32 v134, v44, v45
  v_cvt_pk_bf16_f32 v135, v46, v47
  buffer_store_dwordx4 v[128:131], v8, s[8:11], s36 offen sc1
  buffer_store_dwordx4 v[132:135], v8, s[8:11], s36 offen offset:640 sc1
  s_cmp_eq_u32 s24, 13
  s_cbranch_scc1 QE_chain1_k_119
  v_add_u32 v7, s37, v6
  v_add_u32 v7, 64, v7
  v_mul_u32_u24 v8, 3641, v7
  v_lshrrev_b32 v8, 16, v8
  v_mul_u32_u24 v10, 18, v8
  v_sub_u32 v7, v7, v10
  v_mul_u32_u24 v8, 155648, v8
  v_lshl_add_u32 v8, v7, 4, v8
  v_add_u32 v8, v8, v9
  v_cvt_pk_bf16_f32 v136, v48, v49
  v_cvt_pk_bf16_f32 v137, v50, v51
  v_cvt_pk_bf16_f32 v138, v52, v53
  v_cvt_pk_bf16_f32 v139, v54, v55
  v_cvt_pk_bf16_f32 v140, v56, v57
  v_cvt_pk_bf16_f32 v141, v58, v59
  v_cvt_pk_bf16_f32 v142, v60, v61
  v_cvt_pk_bf16_f32 v143, v62, v63
  buffer_store_dwordx4 v[136:139], v8, s[8:11], s36 offen sc1
  buffer_store_dwordx4 v[140:143], v8, s[8:11], s36 offen offset:640 sc1
  v_add_u32 v7, s37, v6
  v_add_u32 v7, 96, v7
  v_mul_u32_u24 v8, 3641, v7
  v_lshrrev_b32 v8, 16, v8
  v_mul_u32_u24 v10, 18, v8
  v_sub_u32 v7, v7, v10
  v_mul_u32_u24 v8, 155648, v8
  v_lshl_add_u32 v8, v7, 4, v8
  v_add_u32 v8, v8, v9
  v_cvt_pk_bf16_f32 v144, v64, v65
  v_cvt_pk_bf16_f32 v145, v66, v67
  v_cvt_pk_bf16_f32 v146, v68, v69
  v_cvt_pk_bf16_f32 v147, v70, v71
  v_cvt_pk_bf16_f32 v148, v72, v73
  v_cvt_pk_bf16_f32 v149, v74, v75
  v_cvt_pk_bf16_f32 v150, v76, v77
  v_cvt_pk_bf16_f32 v151, v78, v79
  buffer_store_dwordx4 v[144:147], v8, s[8:11], s36 offen sc1
  buffer_store_dwordx4 v[148:151], v8, s[8:11], s36 offen offset:640 sc1
SWE_chain1_k_128:
QE_chain1_k_119:
PHS_end:
END_chain1_k_77:
  s_endpgm
chain1_kernel_codeend:
.globl chain2_kernel
.p2align 8
.type chain2_kernel,@function
chain2_kernel:
  s_mov_b32 s18, 1
  s_branch CHAIN_BODY

TEXT_END:
  s_endpgm
.section .rodata,"a"
.p2align 6
.amdhsa_kernel prep_kernel
  .amdhsa_next_free_vgpr 88
  .amdhsa_next_free_sgpr 102
  .amdhsa_accum_offset 88
  .amdhsa_group_segment_fixed_size 0
  .amdhsa_kernarg_size 72
  .amdhsa_user_sgpr_count 2
  .amdhsa_user_sgpr_kernarg_segment_ptr 1
  .amdhsa_system_sgpr_workgroup_id_x 1
  .amdhsa_float_denorm_mode_32 3
.end_amdhsa_kernel

.p2align 6
.amdhsa_kernel qkv_kernel
  .amdhsa_next_free_vgpr 152
  .amdhsa_next_free_sgpr 102
  .amdhsa_accum_offset 152
  .amdhsa_group_segment_fixed_size 0
  .amdhsa_kernarg_size 72
  .amdhsa_user_sgpr_count 2
  .amdhsa_user_sgpr_kernarg_segment_ptr 1
  .amdhsa_system_sgpr_workgroup_id_x 1
  .amdhsa_float_denorm_mode_32 3
.end_amdhsa_kernel

.p2align 6
.amdhsa_kernel attn1_kernel
  .amdhsa_next_free_vgpr 120
  .amdhsa_next_free_sgpr 102
  .amdhsa_accum_offset 120
  .amdhsa_group_segment_fixed_size 0
  .amdhsa_kernarg_size 72
  .amdhsa_user_sgpr_count 2
  .amdhsa_user_sgpr_kernarg_segment_ptr 1
  .amdhsa_system_sgpr_workgroup_id_x 1
  .amdhsa_float_denorm_mode_32 3
.end_amdhsa_kernel

.p2align 6
.amdhsa_kernel attn2_kernel
  .amdhsa_next_free_vgpr 120
  .amdhsa_next_free_sgpr 102
  .amdhsa_accum_offset 120
  .amdhsa_group_segment_fixed_size 0
  .amdhsa_kernarg_size 72
  .amdhsa_user_sgpr_count 2
  .amdhsa_user_sgpr_kernarg_segment_ptr 1
  .amdhsa_system_sgpr_workgroup_id_x 1
  .amdhsa_float_denorm_mode_32 3
.end_amdhsa_kernel

.p2align 6
.amdhsa_kernel chain1_kernel
  .amdhsa_next_free_vgpr 256
  .amdhsa_next_free_sgpr 102
  .amdhsa_accum_offset 256
  .amdhsa_group_segment_fixed_size 0
  .amdhsa_kernarg_size 72
  .amdhsa_user_sgpr_count 2
  .amdhsa_user_sgpr_kernarg_segment_ptr 1
  .amdhsa_system_sgpr_workgroup_id_x 1
  .amdhsa_float_denorm_mode_32 3
.end_amdhsa_kernel

.p2align 6
.amdhsa_kernel chain2_kernel
  .amdhsa_next_free_vgpr 256
  .amdhsa_next_free_sgpr 102
  .amdhsa_accum_offset 256
  .amdhsa_group_segment_fixed_size 0
  .amdhsa_kernarg_size 72
  .amdhsa_user_sgpr_count 2
  .amdhsa_user_sgpr_kernarg_segment_ptr 1
  .amdhsa_system_sgpr_workgroup_id_x 1
  .amdhsa_float_denorm_mode_32 3
.end_amdhsa_kernel
```
